```python
import torch

def _softmax(x, axis=-1):
    return torch.softmax(x, dim=axis)
def _gelu(x):
    return torch.nn.functional.gelu(x, approximate="tanh")
def _silu(x):
    return torch.nn.functional.silu(x)
def _sigmoid(x):
    return torch.sigmoid(x)
def _layernorm(x, axis=-1, eps=1e-5):
    m = x.mean(dim=axis, keepdim=True)
    v = x.var(dim=axis, keepdim=True, unbiased=False)
    return (x - m) / torch.sqrt(v + eps)
def _scatter_add(tgt, idx, src, axis=0):
    return tgt.clone().index_add_(axis, idx, src)
def _segment_sum(src, seg, n):
    out = torch.zeros((n,) + src.shape[1:], dtype=src.dtype)
    return out.index_add_(0, seg, src)
def _pad(x, pw):
    flat = tuple(v for pair in reversed(pw) for v in pair)
    return torch.nn.functional.pad(x, flat)

kernel_name = 'interleave_layers__sliding_block__glu_gated_swiglu__prompt'

def setup_inputs():

    _w = (lambda a: (lambda t: t.to(torch.bfloat16) if t.is_floating_point() else t)(torch.as_tensor(a)))
    def _A_setup():
        B, S, D = 1, 2048, 448
        return {
            "x": _w((lambda *s: torch.randn(*s, dtype=torch.bfloat16) * 0.05)(B, S, D)),
            "wqkv": _w((lambda *s: torch.randn(*s, dtype=torch.bfloat16) * 0.05)(D, 3 * D)),
            "wo": _w((lambda *s: torch.randn(*s, dtype=torch.bfloat16) * 0.05)(D, D)),
        }
    _A_in = _A_setup()

    def _B_setup():
        B, S, D, F = 1, 2048, 448, 1792
        return {
            "x": _w((lambda *s: torch.randn(*s, dtype=torch.bfloat16) * 0.05)(B, S, D)),
            "w1": _w((lambda *s: torch.randn(*s, dtype=torch.bfloat16) * 0.8)(D, F) * (2.0 / D) ** 0.5),
            "w3": _w((lambda *s: torch.randn(*s, dtype=torch.bfloat16) * 0.8)(D, F) * (2.0 / D) ** 0.5),
            "w2": _w((lambda *s: torch.randn(*s, dtype=torch.bfloat16) * 0.8)(F, D) * (2.0 / F) ** 0.5),
        }
    _B_in = _B_setup()

    return {
        "A_x": _A_in["x"],
        "A_wqkv": _A_in["wqkv"],
        "A_wo": _A_in["wo"],
        "B_x": _B_in["x"],
        "B_w1": _B_in["w1"],
        "B_w3": _B_in["w3"],
        "B_w2": _B_in["w2"],
    }

def reference(A_x, A_wqkv, A_wo, B_x, B_w1, B_w3, B_w2):
    def _A_ref(x, wqkv, wo):
        B, S, D = x.shape
        H = 16; Dh = D // H; W = 256
        qkv = (lambda x, *d: x.permute(*d))((x @ wqkv).reshape(B, S, 3, H, Dh), 2, 0, 3, 1, 4)
        q, k, v = qkv[0], qkv[1], qkv[2]
        scores = torch.einsum("bhqd,bhkd->bhqk", q, k) * (Dh ** -0.5)
        idx = torch.arange(S)
        mask = (idx[:, None] - idx[None, :] >= 0) & (idx[:, None] - idx[None, :] < W)
        scores = torch.where(mask[None, None], scores, -1e9)
        p = _softmax(scores, axis=-1)
        o = torch.einsum("bhqk,bhkd->bhqd", p, v)
        return (lambda x, *d: x.permute(*d))(o, 0, 2, 1, 3).reshape(B, S, D) @ wo

    def _B_ref(x, w1, w3, w2):
        gate = torch.einsum("bsd,df->bsf", x, w1)
        up = torch.einsum("bsd,df->bsf", x, w3)
        h = _silu(gate) * up
        out = torch.einsum("bsf,fd->bsd", h, w2)
        return out

    x = A_x
    x = x + _A_ref(_layernorm(x, axis=-1), A_wqkv, A_wo)
    x = x + _B_ref(_layernorm(x, axis=-1), B_w1, B_w3, B_w2)
    x = x + _A_ref(_layernorm(x, axis=-1), A_wqkv, A_wo)
    x = x + _B_ref(_layernorm(x, axis=-1), B_w1, B_w3, B_w2)
    return x
```

```asm
; @launch grid=(256,1,1) block=(256,1,1) lds=163840
.amdgcn_target "amdgcn-amd-amdhsa--gfx950"
.text
.globl interleave_layers__sliding_block__glu_gated_swiglu__prompt_kernel
.p2align 8
.type interleave_layers__sliding_block__glu_gated_swiglu__prompt_kernel,@function
interleave_layers__sliding_block__glu_gated_swiglu__prompt_kernel:
    s_load_dwordx16 s[64:79], s[0:1], 0
    s_load_dwordx4 s[80:83], s[0:1], 64
    s_cmp_ge_u32 s2, 256
    s_cbranch_scc1 main_done
    v_lshrrev_b32 v1, 6, v0
    v_and_b32 v7, 63, v0
    v_readfirstlane_b32 s14, v1
    s_and_b32 s12, s2, 7
    s_lshl_b32 s12, s12, 1
    s_bfe_u32 s34, s2, 0x10003
    s_add_u32 s12, s12, s34
    s_lshr_b32 s13, s2, 4
    s_mul_i32 s16, s13, 5
    s_add_u32 s16, s16, s12
    s_and_b32 s16, s16, 15
    s_getpc_b64 s[34:35]
Lpc_base:
    s_cmp_eq_u32 s14, 3
    s_cbranch_scc0 Lcpf_1
    s_lshr_b32 s36, s2, 3
    s_lshl_b32 s36, s36, 11
    v_lshl_add_u32 v196, v7, 7, s36
    s_mov_b32 s36, main_done - Lpc_base
    v_min_u32 v196, s36, v196
    s_mov_b64 exec, 0xffff
    global_load_dword v223, v196, s[34:35]
    s_mov_b64 exec, -1
Lcpf_1:
    v_lshrrev_b32 v196, 2, v7
    v_and_b32 v197, 3, v7
    v_lshlrev_b32 v0, 4, v7
    v_and_b32 v206, 31, v7
    v_lshrrev_b32 v207, 5, v7
    s_lshr_b32 s34, s16, 2
    s_and_b32 s35, s16, 3
    s_add_u32 s36, s34, 1
    s_cmp_ge_u32 s36, 3
    s_cselect_b32 s36, 0, s36
    s_mul_i32 s36, s36, 896
    s_mul_i32 s37, s13, 56
    s_add_u32 s36, s36, s37
    s_mul_i32 s37, s35, 7
    s_lshl_b32 s38, s14, 1
    s_add_u32 s38, s38, s37
    s_mul_i32 s39, s38, 43008
    s_add_u32 s36, s36, s39
    s_add_u32 s39, s36, 43008
    s_cmp_eq_u32 s14, 3
    s_cselect_b32 s39, 0x40000000, s39
    s_mul_i32 s40, s13, 3
    s_add_u32 s40, s40, s34
    s_mul_i32 s41, s40, 28
    s_add_u32 s41, s41, s37
    s_lshl_b32 s41, s41, 10
    s_add_u32 s41, s41, 262144
    s_lshl_b32 s42, s40, 4
    s_lshl_b32 s43, s35, 2
    s_add_u32 s42, s42, s43
    s_add_u32 s42, s42, s14
    s_lshl_b32 s42, s42, 8
    s_add_u32 s42, s42, 7340032
    s_cmp_lt_u32 s16, 12
    s_cselect_b32 s43, -1, 0
    v_mul_u32_u24 v198, 2688, v196
    v_lshl_add_u32 v198, v197, 4, v198
    s_lshl_b32 s44, s14, 11
    s_add_u32 s44, s44, 32768
    v_lshrrev_b32 v199, 3, v7
    v_and_b32 v200, 7, v7
    v_lshrrev_b32 v201, 1, v199
    v_xor_b32 v200, v200, v201
    v_lshlrev_b32 v200, 4, v200
    v_mul_u32_u24 v201, 896, v199
    v_xor_b32 v202, 64, v200
    v_add_u32 v200, v200, v201
    v_add_u32 v202, v202, v201
    s_lshl_b32 s48, s12, 2
    s_add_u32 s48, s48, s14
    s_mul_i32 s48, s48, 28672
    s_mul_i32 s46, s14, 28672
    s_add_u32 s46, s46, 40960
    s_lshr_b32 s47, s13, 1
    s_min_u32 s47, s47, 6
    s_waitcnt lgkmcnt(0)
    s_mov_b64 s[84:85], s[66:67]
    s_and_b32 s86, s43, 1204224
    s_mov_b32 s87, 0x20000
    s_mov_b32 s8, s64
    s_mov_b32 s9, s65
    s_mov_b32 s10, 1835008
    s_mov_b32 s11, 0x20000
    s_mov_b32 m0, s44
    s_nop 0
    buffer_load_dwordx4 v198, s[84:87], s36 offen lds
    s_add_u32 m0, s44, 1024
    s_nop 0
    buffer_load_dwordx4 v198, s[84:87], s39 offen lds
    s_mov_b32 s64, s47
    s_lshl_b32 s65, s64, 12
    s_add_u32 s65, s65, s46
    s_lshl_b32 s66, s64, 7
    s_add_u32 s66, s66, s48
    s_add_u32 s64, s64, 1
    s_cmp_eq_u32 s64, 7
    s_cselect_b32 s64, 0, s64
    s_add_u32 m0, s65, 0
    s_add_u32 s67, s66, 0
    buffer_load_dwordx4 v200, s[8:11], s67 offen lds
    s_add_u32 m0, s65, 1024
    s_add_u32 s67, s66, 7168
    buffer_load_dwordx4 v202, s[8:11], s67 offen lds
    s_add_u32 m0, s65, 2048
    s_add_u32 s67, s66, 14336
    buffer_load_dwordx4 v200, s[8:11], s67 offen lds
    s_add_u32 m0, s65, 3072
    s_add_u32 s67, s66, 21504
    buffer_load_dwordx4 v202, s[8:11], s67 offen lds
    s_cmp_eq_u32 s2, 0
    s_cbranch_scc0 Lnonce_2
    s_cmp_eq_u32 s14, 0
    s_cbranch_scc0 Lnonce_2
    s_memrealtime s[34:35]
    s_waitcnt lgkmcnt(0)
    s_waitcnt lgkmcnt(0)
    s_or_b32 s34, s34, 1
    v_mov_b32 v210, s34
    v_mov_b32 v211, s35
    s_mov_b64 exec, 1
    global_store_dwordx2 v0, v[210:211], s[80:81] sc1
    s_mov_b64 exec, -1
Lnonce_2:
    s_lshl_b32 s65, s64, 12
    s_add_u32 s65, s65, s46
    s_lshl_b32 s66, s64, 7
    s_add_u32 s66, s66, s48
    s_add_u32 s64, s64, 1
    s_cmp_eq_u32 s64, 7
    s_cselect_b32 s64, 0, s64
    s_add_u32 m0, s65, 0
    s_add_u32 s67, s66, 0
    buffer_load_dwordx4 v200, s[8:11], s67 offen lds
    s_add_u32 m0, s65, 1024
    s_add_u32 s67, s66, 7168
    buffer_load_dwordx4 v202, s[8:11], s67 offen lds
    s_add_u32 m0, s65, 2048
    s_add_u32 s67, s66, 14336
    buffer_load_dwordx4 v200, s[8:11], s67 offen lds
    s_add_u32 m0, s65, 3072
    s_add_u32 s67, s66, 21504
    buffer_load_dwordx4 v202, s[8:11], s67 offen lds
    s_mov_b32 s4, s82
    s_mov_b32 s5, s83
    s_mov_b32 s6, 0x10000000
    s_mov_b32 s7, 0x20000
    s_add_u32 s92, s82, s41
    s_addc_u32 s93, s83, 0
    s_and_b32 s94, s43, 7168
    s_mov_b32 s95, 0x20000
    s_mov_b32 s96, s82
    s_mov_b32 s97, s83
    s_and_b32 s98, s43, 0x10000000
    s_mov_b32 s99, 0x20000
    v_lshlrev_b32 v7, 3, v7
    v_bfe_u32 v205, v7, 5, 2
    v_lshl_add_u32 v205, v207, 3, v205
    v_lshlrev_b32 v205, 6, v205
    v_bfe_u32 v203, v7, 7, 1
    v_lshl_add_u32 v205, v203, 5, v205
    v_bfe_u32 v203, v7, 3, 1
    v_lshl_add_u32 v205, v203, 4, v205
    v_bfe_u32 v203, v7, 4, 1
    v_lshl_add_u32 v205, v203, 3, v205
    v_add_u32 v203, s44, v205
    v_cmp_gt_u32 vcc, 28, v206
    s_nop 1
    v_cndmask_b32 v201, 0, -1, vcc
    v_mov_b32 v209, 0x3f803f80
    s_lshl_b32 s34, s14, 11
    v_add_u32 v199, s34, v0
    v_lshrrev_b32 v198, 1, v7
    v_bfe_u32 v204, v206, 1, 3
    v_xor_b32 v204, v204, v207
    v_lshlrev_b32 v204, 4, v204
    v_lshl_add_u32 v204, v206, 7, v204
    v_add_u32 v204, s46, v204
    s_and_b32 s34, s13, 1
    s_lshl_b32 s34, s34, 6
    v_xor_b32 v208, s34, v204
    s_lshl_b32 s34, s47, 12
    v_add_u32 v208, s34, v208
    v_xor_b32 v197, 32, v208
    v_mov_b32 v188, 0
    v_mov_b32 v189, 0
    v_mov_b32 v190, 0
    v_mov_b32 v191, 0
    v_mov_b32 v192, 0
    v_mov_b32 v193, 0
    v_mov_b32 v194, 0
    v_mov_b32 v195, 0
    s_waitcnt vmcnt(8)
    ds_read_b64_tr_b16 v[128:129], v203 offset:0
    ds_read_b64_tr_b16 v[130:131], v203 offset:256
    ds_read_b64_tr_b16 v[132:133], v203 offset:1024
    ds_read_b64_tr_b16 v[134:135], v203 offset:1280
    s_waitcnt lgkmcnt(3)
    v_and_b32 v128, v201, v128
    v_and_b32 v129, v201, v129
    s_waitcnt lgkmcnt(2)
    v_and_b32 v130, v201, v130
    v_and_b32 v131, v201, v131
    buffer_store_dwordx4 v[128:131], v199, s[92:95], 0 offen offset:0 sc1
    s_waitcnt lgkmcnt(1)
    v_and_b32 v132, v201, v132
    v_and_b32 v133, v201, v133
    s_waitcnt lgkmcnt(0)
    v_and_b32 v134, v201, v134
    v_and_b32 v135, v201, v135
    buffer_store_dwordx4 v[132:135], v199, s[92:95], 0 offen offset:1024 sc1
    v_dot2_f32_bf16 v188, v128, v209, v188
    v_dot2_f32_bf16 v189, v129, v209, v189
    v_dot2_f32_bf16 v190, v130, v209, v190
    v_dot2_f32_bf16 v191, v131, v209, v191
    v_dot2_f32_bf16 v188, v132, v209, v188
    v_dot2_f32_bf16 v189, v133, v209, v189
    v_dot2_f32_bf16 v190, v134, v209, v190
    v_dot2_f32_bf16 v191, v135, v209, v191
    s_nop 0
    v_add_f32 v188, v188, v189
    s_nop 0
    v_add_f32 v190, v190, v191
    v_add_f32 v188, v188, v190
    buffer_store_dword v188, v198, s[96:99], s42 offen sc1
    s_lshl_b32 s15, s12, 20
    s_add_u32 s15, s15, 16777216
    s_mul_i32 s34, s14, 14
    s_add_u32 s34, s34, s13
    s_lshl_b32 s34, s34, 8
    s_add_u32 s34, s34, s15
    s_add_u32 s34, s34, 344064
    s_cmp_lt_u32 s13, 14
    s_cselect_b32 s34, s34, 0x40000000
    s_waitcnt vmcnt(7)
    ds_read_b128 v[136:139], v208
    ds_read_b128 v[140:143], v197
    s_waitcnt lgkmcnt(1)
    v_dot2_f32_bf16 v192, v136, v209, v192
    v_dot2_f32_bf16 v193, v136, v136, v193
    v_dot2_f32_bf16 v194, v137, v209, v194
    v_dot2_f32_bf16 v195, v137, v137, v195
    v_dot2_f32_bf16 v192, v138, v209, v192
    v_dot2_f32_bf16 v193, v138, v138, v193
    v_dot2_f32_bf16 v194, v139, v209, v194
    v_dot2_f32_bf16 v195, v139, v139, v195
    s_waitcnt lgkmcnt(0)
    v_dot2_f32_bf16 v192, v140, v209, v192
    v_dot2_f32_bf16 v193, v140, v140, v193
    v_dot2_f32_bf16 v194, v141, v209, v194
    v_dot2_f32_bf16 v195, v141, v141, v195
    v_dot2_f32_bf16 v192, v142, v209, v192
    v_dot2_f32_bf16 v193, v142, v142, v193
    v_dot2_f32_bf16 v194, v143, v209, v194
    v_dot2_f32_bf16 v195, v143, v143, v195
    s_nop 1
    v_add_f32 v192, v192, v194
    v_add_f32 v193, v193, v195
    v_mov_b32 v194, v192
    v_mov_b32 v195, v193
    v_and_b32 v197, 0xf8, v7
    v_permlane32_swap_b32 v192, v194
    v_permlane32_swap_b32 v193, v195
    v_add_f32 v192, v192, v194
    v_add_f32 v193, v193, v195
    buffer_store_dwordx2 v[192:193], v197, s[4:7], s34 offen sc1
    v_mov_b32 v203, 0
    global_load_dwordx2 v[210:211], v203, s[80:81] sc1
    s_lshl_b32 s65, s64, 12
    s_add_u32 s65, s65, s46
    s_lshl_b32 s66, s64, 7
    s_add_u32 s66, s66, s48
    s_add_u32 s64, s64, 1
    s_cmp_eq_u32 s64, 7
    s_cselect_b32 s64, 0, s64
    s_add_u32 m0, s65, 0
    s_add_u32 s67, s66, 0
    buffer_load_dwordx4 v200, s[8:11], s67 offen lds
    s_add_u32 m0, s65, 1024
    s_add_u32 s67, s66, 7168
    buffer_load_dwordx4 v202, s[8:11], s67 offen lds
    s_add_u32 m0, s65, 2048
    s_add_u32 s67, s66, 14336
    buffer_load_dwordx4 v200, s[8:11], s67 offen lds
    s_add_u32 m0, s65, 3072
    s_add_u32 s67, s66, 21504
    buffer_load_dwordx4 v202, s[8:11], s67 offen lds
    s_lshl_b32 s65, s64, 12
    s_add_u32 s65, s65, s46
    s_lshl_b32 s66, s64, 7
    s_add_u32 s66, s66, s48
    s_add_u32 s64, s64, 1
    s_cmp_eq_u32 s64, 7
    s_cselect_b32 s64, 0, s64
    s_add_u32 m0, s65, 0
    s_add_u32 s67, s66, 0
    buffer_load_dwordx4 v200, s[8:11], s67 offen lds
    s_add_u32 m0, s65, 1024
    s_add_u32 s67, s66, 7168
    buffer_load_dwordx4 v202, s[8:11], s67 offen lds
    s_add_u32 m0, s65, 2048
    s_add_u32 s67, s66, 14336
    buffer_load_dwordx4 v200, s[8:11], s67 offen lds
    s_add_u32 m0, s65, 3072
    s_add_u32 s67, s66, 21504
    buffer_load_dwordx4 v202, s[8:11], s67 offen lds
    s_lshl_b32 s65, s64, 12
    s_add_u32 s65, s65, s46
    s_lshl_b32 s66, s64, 7
    s_add_u32 s66, s66, s48
    s_add_u32 s64, s64, 1
    s_cmp_eq_u32 s64, 7
    s_cselect_b32 s64, 0, s64
    s_add_u32 m0, s65, 0
    s_add_u32 s67, s66, 0
    buffer_load_dwordx4 v200, s[8:11], s67 offen lds
    s_add_u32 m0, s65, 1024
    s_add_u32 s67, s66, 7168
    buffer_load_dwordx4 v202, s[8:11], s67 offen lds
    s_add_u32 m0, s65, 2048
    s_add_u32 s67, s66, 14336
    buffer_load_dwordx4 v200, s[8:11], s67 offen lds
    s_add_u32 m0, s65, 3072
    s_add_u32 s67, s66, 21504
    buffer_load_dwordx4 v202, s[8:11], s67 offen lds
    s_lshl_b32 s65, s64, 12
    s_add_u32 s65, s65, s46
    s_lshl_b32 s66, s64, 7
    s_add_u32 s66, s66, s48
    s_add_u32 s64, s64, 1
    s_cmp_eq_u32 s64, 7
    s_cselect_b32 s64, 0, s64
    s_add_u32 m0, s65, 0
    s_add_u32 s67, s66, 0
    buffer_load_dwordx4 v200, s[8:11], s67 offen lds
    s_add_u32 m0, s65, 1024
    s_add_u32 s67, s66, 7168
    buffer_load_dwordx4 v202, s[8:11], s67 offen lds
    s_add_u32 m0, s65, 2048
    s_add_u32 s67, s66, 14336
    buffer_load_dwordx4 v200, s[8:11], s67 offen lds
    s_add_u32 m0, s65, 3072
    s_add_u32 s67, s66, 21504
    buffer_load_dwordx4 v202, s[8:11], s67 offen lds
    s_lshl_b32 s65, s64, 12
    s_add_u32 s65, s65, s46
    s_lshl_b32 s66, s64, 7
    s_add_u32 s66, s66, s48
    s_add_u32 s64, s64, 1
    s_cmp_eq_u32 s64, 7
    s_cselect_b32 s64, 0, s64
    s_add_u32 m0, s65, 0
    s_add_u32 s67, s66, 0
    buffer_load_dwordx4 v200, s[8:11], s67 offen lds
    s_add_u32 m0, s65, 1024
    s_add_u32 s67, s66, 7168
    buffer_load_dwordx4 v202, s[8:11], s67 offen lds
    s_add_u32 m0, s65, 2048
    s_add_u32 s67, s66, 14336
    buffer_load_dwordx4 v200, s[8:11], s67 offen lds
    s_add_u32 m0, s65, 3072
    s_add_u32 s67, s66, 21504
    buffer_load_dwordx4 v202, s[8:11], s67 offen lds
    s_sub_u32 s3, 15, s16
    s_lshl_b32 s3, s3, 4
    s_add_u32 s3, s3, s13
    s_and_b32 s40, s14, 1
    s_lshr_b32 s41, s14, 1
    s_mov_b32 s39, 0
    s_mov_b32 s70, 0x40000000
    s_mov_b32 s94, 7168
    s_mov_b32 s38, 32
    s_mul_i32 s67, s14, 7168
    s_mov_b32 s71, 155648
    s_cmp_ge_u32 s3, 168
    s_cbranch_scc1 Luwo_6
    s_cmp_ge_u32 s3, 112
    s_cbranch_scc1 Luw2_5
    s_lshr_b32 s34, s3, 2
    s_and_b32 s35, s3, 3
    s_mov_b32 s36, 3584
    s_lshl_b32 s37, s35, 1
    s_add_u32 s37, s37, s40
    s_mul_i32 s37, s37, 200704
    s_lshl_b32 s64, s34, 7
    s_add_u32 s37, s37, s64
    s_cmp_eq_u32 s41, 0
    s_cselect_b32 s84, s72, s74
    s_cselect_b32 s85, s73, s75
    s_mov_b32 s86, 1605632
    s_lshl_b32 s64, s34, 2
    s_add_u32 s64, s64, s14
    s_lshl_b32 s70, s64, 2
    s_add_u32 s70, s70, s35
    s_mul_i32 s66, s70, 7168
    s_add_u32 s66, s66, 2097152
    s_lshl_b32 s70, s70, 8
    s_add_u32 s70, s70, 7602176
    s_lshl_b32 s65, s14, 5
    s_mov_b32 s38, 14336
    s_branch Luend_7
Luw2_5:
    s_sub_u32 s34, s3, 112
    s_and_b32 s35, s34, 7
    s_lshr_b32 s34, s34, 3
    s_mov_b32 s36, 896
    s_lshl_b32 s37, s35, 2
    s_add_u32 s37, s37, s14
    s_mul_i32 s37, s37, 50176
    s_lshl_b32 s64, s34, 7
    s_add_u32 s37, s37, s64
    s_mov_b64 s[84:85], s[76:77]
    s_mov_b32 s86, 1605632
    s_lshl_b32 s64, s34, 1
    s_add_u32 s64, s64, s40
    s_lshl_b32 s64, s64, 4
    s_lshl_b32 s65, s35, 1
    s_add_u32 s64, s64, s65
    s_add_u32 s64, s64, s41
    s_mul_i32 s66, s64, 7168
    s_add_u32 s66, s66, 5308416
    s_mul_i32 s65, s41, 14336
    s_lshl_b32 s64, s40, 6
    s_add_u32 s65, s65, s64
    s_branch Luend_7
Luwo_6:
    s_sub_u32 s34, s3, 168
    s_and_b32 s35, s34, 1
    s_lshr_b32 s34, s34, 1
    s_mov_b32 s36, 896
    s_mov_b32 s39, 4
    s_lshl_b32 s37, s35, 2
    s_add_u32 s37, s37, s14
    s_mul_i32 s37, s37, 50176
    s_lshl_b32 s64, s34, 7
    s_add_u32 s37, s37, s64
    s_mov_b64 s[84:85], s[68:69]
    s_cmp_lt_u32 s3, 182
    s_cselect_b32 s86, 401408, 0
    s_cselect_b32 s94, 8192, 0
    s_lshl_b32 s64, s34, 1
    s_add_u32 s64, s64, s40
    s_lshl_b32 s64, s64, 2
    s_lshl_b32 s65, s35, 1
    s_add_u32 s64, s64, s65
    s_add_u32 s64, s64, s41
    s_lshl_b32 s66, s64, 13
    s_add_u32 s66, s66, 1638400
    s_lshl_b32 s65, s41, 14
    s_lshl_b32 s64, s40, 6
    s_add_u32 s65, s65, s64
    s_lshl_b32 s67, s14, 13
    s_add_u32 s71, s67, 7168
Luend_7:
    s_add_u32 s92, s82, s66
    s_addc_u32 s93, s83, 0
    v_bfe_u32 v196, v7, 6, 3
    v_bfe_u32 v197, v7, 3, 3
    v_mul_lo_u32 v198, v196, s36
    v_lshl_add_u32 v198, v197, 4, v198
    v_mov_b32 v201, 0x40000000
    v_add_u32 v199, s39, v196
    v_cmp_le_u32 vcc, 8, v199
    s_nop 1
    v_cndmask_b32 v199, v198, v201, vcc
    s_lshl_b32 s64, s36, 3
    s_sub_u32 s66, 8, s39
    s_mul_i32 s66, s66, s36
    s_add_u32 m0, s67, 0
    s_nop 0
    buffer_load_dwordx4 v198, s[84:87], s37 offen lds
    s_add_u32 s37, s37, s64
    s_add_u32 m0, s67, 1024
    s_nop 0
    buffer_load_dwordx4 v198, s[84:87], s37 offen lds
    s_add_u32 s37, s37, s64
    s_add_u32 m0, s67, 2048
    s_nop 0
    buffer_load_dwordx4 v198, s[84:87], s37 offen lds
    s_add_u32 s37, s37, s64
    s_add_u32 m0, s67, 3072
    s_nop 0
    buffer_load_dwordx4 v199, s[84:87], s37 offen lds
    s_add_u32 s37, s37, s66
    s_add_u32 m0, s67, 4096
    s_nop 0
    buffer_load_dwordx4 v198, s[84:87], s37 offen lds
    s_add_u32 s37, s37, s64
    s_add_u32 m0, s67, 5120
    s_nop 0
    buffer_load_dwordx4 v198, s[84:87], s37 offen lds
    s_add_u32 s37, s37, s64
    s_add_u32 m0, s67, 6144
    s_nop 0
    buffer_load_dwordx4 v198, s[84:87], s37 offen lds
    s_add_u32 s37, s37, s64
    s_mov_b32 m0, s71
    s_nop 0
    buffer_load_dwordx4 v199, s[84:87], s37 offen lds
    v_bfe_u32 v205, v7, 5, 2
    v_lshl_add_u32 v205, v207, 3, v205
    v_lshlrev_b32 v205, 7, v205
    v_bfe_u32 v201, v7, 7, 1
    v_mul_lo_u32 v201, v201, s38
    v_add_u32 v205, v205, v201
    v_bfe_u32 v201, v7, 3, 1
    v_lshl_add_u32 v205, v201, 4, v205
    v_bfe_u32 v201, v7, 4, 1
    v_lshl_add_u32 v205, v201, 3, v205
    v_add_u32 v205, s65, v205
    s_lshl_b32 s3, s3, 3
    s_lshl_b32 s69, s16, 3
    v_add_u32 v1, 0x10000, v0
    v_add_u32 v2, 0x20000, v0
    s_mul_i32 s48, s13, 86016
    s_add_u32 s48, s48, 262144
    s_mul_i32 s49, s13, 200704
    s_add_u32 s49, s49, 2097152
    s_mov_b32 s33, 0x40000
    s_getreg_b32 s63, hwreg(HW_REG_XCC_ID, 0, 4)
    s_mov_b32 s16, s15
    s_cmp_ge_u32 s13, 7
    s_cselect_b32 s40, 1, 0
    s_mul_i32 s41, s40, 7
    s_sub_u32 s41, s13, s41
    s_min_u32 s41, s41, 6
    s_lshr_b32 s36, s14, 1
    s_and_b32 s37, s14, 1
    s_lshl_b32 s38, s40, 1
    s_add_u32 s39, s38, s36
    s_sub_u32 s38, s38, s36
    s_add_u32 s38, s38, 1
    s_lshl_b32 s41, s41, 1
    s_add_u32 s46, s41, s37
    s_sub_u32 s47, s41, s37
    s_add_u32 s47, s47, 1
    s_mul_i32 s17, s14, 28672
    s_add_u32 s17, s17, s16
    s_mov_b32 s15, s17
    s_mul_i32 s18, s14, 3584
    s_add_u32 s18, s18, s16
    s_mov_b32 s32, s18
    s_lshl_b32 s19, s12, 5
    s_add_u32 s19, s19, s13
    s_lshl_b32 s19, s19, 14
    s_add_u32 s19, s19, 8388608
    s_add_u32 s20, s14, 1
    s_lshl_b32 s20, s20, 19
    s_sub_u32 s20, s19, s20
    s_lshl_b32 s34, s14, 12
    s_add_u32 s19, s19, s34
    s_lshl_b32 s21, s14, 4
    s_add_u32 s21, s21, s13
    s_lshl_b32 s21, s21, 11
    s_add_u32 s21, s21, s16
    s_add_u32 s21, s21, 430080
    s_lshl_b32 s34, s14, 13
    s_add_u32 s34, s34, s16
    s_add_u32 s34, s34, 430080
    s_lshl_b32 s22, s39, 15
    s_add_u32 s22, s22, s34
    s_lshl_b32 s23, s38, 15
    s_add_u32 s23, s23, s34
    s_add_u32 s34, s17, 561152
    s_mul_i32 s24, s39, 114688
    s_add_u32 s24, s24, s34
    s_mul_i32 s25, s38, 114688
    s_add_u32 s25, s25, s34
    s_mul_i32 s34, s39, 14
    s_add_u32 s34, s34, s46
    s_lshl_b32 s26, s34, 11
    s_add_u32 s26, s26, s16
    s_lshl_b32 s27, s34, 8
    s_add_u32 s27, s27, s16
    s_lshl_b32 s28, s14, 4
    s_add_u32 s28, s28, s13
    s_mul_i32 s28, s28, 7168
    s_add_u32 s28, s28, s16
    s_add_u32 s28, s28, 561152
    s_lshl_b32 s34, s12, 2
    s_add_u32 s34, s34, s39
    s_mul_i32 s57, s34, 28672
    s_lshl_b32 s34, s46, 6
    s_add_u32 s57, s57, s34
    s_lshl_b32 s34, s14, 13
    s_add_u32 s34, s34, 1638400
    s_lshl_b32 s58, s46, 15
    s_add_u32 s58, s58, s34
    s_lshl_b32 s59, s47, 15
    s_add_u32 s59, s59, s34
    s_mul_i32 s34, s14, 28672
    s_add_u32 s34, s34, 5308416
    s_mul_i32 s60, s46, 114688
    s_add_u32 s60, s60, s34
    s_mul_i32 s61, s47, 114688
    s_add_u32 s61, s61, s34
    s_mov_b32 s46, s41
    v_mul_u32_u24 v208, 896, v206
    v_lshl_add_u32 v208, v207, 4, v208
    buffer_load_dwordx4 v[8:11], v208, s[8:11], s57 offen
    buffer_load_dwordx4 v[12:15], v208, s[8:11], s57 offen offset:32
    s_lshl_b32 s29, s12, 8
    s_lshl_b32 s34, s13, 3
    s_add_u32 s30, s29, s34
    s_lshl_b32 s62, s12, 4
    s_add_u32 s62, s62, s13
    s_lshl_b32 s62, s62, 7
    s_add_u32 s62, s62, 65536
    s_add_u32 s34, s14, 1
    s_lshl_b32 s34, s34, 11
    s_sub_u32 s31, s62, s34
    s_sub_u32 s50, s14, 1
    s_mov_b32 s52, 0x3b124925
    s_mov_b32 s53, 0x3727c5ac
    s_mov_b32 s54, 0x3e8b97f6
    s_mov_b32 s55, 0xbfb8aa3b
    s_mov_b32 s56, 0xf1800000
    s_mov_b32 s40, 0
    s_mov_b32 s41, -1
    s_waitcnt vmcnt(30)
    v_readfirstlane_b32 s100, v210
    v_readfirstlane_b32 s101, v211
    s_cmp_lg_u32 s100, 0
    s_cbranch_scc1 Ltagok_4
Ltag_3:
    global_load_dwordx2 v[210:211], v203, s[80:81] sc1
    s_waitcnt vmcnt(0)
    s_waitcnt vmcnt(0)
    v_readfirstlane_b32 s100, v210
    v_readfirstlane_b32 s101, v211
    s_sub_u32 s33, s33, 1
    s_cmp_eq_u32 s33, 0
    s_cbranch_scc1 main_done
    s_cmp_lg_u32 s100, 0
    s_cbranch_scc0 Ltag_3
Ltagok_4:
    s_barrier
    s_cmp_eq_u32 s14, 0
    s_cbranch_scc0 Loth_8
    s_lshl_b32 s35, s13, 8
    s_add_u32 s35, s35, s69
    s_add_u32 s34, s35, 40960
    v_mov_b32 v220, s100
    v_mov_b32 v221, s101
    s_mov_b64 exec, 1
    buffer_store_dwordx2 v[220:221], v0, s[4:7], s34 offen sc1
    s_mov_b64 exec, -1
    s_add_u32 s35, s101, s63
    v_mov_b32 v221, s35
    s_add_u32 s34, s30, 32768
    s_mov_b64 exec, 1
    buffer_store_dwordx2 v[220:221], v0, s[4:7], s34 offen sc1
    s_mov_b64 exec, -1
Loth_8:
    v_lshlrev_b32 v4, 4, v206
    v_add_u32 v4, 157696, v4
    v_cmp_eq_u32 vcc, 28, v206
    s_nop 1
    v_cndmask_b32 v5, 0, 1.0, vcc
    s_lshl_b32 s34, s14, 7
    s_add_u32 s34, s34, 162816
    v_lshl_add_u32 v3, v206, 2, s34
    v_lshl_add_u32 v6, v207, 4, s34
    v_xor_b32 v197, 32, v204
    v_xor_b32 v198, 64, v204
    v_xor_b32 v199, 96, v204
    s_waitcnt vmcnt(0)
    ds_read_b128 v[16:19], v204 offset:0
    ds_read_b128 v[20:23], v197 offset:0
    ds_read_b128 v[24:27], v198 offset:0
    ds_read_b128 v[28:31], v199 offset:0
    ds_read_b128 v[32:35], v204 offset:4096
    ds_read_b128 v[36:39], v197 offset:4096
    ds_read_b128 v[40:43], v198 offset:4096
    ds_read_b128 v[44:47], v199 offset:4096
    ds_read_b128 v[48:51], v204 offset:8192
    ds_read_b128 v[52:55], v197 offset:8192
    ds_read_b128 v[56:59], v198 offset:8192
    ds_read_b128 v[60:63], v199 offset:8192
    ds_read_b128 v[64:67], v204 offset:12288
    ds_read_b128 v[68:71], v197 offset:12288
    ds_read_b128 v[72:75], v198 offset:12288
    ds_read_b128 v[76:79], v199 offset:12288
    ds_read_b128 v[80:83], v204 offset:16384
    ds_read_b128 v[84:87], v197 offset:16384
    ds_read_b128 v[88:91], v198 offset:16384
    ds_read_b128 v[92:95], v199 offset:16384
    ds_read_b128 v[96:99], v204 offset:20480
    ds_read_b128 v[100:103], v197 offset:20480
    ds_read_b128 v[104:107], v198 offset:20480
    ds_read_b128 v[108:111], v199 offset:20480
    ds_read_b128 v[112:115], v204 offset:24576
    ds_read_b128 v[116:119], v197 offset:24576
    ds_read_b128 v[120:123], v198 offset:24576
    ds_read_b128 v[124:127], v199 offset:24576
    s_lshl_b32 s35, s13, 8
    s_cmp_lt_u32 s14, 2
    s_cbranch_scc0 Loth_10
    s_cmp_eq_u32 s14, 0
    s_cbranch_scc0 Lpb_12
    s_add_u32 s34, s35, 40960
    s_mov_b32 exec_lo, 0xfff
    s_mov_b32 exec_hi, 0
Lpoll_14:
    buffer_load_dwordx2 v[220:221], v7, s[4:7], s34 offen sc1
    s_waitcnt vmcnt(0)
    s_waitcnt vmcnt(0)
    v_cmp_eq_u64 vcc, s[100:101], v[220:221]
    s_sub_u32 s33, s33, 1
    s_cmp_eq_u32 s33, 0
    s_cbranch_scc1 main_done
    s_cmp_eq_u64 vcc, exec
    s_cbranch_scc0 Lpoll_14
    s_mov_b64 exec, -1
    s_branch Lpc_13
Lpb_12:
    s_add_u32 s34, s29, 32768
    s_mov_b64 exec, 0xffff
Lxcc_15:
    buffer_load_dwordx2 v[220:221], v7, s[4:7], s34 offen sc1
    s_waitcnt vmcnt(0)
    s_waitcnt vmcnt(0)
    v_subrev_u32 v218, s101, v221
    v_cmp_eq_u32 s[36:37], s100, v220
    v_cmp_gt_u32 vcc, 16, v218
    s_sub_u32 s33, s33, 1
    s_cmp_eq_u32 s33, 0
    s_cbranch_scc1 main_done
    s_and_b32 s36, s36, vcc_lo
    s_cmp_eq_u32 s36, 0xffff
    s_cbranch_scc0 Lxcc_15
    s_mov_b64 exec, -1
Lpc_13:
Loth_10:
    s_lshr_b32 s37, s14, 1
    s_mul_i32 s37, s37, 28672
    s_and_b32 s39, s14, 1
    s_mul_i32 s39, s39, 7168
    s_add_u32 s37, s37, s39
    s_mul_i32 s39, s14, 7168
    s_waitcnt vmcnt(0) lgkmcnt(0)
    s_barrier
    s_add_u32 s38, s48, s37
    s_add_u32 s34, s38, 0
    s_add_u32 m0, s37, 100352
    s_nop 0
    buffer_load_dwordx4 v0, s[4:7], s34 offen offset:0 sc1 lds
    buffer_load_dwordx4 v0, s[4:7], s34 offen offset:1024 sc1 lds
    buffer_load_dwordx4 v0, s[4:7], s34 offen offset:2048 sc1 lds
    buffer_load_dwordx4 v0, s[4:7], s34 offen offset:3072 sc1 lds
    s_add_u32 s34, s38, 4096
    s_add_u32 m0, s37, 104448
    s_nop 0
    buffer_load_dwordx4 v0, s[4:7], s34 offen offset:0 sc1 lds
    buffer_load_dwordx4 v0, s[4:7], s34 offen offset:1024 sc1 lds
    buffer_load_dwordx4 v0, s[4:7], s34 offen offset:2048 sc1 lds
    s_add_u32 s34, s38, 14336
    s_add_u32 m0, s37, 114688
    s_nop 0
    buffer_load_dwordx4 v0, s[4:7], s34 offen offset:0 sc1 lds
    buffer_load_dwordx4 v0, s[4:7], s34 offen offset:1024 sc1 lds
    buffer_load_dwordx4 v0, s[4:7], s34 offen offset:2048 sc1 lds
    buffer_load_dwordx4 v0, s[4:7], s34 offen offset:3072 sc1 lds
    s_add_u32 s34, s38, 18432
    s_add_u32 m0, s37, 118784
    s_nop 0
    buffer_load_dwordx4 v0, s[4:7], s34 offen offset:0 sc1 lds
    buffer_load_dwordx4 v0, s[4:7], s34 offen offset:1024 sc1 lds
    buffer_load_dwordx4 v0, s[4:7], s34 offen offset:2048 sc1 lds
    ds_read_b64_tr_b16 v[224:225], v205 offset:0
    ds_read_b64_tr_b16 v[226:227], v205 offset:512
    ds_read_b64_tr_b16 v[228:229], v205 offset:2048
    ds_read_b64_tr_b16 v[230:231], v205 offset:2560
    ds_read_b64_tr_b16 v[232:233], v205 offset:4096
    ds_read_b64_tr_b16 v[234:235], v205 offset:4608
    ds_read_b64_tr_b16 v[236:237], v205 offset:6144
    ds_read_b64_tr_b16 v[238:239], v205 offset:6656
    ds_read_b64_tr_b16 v[240:241], v205 offset:8192
    ds_read_b64_tr_b16 v[242:243], v205 offset:8704
    ds_read_b64_tr_b16 v[244:245], v205 offset:10240
    ds_read_b64_tr_b16 v[246:247], v205 offset:10752
    ds_read_b64_tr_b16 v[248:249], v205 offset:12288
    ds_read_b64_tr_b16 v[250:251], v205 offset:12800
    ds_read_b64_tr_b16 v[252:253], v205 offset:14336
    ds_read_b64_tr_b16 v[254:255], v205 offset:14848
    v_mov_b32 v188, 0
    v_mov_b32 v189, 0
    v_mov_b32 v190, 0
    v_mov_b32 v191, 0
    s_waitcnt lgkmcnt(15)
    v_dot2_f32_bf16 v188, v224, v209, v188
    v_dot2_f32_bf16 v189, v225, v209, v189
    s_waitcnt lgkmcnt(14)
    v_dot2_f32_bf16 v190, v226, v209, v190
    v_dot2_f32_bf16 v191, v227, v209, v191
    s_waitcnt lgkmcnt(13)
    v_dot2_f32_bf16 v188, v228, v209, v188
    v_dot2_f32_bf16 v189, v229, v209, v189
    s_waitcnt lgkmcnt(12)
    v_dot2_f32_bf16 v190, v230, v209, v190
    v_dot2_f32_bf16 v191, v231, v209, v191
    s_waitcnt lgkmcnt(11)
    v_dot2_f32_bf16 v188, v232, v209, v188
    v_dot2_f32_bf16 v189, v233, v209, v189
    s_waitcnt lgkmcnt(10)
    v_dot2_f32_bf16 v190, v234, v209, v190
    v_dot2_f32_bf16 v191, v235, v209, v191
    s_waitcnt lgkmcnt(9)
    v_dot2_f32_bf16 v188, v236, v209, v188
    v_dot2_f32_bf16 v189, v237, v209, v189
    s_waitcnt lgkmcnt(8)
    v_dot2_f32_bf16 v190, v238, v209, v190
    v_dot2_f32_bf16 v191, v239, v209, v191
    s_waitcnt lgkmcnt(7)
    v_dot2_f32_bf16 v188, v240, v209, v188
    v_dot2_f32_bf16 v189, v241, v209, v189
    s_waitcnt lgkmcnt(6)
    v_dot2_f32_bf16 v190, v242, v209, v190
    v_dot2_f32_bf16 v191, v243, v209, v191
    s_waitcnt lgkmcnt(5)
    v_dot2_f32_bf16 v188, v244, v209, v188
    v_dot2_f32_bf16 v189, v245, v209, v189
    s_waitcnt lgkmcnt(4)
    v_dot2_f32_bf16 v190, v246, v209, v190
    v_dot2_f32_bf16 v191, v247, v209, v191
    s_waitcnt lgkmcnt(3)
    v_dot2_f32_bf16 v188, v248, v209, v188
    v_dot2_f32_bf16 v189, v249, v209, v189
    s_waitcnt lgkmcnt(2)
    v_dot2_f32_bf16 v190, v250, v209, v190
    v_dot2_f32_bf16 v191, v251, v209, v191
    v_add_f32 v188, v188, v189
    s_nop 1
    v_add_f32 v190, v190, v191
    v_add_f32 v5, v188, v190
    s_mov_b64 s[96:97], s[92:93]
    s_mov_b32 s98, s94
    s_mov_b32 s47, s70
    s_mov_b32 s8, s78
    s_mov_b32 s9, s79
    v_lshlrev_b32 v207, 2, v207
    v_sub_u32 v207, v206, v207
    v_cmp_le_i32 s[64:65], 0, v207
    v_cmp_le_i32 s[66:67], 1, v207
    v_cmp_le_i32 s[68:69], 2, v207
    v_cmp_le_i32 s[70:71], 3, v207
    v_cmp_le_i32 s[72:73], 8, v207
    v_cmp_le_i32 s[74:75], 9, v207
    v_cmp_le_i32 s[76:77], 10, v207
    v_cmp_le_i32 s[78:79], 11, v207
    v_cmp_le_i32 s[80:81], 16, v207
    v_cmp_le_i32 s[82:83], 17, v207
    v_cmp_le_i32 s[84:85], 18, v207
    v_cmp_le_i32 s[86:87], 19, v207
    v_cmp_le_i32 s[88:89], 24, v207
    v_cmp_le_i32 s[90:91], 25, v207
    v_cmp_le_i32 s[92:93], 26, v207
    v_cmp_le_i32 s[94:95], 27, v207
    s_waitcnt vmcnt(7)
    s_barrier
    s_lshl_b32 s34, s14, 12
    v_add_u32 v220, s34, v0
    v_lshrrev_b32 v174, 1, v7
    v_add_u32 v175, 4096, v0
    s_add_u32 s38, s48, s39
    ds_read_b128 v[176:179], v1 offset:34816
    ds_read_b128 v[180:183], v1 offset:63488
    ds_read_b128 v[184:187], v1 offset:35840
    ds_read_b128 v[188:191], v1 offset:64512
    ds_read_b128 v[192:195], v1 offset:36864
    ds_read_b128 v[196:199], v2 offset:0
    s_waitcnt lgkmcnt(5)
    v_mfma_f32_32x32x16_bf16 v[128:143], v[176:179], v[16:19], 0
    ds_read_b128 v[176:179], v1 offset:37888
    s_add_u32 s35, s18, 344064
    buffer_load_dwordx2 v[160:161], v7, s[4:7], s35 offen offset:0 sc1
    buffer_load_dwordx2 v[162:163], v7, s[4:7], s35 offen offset:512 sc1
    s_waitcnt lgkmcnt(5)
    v_mfma_f32_32x32x16_bf16 v[144:159], v[16:19], v[180:183], 0
    ds_read_b128 v[180:183], v2 offset:1024
    buffer_load_dwordx2 v[164:165], v7, s[4:7], s35 offen offset:1024 sc1
    buffer_load_dwordx2 v[166:167], v7, s[4:7], s35 offen offset:1536 sc1
    s_waitcnt lgkmcnt(5)
    v_mfma_f32_32x32x16_bf16 v[128:143], v[184:187], v[20:23], v[128:143]
    ds_read_b128 v[184:187], v1 offset:38912
    buffer_load_dwordx2 v[168:169], v7, s[4:7], s35 offen offset:2048 sc1
    buffer_load_dwordx2 v[170:171], v7, s[4:7], s35 offen offset:2560 sc1
    s_waitcnt lgkmcnt(5)
    v_mfma_f32_32x32x16_bf16 v[144:159], v[20:23], v[188:191], v[144:159]
    ds_read_b128 v[188:191], v2 offset:2048
    buffer_load_dwordx2 v[172:173], v7, s[4:7], s35 offen offset:3072 sc1
    s_min_u32 s36, s14, 2
    s_mul_i32 s35, s13, 3
    s_add_u32 s35, s35, s36
    s_lshl_b32 s35, s35, 12
    s_add_u32 s35, s35, 7340032
    s_waitcnt lgkmcnt(5)
    v_mfma_f32_32x32x16_bf16 v[128:143], v[192:195], v[24:27], v[128:143]
    ds_read_b128 v[192:195], v1 offset:39936
    buffer_load_dword v200, v174, s[4:7], s35 offen offset:0 sc1
    buffer_load_dword v201, v174, s[4:7], s35 offen offset:256 sc1
    s_waitcnt lgkmcnt(5)
    v_mfma_f32_32x32x16_bf16 v[144:159], v[24:27], v[196:199], v[144:159]
    ds_read_b128 v[196:199], v2 offset:3072
    buffer_load_dword v202, v174, s[4:7], s35 offen offset:512 sc1
    buffer_load_dword v203, v174, s[4:7], s35 offen offset:768 sc1
    s_waitcnt lgkmcnt(5)
    v_mfma_f32_32x32x16_bf16 v[128:143], v[176:179], v[28:31], v[128:143]
    ds_read_b128 v[176:179], v1 offset:40960
    buffer_load_dword v204, v174, s[4:7], s35 offen offset:1024 sc1
    buffer_load_dword v205, v174, s[4:7], s35 offen offset:1280 sc1
    s_waitcnt lgkmcnt(5)
    v_mfma_f32_32x32x16_bf16 v[144:159], v[28:31], v[180:183], v[144:159]
    ds_read_b128 v[180:183], v2 offset:4096
    buffer_load_dword v206, v174, s[4:7], s35 offen offset:1536 sc1
    buffer_load_dword v207, v174, s[4:7], s35 offen offset:1792 sc1
    s_waitcnt lgkmcnt(5)
    v_mfma_f32_32x32x16_bf16 v[128:143], v[184:187], v[32:35], v[128:143]
    ds_read_b128 v[184:187], v1 offset:41984
    buffer_load_dword v208, v174, s[4:7], s35 offen offset:2048 sc1
    buffer_load_dword v209, v174, s[4:7], s35 offen offset:2304 sc1
    s_waitcnt lgkmcnt(5)
    v_mfma_f32_32x32x16_bf16 v[144:159], v[32:35], v[188:191], v[144:159]
    ds_read_b128 v[188:191], v2 offset:5120
    buffer_load_dword v210, v174, s[4:7], s35 offen offset:2560 sc1
    buffer_load_dword v211, v174, s[4:7], s35 offen offset:2816 sc1
    s_waitcnt lgkmcnt(5)
    v_mfma_f32_32x32x16_bf16 v[128:143], v[192:195], v[36:39], v[128:143]
    ds_read_b128 v[192:195], v1 offset:43008
    buffer_load_dword v216, v174, s[4:7], s35 offen offset:3072 sc1
    buffer_load_dword v217, v174, s[4:7], s35 offen offset:3328 sc1
    s_waitcnt lgkmcnt(5)
    v_mfma_f32_32x32x16_bf16 v[144:159], v[36:39], v[196:199], v[144:159]
    ds_read_b128 v[196:199], v2 offset:6144
    buffer_load_dword v218, v174, s[4:7], s35 offen offset:3584 sc1
    buffer_load_dword v219, v174, s[4:7], s35 offen offset:3840 sc1
    s_waitcnt lgkmcnt(5)
    v_mfma_f32_32x32x16_bf16 v[128:143], v[176:179], v[40:43], v[128:143]
    ds_read_b128 v[176:179], v1 offset:44032
    s_add_u32 s34, s38, 57344
    s_add_u32 m0, s39, 71680
    s_nop 0
    buffer_load_dwordx4 v0, s[4:7], s34 offen offset:0 sc1 lds
    buffer_store_dwordx4 v[224:227], v0, s[96:99], 0 offen offset:0 sc1
    s_waitcnt lgkmcnt(5)
    v_mfma_f32_32x32x16_bf16 v[144:159], v[40:43], v[180:183], v[144:159]
    ds_read_b128 v[180:183], v2 offset:7168
    s_add_u32 s34, s38, 58368
    s_add_u32 m0, s39, 72704
    s_nop 0
    buffer_load_dwordx4 v0, s[4:7], s34 offen offset:0 sc1 lds
    s_waitcnt lgkmcnt(5)
    v_mfma_f32_32x32x16_bf16 v[128:143], v[184:187], v[44:47], v[128:143]
    ds_read_b128 v[184:187], v1 offset:45056
    s_add_u32 s34, s38, 59392
    s_add_u32 m0, s39, 73728
    s_nop 0
    buffer_load_dwordx4 v0, s[4:7], s34 offen offset:0 sc1 lds
    buffer_store_dwordx4 v[228:231], v0, s[96:99], 0 offen offset:1024 sc1
    s_waitcnt lgkmcnt(5)
    v_mfma_f32_32x32x16_bf16 v[144:159], v[44:47], v[188:191], v[144:159]
    ds_read_b128 v[188:191], v2 offset:8192
    s_add_u32 s34, s38, 60416
    s_add_u32 m0, s39, 74752
    s_nop 0
    buffer_load_dwordx4 v0, s[4:7], s34 offen offset:0 sc1 lds
    s_waitcnt lgkmcnt(5)
    v_mfma_f32_32x32x16_bf16 v[128:143], v[192:195], v[48:51], v[128:143]
    ds_read_b128 v[192:195], v1 offset:46080
    s_add_u32 s34, s38, 61440
    s_add_u32 m0, s39, 75776
    s_nop 0
    buffer_load_dwordx4 v0, s[4:7], s34 offen offset:0 sc1 lds
    buffer_store_dwordx4 v[232:235], v0, s[96:99], 0 offen offset:2048 sc1
    s_waitcnt lgkmcnt(5)
    v_mfma_f32_32x32x16_bf16 v[144:159], v[48:51], v[196:199], v[144:159]
    ds_read_b128 v[196:199], v2 offset:9216
    s_add_u32 s34, s38, 62464
    s_add_u32 m0, s39, 76800
    s_nop 0
    buffer_load_dwordx4 v0, s[4:7], s34 offen offset:0 sc1 lds
    s_waitcnt lgkmcnt(5)
    v_mfma_f32_32x32x16_bf16 v[128:143], v[176:179], v[52:55], v[128:143]
    ds_read_b128 v[176:179], v1 offset:47104
    s_add_u32 s34, s38, 63488
    s_add_u32 m0, s39, 77824
    s_nop 0
    buffer_load_dwordx4 v0, s[4:7], s34 offen offset:0 sc1 lds
    buffer_store_dwordx4 v[236:239], v0, s[96:99], 0 offen offset:3072 sc1
    s_waitcnt lgkmcnt(5)
    v_mfma_f32_32x32x16_bf16 v[144:159], v[52:55], v[180:183], v[144:159]
    ds_read_b128 v[180:183], v2 offset:10240
    s_waitcnt lgkmcnt(5)
    v_mfma_f32_32x32x16_bf16 v[128:143], v[184:187], v[56:59], v[128:143]
    ds_read_b128 v[184:187], v1 offset:48128
    buffer_store_dwordx4 v[240:243], v175, s[96:99], 0 offen offset:0 sc1
    s_waitcnt lgkmcnt(5)
    v_mfma_f32_32x32x16_bf16 v[144:159], v[56:59], v[188:191], v[144:159]
    ds_read_b128 v[188:191], v2 offset:11264
    s_waitcnt vmcnt(35)
    s_barrier
    s_waitcnt lgkmcnt(5)
    v_mfma_f32_32x32x16_bf16 v[128:143], v[192:195], v[60:63], v[128:143]
    ds_read_b128 v[192:195], v1 offset:49152
    buffer_store_dwordx4 v[244:247], v175, s[96:99], 0 offen offset:1024 sc1
    s_waitcnt lgkmcnt(5)
    v_mfma_f32_32x32x16_bf16 v[144:159], v[60:63], v[196:199], v[144:159]
    ds_read_b128 v[196:199], v2 offset:12288
    s_waitcnt lgkmcnt(5)
    v_mfma_f32_32x32x16_bf16 v[128:143], v[176:179], v[64:67], v[128:143]
    ds_read_b128 v[176:179], v1 offset:50176
    buffer_store_dwordx4 v[248:251], v175, s[96:99], 0 offen offset:2048 sc1
    s_waitcnt lgkmcnt(5)
    v_mfma_f32_32x32x16_bf16 v[144:159], v[64:67], v[180:183], v[144:159]
    ds_read_b128 v[180:183], v2 offset:13312
    s_waitcnt lgkmcnt(5)
    v_mfma_f32_32x32x16_bf16 v[128:143], v[184:187], v[68:71], v[128:143]
    ds_read_b128 v[184:187], v1 offset:51200
    buffer_store_dwordx4 v[252:255], v175, s[96:99], 0 offen offset:3072 sc1
    s_waitcnt vmcnt(22)
    v_add_f32 v200, v200, v208
    s_waitcnt vmcnt(21)
    v_add_f32 v201, v201, v209
    s_waitcnt lgkmcnt(5)
    v_mfma_f32_32x32x16_bf16 v[144:159], v[68:71], v[188:191], v[144:159]
    ds_read_b128 v[188:191], v2 offset:14336
    s_waitcnt vmcnt(20)
    v_add_f32 v202, v202, v210
    s_waitcnt vmcnt(19)
    v_add_f32 v203, v203, v211
    s_waitcnt vmcnt(18)
    v_add_f32 v204, v204, v216
    s_waitcnt vmcnt(17)
    v_add_f32 v205, v205, v217
    s_waitcnt lgkmcnt(5)
    v_mfma_f32_32x32x16_bf16 v[128:143], v[192:195], v[72:75], v[128:143]
    ds_read_b128 v[192:195], v1 offset:52224
    buffer_store_dword v5, v174, s[4:7], s47 offen sc1
    v_bfe_u32 v221, v7, 3, 5
    v_cmp_eq_u32 vcc, 28, v221
    s_nop 1
    v_cndmask_b32 v5, 0, 1.0, vcc
    s_waitcnt vmcnt(17)
    v_add_f32 v206, v206, v218
    s_waitcnt lgkmcnt(5)
    v_mfma_f32_32x32x16_bf16 v[144:159], v[72:75], v[196:199], v[144:159]
    ds_read_b128 v[196:199], v2 offset:15360
    s_waitcnt vmcnt(16)
    v_add_f32 v207, v207, v219
    v_add_f32 v200, v200, v204
    v_add_f32 v201, v201, v205
    v_add_f32 v202, v202, v206
    s_waitcnt lgkmcnt(5)
    v_mfma_f32_32x32x16_bf16 v[128:143], v[176:179], v[76:79], v[128:143]
    ds_read_b128 v[176:179], v1 offset:53248
    v_add_f32 v203, v203, v207
    v_add_f32 v200, v200, v202
    v_add_f32 v201, v201, v203
    v_add_f32 v200, v200, v201
    s_waitcnt lgkmcnt(5)
    v_mfma_f32_32x32x16_bf16 v[144:159], v[76:79], v[180:183], v[144:159]
    ds_read_b128 v[180:183], v2 offset:16384
    v_mov_b32 v201, v200
    s_lshl_b32 s36, s36, 9
    v_add_u32 v208, s36, v4
    v_permlane32_swap_b32 v200, v201
    s_waitcnt lgkmcnt(5)
    v_mfma_f32_32x32x16_bf16 v[128:143], v[184:187], v[80:83], v[128:143]
    ds_read_b128 v[184:187], v1 offset:54272
    v_add_f32 v200, v200, v201
    v_cvt_pk_bf16_f32 v204, v200, v200
    v_and_b32 v201, 0xffff0000, v204
    v_sub_f32 v201, v200, v201
    s_waitcnt lgkmcnt(5)
    v_mfma_f32_32x32x16_bf16 v[144:159], v[80:83], v[188:191], v[144:159]
    ds_read_b128 v[188:191], v2 offset:17408
    v_cvt_pk_bf16_f32 v205, v201, v200
    v_lshlrev_b32 v202, 16, v205
    v_sub_f32 v202, v201, v202
    v_cvt_pk_bf16_f32 v206, v202, v201
    s_waitcnt lgkmcnt(5)
    v_mfma_f32_32x32x16_bf16 v[128:143], v[192:195], v[84:87], v[128:143]
    ds_read_b128 v[192:195], v1 offset:55296
    v_mov_b32 v207, 0
    ds_write_b128 v208, v[204:207]
    v_add_f32 v160, v160, v162
    v_add_f32 v161, v161, v163
    s_waitcnt lgkmcnt(6)
    v_mfma_f32_32x32x16_bf16 v[144:159], v[84:87], v[196:199], v[144:159]
    ds_read_b128 v[196:199], v2 offset:18432
    v_add_f32 v164, v164, v166
    v_add_f32 v165, v165, v167
    v_add_f32 v168, v168, v170
    v_add_f32 v169, v169, v171
    s_waitcnt lgkmcnt(6)
    v_mfma_f32_32x32x16_bf16 v[128:143], v[176:179], v[88:91], v[128:143]
    ds_read_b128 v[176:179], v1 offset:56320
    v_add_f32 v160, v160, v164
    v_add_f32 v161, v161, v165
    v_add_f32 v168, v168, v172
    v_add_f32 v169, v169, v173
    s_waitcnt lgkmcnt(6)
    v_mfma_f32_32x32x16_bf16 v[144:159], v[88:91], v[180:183], v[144:159]
    ds_read_b128 v[180:183], v2 offset:19456
    v_add_f32 v160, v160, v168
    v_add_f32 v161, v161, v169
    v_mov_b32 v162, v160
    v_mov_b32 v163, v161
    s_waitcnt lgkmcnt(6)
    v_mfma_f32_32x32x16_bf16 v[128:143], v[184:187], v[92:95], v[128:143]
    ds_read_b128 v[184:187], v1 offset:57344
    v_permlane32_swap_b32 v160, v162
    v_permlane32_swap_b32 v161, v163
    v_add_f32 v160, v160, v162
    v_add_f32 v161, v161, v163
    s_waitcnt lgkmcnt(6)
    v_mfma_f32_32x32x16_bf16 v[144:159], v[92:95], v[188:191], v[144:159]
    ds_read_b128 v[188:191], v2 offset:20480
    v_mul_f32 v216, s52, v160
    v_mul_f32 v219, s52, v161
    v_fma_f32 v219, -v216, v216, v219
    v_max_f32 v219, 0, v219
    s_waitcnt lgkmcnt(6)
    v_mfma_f32_32x32x16_bf16 v[128:143], v[192:195], v[96:99], v[128:143]
    ds_read_b128 v[192:195], v1 offset:58368
    v_add_f32 v219, s53, v219
    v_rsq_f32 v217, v219
    v_cndmask_b32 v160, -v216, 0, s[40:41]
    s_waitcnt lgkmcnt(5)
    v_mfma_f32_32x32x16_bf16 v[144:159], v[96:99], v[196:199], v[144:159]
    ds_read_b128 v[196:199], v2 offset:21504
    v_cvt_pk_bf16_f32 v161, v160, v160
    v_and_b32 v161, 0xffff0000, v161
    v_sub_f32 v161, v160, v161
    v_cvt_pk_bf16_f32 v212, v160, v161
    s_waitcnt lgkmcnt(5)
    v_mfma_f32_32x32x16_bf16 v[128:143], v[176:179], v[100:103], v[128:143]
    ds_read_b128 v[176:179], v1 offset:59392
    v_and_b32 v162, 0xffff0000, v212
    v_sub_f32 v162, v161, v162
    v_cvt_pk_bf16_f32 v213, v160, v162
    v_mov_b32 v214, v212
    s_waitcnt lgkmcnt(5)
    v_mfma_f32_32x32x16_bf16 v[144:159], v[100:103], v[180:183], v[144:159]
    ds_read_b128 v[180:183], v2 offset:22528
    v_mov_b32 v215, 0
    ds_write_b32 v3, v217
    ds_read_b128 v[200:203], v6 offset:0
    ds_read_b128 v[204:207], v6 offset:32
    s_waitcnt lgkmcnt(8)
    v_mfma_f32_32x32x16_bf16 v[128:143], v[184:187], v[104:107], v[128:143]
    ds_read_b128 v[184:187], v1 offset:60416
    ds_read_b128 v[208:211], v6 offset:64
    v_mul_f32 v219, s54, v217
    s_waitcnt lgkmcnt(9)
    v_mfma_f32_32x32x16_bf16 v[144:159], v[104:107], v[188:191], v[144:159]
    ds_read_b128 v[188:191], v2 offset:23552
    s_waitcnt lgkmcnt(9)
    v_mfma_f32_32x32x16_bf16 v[128:143], v[192:195], v[108:111], v[128:143]
    ds_read_b128 v[192:195], v1 offset:61440
    s_waitcnt lgkmcnt(9)
    v_mfma_f32_32x32x16_bf16 v[144:159], v[108:111], v[196:199], v[144:159]
    ds_read_b128 v[196:199], v2 offset:24576
    s_waitcnt lgkmcnt(9)
    v_mfma_f32_32x32x16_bf16 v[128:143], v[176:179], v[112:115], v[128:143]
    ds_read_b128 v[176:179], v1 offset:62464
    s_waitcnt lgkmcnt(9)
    v_mfma_f32_32x32x16_bf16 v[144:159], v[112:115], v[180:183], v[144:159]
    ds_read_b128 v[180:183], v2 offset:25600
    s_waitcnt vmcnt(0)
    s_waitcnt lgkmcnt(0)
    s_barrier
    v_mov_b32 v222, v220
    s_cmp_eq_u32 s14, 3
    s_cbranch_scc0 Loth_16
    s_add_u32 s34, s3, 36864
    v_mov_b32 v220, s100
    v_mov_b32 v221, s101
    s_mov_b64 exec, 1
    buffer_store_dwordx2 v[220:221], v0, s[4:7], s34 offen sc1
    s_mov_b64 exec, -1
Loth_16:
    v_mov_b32 v220, v222
    v_mfma_f32_32x32x16_bf16 v[128:143], v[184:187], v[116:119], v[128:143]
    ds_read_b128 v[184:187], v4 offset:0
    v_mfma_f32_32x32x16_bf16 v[144:159], v[116:119], v[188:191], v[144:159]
    ds_read_b128 v[188:191], v4 offset:512
    v_mfma_f32_32x32x16_bf16 v[128:143], v[192:195], v[120:123], v[128:143]
    ds_read_b128 v[192:195], v1 offset:6144
    v_mfma_f32_32x32x16_bf16 v[144:159], v[120:123], v[196:199], v[144:159]
    ds_read_b128 v[196:199], v1 offset:7168
    v_mfma_f32_32x32x16_bf16 v[128:143], v[176:179], v[124:127], v[128:143]
    ds_read_b128 v[176:179], v1 offset:8192
    v_mfma_f32_32x32x16_bf16 v[144:159], v[124:127], v[180:183], v[144:159]
    ds_read_b128 v[180:183], v1 offset:9216
    s_waitcnt lgkmcnt(5)
    v_mfma_f32_32x32x16_bf16 v[128:143], v[184:187], v[212:215], v[128:143]
    ds_read_b128 v[184:187], v1 offset:10240
    s_waitcnt lgkmcnt(5)
    v_mfma_f32_32x32x16_bf16 v[144:159], v[212:215], v[188:191], v[144:159]
    ds_read_b128 v[188:191], v1 offset:11264
    s_waitcnt lgkmcnt(5)
    v_mfma_f32_32x32x16_bf16 v[160:175], v[192:195], v[16:19], 0
    ds_read_b128 v[192:195], v1 offset:12288
    s_nop 4
    v_mul_f32 v128, v217, v128
    v_mul_f32 v129, v217, v129
    v_mul_f32 v130, v217, v130
    v_mul_f32 v131, v217, v131
    v_mul_f32 v132, v217, v132
    v_mul_f32 v133, v217, v133
    v_mul_f32 v134, v217, v134
    v_mul_f32 v135, v217, v135
    s_waitcnt lgkmcnt(5)
    v_mfma_f32_32x32x16_bf16 v[160:175], v[196:199], v[20:23], v[160:175]
    ds_read_b128 v[196:199], v1 offset:13312
    v_mul_f32 v136, v217, v136
    v_mul_f32 v137, v217, v137
    v_mul_f32 v138, v217, v138
    v_mul_f32 v139, v217, v139
    v_mul_f32 v140, v217, v140
    v_mul_f32 v141, v217, v141
    v_mul_f32 v142, v217, v142
    v_mul_f32 v143, v217, v143
    s_waitcnt lgkmcnt(5)
    v_mfma_f32_32x32x16_bf16 v[160:175], v[176:179], v[24:27], v[160:175]
    ds_read_b128 v[176:179], v1 offset:14336
    v_cvt_pk_bf16_f32 v128, v128, v129
    v_cvt_pk_bf16_f32 v129, v130, v131
    v_cvt_pk_bf16_f32 v130, v132, v133
    v_cvt_pk_bf16_f32 v131, v134, v135
    v_cvt_pk_bf16_f32 v132, v136, v137
    v_cvt_pk_bf16_f32 v133, v138, v139
    v_cvt_pk_bf16_f32 v134, v140, v141
    v_cvt_pk_bf16_f32 v135, v142, v143
    s_waitcnt lgkmcnt(5)
    v_mfma_f32_32x32x16_bf16 v[160:175], v[180:183], v[28:31], v[160:175]
    ds_read_b128 v[180:183], v1 offset:15360
    ds_read_b128 v[136:139], v6 offset:96
    buffer_store_dwordx4 v[128:131], v0, s[4:7], s19 offen sc1
    buffer_store_dwordx4 v[132:135], v0, s[4:7], s19 offen offset:1024 sc1
    v_fma_f32 v144, v144, v200, v5
    v_fma_f32 v145, v145, v201, v5
    v_fma_f32 v146, v146, v202, v5
    v_fma_f32 v147, v147, v203, v5
    v_fma_f32 v148, v148, v204, v5
    s_waitcnt lgkmcnt(6)
    v_mfma_f32_32x32x16_bf16 v[160:175], v[184:187], v[32:35], v[160:175]
    ds_read_b128 v[184:187], v1 offset:16384
    v_fma_f32 v149, v149, v205, v5
    v_fma_f32 v150, v150, v206, v5
    v_fma_f32 v151, v151, v207, v5
    v_fma_f32 v152, v152, v208, v5
    v_fma_f32 v153, v153, v209, v5
    v_fma_f32 v154, v154, v210, v5
    v_fma_f32 v155, v155, v211, v5
    s_waitcnt lgkmcnt(1)
    v_fma_f32 v156, v156, v136, v5
    v_mfma_f32_32x32x16_bf16 v[160:175], v[188:191], v[36:39], v[160:175]
    ds_read_b128 v[188:191], v1 offset:17408
    v_fma_f32 v157, v157, v137, v5
    v_fma_f32 v158, v158, v138, v5
    v_fma_f32 v159, v159, v139, v5
    v_cvt_pk_bf16_f32 v144, v144, v145
    v_cvt_pk_bf16_f32 v145, v146, v147
    v_cvt_pk_bf16_f32 v146, v148, v149
    v_cvt_pk_bf16_f32 v147, v150, v151
    v_cvt_pk_bf16_f32 v148, v152, v153
    v_mfma_f32_32x32x16_bf16 v[160:175], v[192:195], v[40:43], v[160:175]
    ds_read_b128 v[192:195], v1 offset:18432
    v_cvt_pk_bf16_f32 v149, v154, v155
    v_cvt_pk_bf16_f32 v150, v156, v157
    v_cvt_pk_bf16_f32 v151, v158, v159
    buffer_store_dwordx4 v[144:147], v0, s[4:7], s19 offen offset:2048 sc1
    buffer_store_dwordx4 v[148:151], v0, s[4:7], s19 offen offset:3072 sc1
    ds_write_b128 v220, v[128:131] offset:32768
    v_mfma_f32_32x32x16_bf16 v[160:175], v[196:199], v[44:47], v[160:175]
    ds_read_b128 v[196:199], v1 offset:19456
    ds_write_b128 v220, v[132:135] offset:33792
    ds_write_b128 v220, v[144:147] offset:34816
    ds_write_b128 v220, v[148:151] offset:35840
    v_mov_b32 v216, 0xffff
    v_mfma_f32_32x32x16_bf16 v[160:175], v[176:179], v[48:51], v[160:175]
    ds_read_b128 v[176:179], v1 offset:20480
    v_mov_b32 v218, 0xffff0000
    v_cndmask_b32 v152, 0, v216, s[64:65]
    v_cndmask_b32 v221, 0, v218, s[66:67]
    v_or_b32 v152, v152, v221
    v_mfma_f32_32x32x16_bf16 v[160:175], v[180:183], v[52:55], v[160:175]
    ds_read_b128 v[180:183], v1 offset:21504
    v_cndmask_b32 v153, 0, v216, s[68:69]
    v_cndmask_b32 v221, 0, v218, s[70:71]
    v_or_b32 v153, v153, v221
    v_cndmask_b32 v154, 0, v216, s[72:73]
    s_waitcnt lgkmcnt(9)
    v_mfma_f32_32x32x16_bf16 v[160:175], v[184:187], v[56:59], v[160:175]
    ds_read_b128 v[184:187], v1 offset:22528
    v_cndmask_b32 v221, 0, v218, s[74:75]
    v_or_b32 v154, v154, v221
    v_cndmask_b32 v155, 0, v216, s[76:77]
    v_cndmask_b32 v221, 0, v218, s[78:79]
    s_waitcnt lgkmcnt(9)
    v_mfma_f32_32x32x16_bf16 v[160:175], v[188:191], v[60:63], v[160:175]
    ds_read_b128 v[188:191], v1 offset:23552
    v_or_b32 v155, v155, v221
    v_cndmask_b32 v156, 0, v216, s[80:81]
    v_cndmask_b32 v221, 0, v218, s[82:83]
    v_or_b32 v156, v156, v221
    s_waitcnt lgkmcnt(9)
    v_mfma_f32_32x32x16_bf16 v[160:175], v[192:195], v[64:67], v[160:175]
    ds_read_b128 v[192:195], v1 offset:24576
    v_cndmask_b32 v157, 0, v216, s[84:85]
    v_cndmask_b32 v221, 0, v218, s[86:87]
    v_or_b32 v157, v157, v221
    v_cndmask_b32 v158, 0, v216, s[88:89]
    s_waitcnt lgkmcnt(8)
    v_mfma_f32_32x32x16_bf16 v[160:175], v[196:199], v[68:71], v[160:175]
    ds_read_b128 v[196:199], v1 offset:25600
    v_cndmask_b32 v221, 0, v218, s[90:91]
    v_or_b32 v158, v158, v221
    v_cndmask_b32 v159, 0, v216, s[92:93]
    v_cndmask_b32 v221, 0, v218, s[94:95]
    s_waitcnt lgkmcnt(5)
    v_mfma_f32_32x32x16_bf16 v[160:175], v[176:179], v[72:75], v[160:175]
    ds_read_b128 v[176:179], v1 offset:26624
    v_or_b32 v159, v159, v221
    s_waitcnt lgkmcnt(5)
    v_mfma_f32_32x32x16_bf16 v[160:175], v[180:183], v[76:79], v[160:175]
    ds_read_b128 v[180:183], v1 offset:27648
    s_waitcnt lgkmcnt(5)
    v_mfma_f32_32x32x16_bf16 v[160:175], v[184:187], v[80:83], v[160:175]
    ds_read_b128 v[184:187], v1 offset:28672
    s_waitcnt lgkmcnt(5)
    v_mfma_f32_32x32x16_bf16 v[160:175], v[188:191], v[84:87], v[160:175]
    ds_read_b128 v[188:191], v1 offset:29696
    s_waitcnt lgkmcnt(5)
    v_mfma_f32_32x32x16_bf16 v[160:175], v[192:195], v[88:91], v[160:175]
    ds_read_b128 v[192:195], v1 offset:30720
    s_waitcnt lgkmcnt(5)
    v_mfma_f32_32x32x16_bf16 v[160:175], v[196:199], v[92:95], v[160:175]
    ds_read_b128 v[196:199], v1 offset:31744
    s_waitcnt lgkmcnt(5)
    v_mfma_f32_32x32x16_bf16 v[160:175], v[176:179], v[96:99], v[160:175]
    ds_read_b128 v[176:179], v1 offset:32768
    s_waitcnt lgkmcnt(5)
    v_mfma_f32_32x32x16_bf16 v[160:175], v[180:183], v[100:103], v[160:175]
    ds_read_b128 v[180:183], v1 offset:33792
    s_waitcnt lgkmcnt(5)
    v_mfma_f32_32x32x16_bf16 v[160:175], v[184:187], v[104:107], v[160:175]
    ds_read_b128 v[184:187], v4 offset:1024
    s_waitcnt lgkmcnt(5)
    v_mfma_f32_32x32x16_bf16 v[160:175], v[188:191], v[108:111], v[160:175]
    s_waitcnt lgkmcnt(4)
    v_mfma_f32_32x32x16_bf16 v[160:175], v[192:195], v[112:115], v[160:175]
    s_waitcnt lgkmcnt(3)
    v_mfma_f32_32x32x16_bf16 v[160:175], v[196:199], v[116:119], v[160:175]
    s_waitcnt lgkmcnt(2)
    v_mfma_f32_32x32x16_bf16 v[160:175], v[176:179], v[120:123], v[160:175]
    s_waitcnt lgkmcnt(1)
    v_mfma_f32_32x32x16_bf16 v[160:175], v[180:183], v[124:127], v[160:175]
    s_waitcnt lgkmcnt(0)
    v_mfma_f32_32x32x16_bf16 v[160:175], v[184:187], v[212:215], v[160:175]
    v_mov_b32 v176, v220
    s_waitcnt vmcnt(0)
    s_waitcnt lgkmcnt(0)
    s_barrier
    s_cmp_eq_u32 s14, 0
    s_cbranch_scc0 Loth_18
    s_add_u32 s34, s62, 0
    v_mov_b32 v220, s100
    v_mov_b32 v221, s101
    s_mov_b64 exec, 1
    buffer_store_dwordx2 v[220:221], v0, s[4:7], s34 offen sc1
    s_mov_b64 exec, -1
Loth_18:
    s_nop 5
    v_mul_f32 v160, v219, v160
    v_mul_f32 v161, v219, v161
    v_mul_f32 v162, v219, v162
    v_mul_f32 v163, v219, v163
    v_mul_f32 v164, v219, v164
    v_mul_f32 v165, v219, v165
    v_mul_f32 v166, v219, v166
    v_mul_f32 v167, v219, v167
    v_mul_f32 v168, v219, v168
    v_mul_f32 v169, v219, v169
    v_mul_f32 v170, v219, v170
    v_mul_f32 v171, v219, v171
    v_mul_f32 v172, v219, v172
    v_mul_f32 v173, v219, v173
    v_mul_f32 v174, v219, v174
    v_mul_f32 v175, v219, v175
    v_mov_b32 v221, s56
    v_cndmask_b32 v172, v172, v221, s[40:41]
    v_cvt_pk_bf16_f32 v160, v160, v161
    v_cvt_pk_bf16_f32 v161, v162, v163
    v_cvt_pk_bf16_f32 v162, v164, v165
    v_cvt_pk_bf16_f32 v163, v166, v167
    v_cvt_pk_bf16_f32 v164, v168, v169
    v_cvt_pk_bf16_f32 v165, v170, v171
    v_cvt_pk_bf16_f32 v166, v172, v173
    v_cvt_pk_bf16_f32 v167, v174, v175
    v_mov_b32 v168, v176
    s_add_u32 s34, s29, 32768
    s_mov_b64 exec, 0xffff
Lxcc_20:
    buffer_load_dwordx2 v[220:221], v7, s[4:7], s34 offen sc1
    s_waitcnt vmcnt(0)
    v_subrev_u32 v218, s101, v221
    v_cmp_eq_u32 s[36:37], s100, v220
    v_cmp_gt_u32 vcc, 16, v218
    s_sub_u32 s33, s33, 1
    s_cmp_eq_u32 s33, 0
    s_cbranch_scc1 main_done
    s_and_b32 s36, s36, vcc_lo
    s_cmp_eq_u32 s36, 0xffff
    s_cbranch_scc0 Lxcc_20
    v_cmp_eq_u32 vcc, s63, v218
    s_mov_b64 exec, -1
    s_mov_b32 s96, s4
    s_mov_b32 s97, s5
    s_mov_b32 s99, 0x20000
    s_mov_b32 s0, s4
    s_mov_b32 s1, s5
    s_mov_b32 s3, 0x20000
    s_cmp_eq_u32 vcc_lo, 0xffff
    s_cselect_b32 s98, 0x10000000, 0
    s_cselect_b32 s2, 0, 0x10000000
    s_cselect_b32 s63, 0, 16777216
    s_cmp_lt_u32 s14, 2
    s_cbranch_scc0 Loth_21
    s_lshl_b32 s37, s14, 14
    s_sub_u32 s37, 16384, s37
    s_cmp_le_u32 s12, s14
    s_cbranch_scc1 Lfill_23
    s_add_u32 s34, s31, 0
    s_mov_b32 exec_lo, 1
    s_mov_b32 exec_hi, 0
Lpoll_25:
    buffer_load_dwordx2 v[220:221], v7, s[4:7], s34 offen sc1
    s_waitcnt vmcnt(0)
    s_waitcnt vmcnt(0)
    v_cmp_eq_u64 vcc, s[100:101], v[220:221]
    s_sub_u32 s33, s33, 1
    s_cmp_eq_u32 s33, 0
    s_cbranch_scc1 main_done
    s_cmp_eq_u64 vcc, exec
    s_cbranch_scc0 Lpoll_25
    s_mov_b64 exec, -1
    s_add_u32 s34, s20, 0
    s_add_u32 m0, s37, 0
    s_nop 0
    buffer_load_dwordx4 v0, s[4:7], s34 offen offset:0 sc1 lds
    buffer_load_dwordx4 v0, s[4:7], s34 offen offset:1024 sc1 lds
    s_add_u32 s34, s20, 4096
    s_add_u32 m0, s37, 4096
    s_nop 0
    buffer_load_dwordx4 v0, s[4:7], s34 offen offset:0 sc1 lds
    buffer_load_dwordx4 v0, s[4:7], s34 offen offset:1024 sc1 lds
    s_add_u32 s34, s20, 8192
    s_add_u32 m0, s37, 8192
    s_nop 0
    buffer_load_dwordx4 v0, s[4:7], s34 offen offset:0 sc1 lds
    buffer_load_dwordx4 v0, s[4:7], s34 offen offset:1024 sc1 lds
    s_add_u32 s34, s20, 12288
    s_add_u32 m0, s37, 12288
    s_nop 0
    buffer_load_dwordx4 v0, s[4:7], s34 offen offset:0 sc1 lds
    buffer_load_dwordx4 v0, s[4:7], s34 offen offset:1024 sc1 lds
    s_add_u32 s34, s20, 2048
    s_add_u32 m0, s37, 2048
    s_nop 0
    buffer_load_dwordx4 v0, s[4:7], s34 offen offset:0 sc1 lds
    buffer_load_dwordx4 v0, s[4:7], s34 offen offset:1024 sc1 lds
    s_add_u32 s34, s20, 6144
    s_add_u32 m0, s37, 6144
    s_nop 0
    buffer_load_dwordx4 v0, s[4:7], s34 offen offset:0 sc1 lds
    buffer_load_dwordx4 v0, s[4:7], s34 offen offset:1024 sc1 lds
    s_add_u32 s34, s20, 10240
    s_add_u32 m0, s37, 10240
    s_nop 0
    buffer_load_dwordx4 v0, s[4:7], s34 offen offset:0 sc1 lds
    buffer_load_dwordx4 v0, s[4:7], s34 offen offset:1024 sc1 lds
    s_add_u32 s34, s20, 14336
    s_add_u32 m0, s37, 14336
    s_nop 0
    buffer_load_dwordx4 v0, s[4:7], s34 offen offset:0 sc1 lds
    buffer_load_dwordx4 v0, s[4:7], s34 offen offset:1024 sc1 lds
    s_waitcnt vmcnt(8)
    s_branch Lhalo_24
Lfill_23:
    v_add_u32 v220, s37, v0
    v_mov_b32 v88, 0
    v_mov_b32 v89, 0
    v_mov_b32 v90, 0
    v_mov_b32 v91, 0
    v_mov_b32 v92, 0
    v_mov_b32 v93, 0
    v_mov_b32 v94, 0
    v_mov_b32 v95, 0
    v_mov_b32 v221, 0x3f80
    v_cndmask_b32 v94, 0, v221, s[40:41]
    ds_write_b128 v220, v[88:91] offset:0
    ds_write_b128 v220, v[92:95] offset:1024
    ds_write_b128 v220, v[88:91] offset:2048
    ds_write_b128 v220, v[88:91] offset:3072
    ds_write_b128 v220, v[88:91] offset:4096
    ds_write_b128 v220, v[92:95] offset:5120
    ds_write_b128 v220, v[88:91] offset:6144
    ds_write_b128 v220, v[88:91] offset:7168
    ds_write_b128 v220, v[88:91] offset:8192
    ds_write_b128 v220, v[92:95] offset:9216
    ds_write_b128 v220, v[88:91] offset:10240
    ds_write_b128 v220, v[88:91] offset:11264
    ds_write_b128 v220, v[88:91] offset:12288
    ds_write_b128 v220, v[92:95] offset:13312
    ds_write_b128 v220, v[88:91] offset:14336
    ds_write_b128 v220, v[88:91] offset:15360
    s_waitcnt lgkmcnt(0)
Lhalo_24:
    s_branch Ljoin_22
Loth_21:
    s_mul_i32 s35, s13, 7
    s_add_u32 s36, s35, 6
    s_lshr_b32 s35, s35, 2
    s_lshr_b32 s36, s36, 2
    s_sub_u32 s36, s36, s35
    s_cmp_eq_u32 s36, 2
    s_cselect_b32 s47, 0xf00, 0
    s_or_b32 s47, s47, 0x00ff00ff
    s_lshl_b32 s35, s35, 5
    s_lshl_b32 s36, s46, 5
    s_add_u32 s36, s36, 896
    s_lshl_b32 s37, s46, 3
    s_add_u32 s37, s37, 1344
    v_bfe_u32 v218, v7, 7, 2
    v_mov_b32 v220, s35
    v_mov_b32 v221, s36
    v_mov_b32 v219, s37
    v_cmp_eq_u32 vcc, 1, v218
    s_nop 1
    v_cndmask_b32 v220, v220, v221, vcc
    v_cmp_eq_u32 vcc, 2, v218
    s_nop 1
    v_cndmask_b32 v220, v220, v219, vcc
    v_and_b32 v218, 0x78, v7
    v_add_u32 v218, v218, v220
    s_mov_b32 s35, 0
    s_add_u32 s34, s35, 36864
    s_mov_b32 exec_lo, s47
    s_mov_b32 exec_hi, 3
Lpoll_26:
    buffer_load_dwordx2 v[220:221], v218, s[4:7], s34 offen sc1
    s_waitcnt vmcnt(0)
    s_waitcnt vmcnt(0)
    v_cmp_eq_u64 vcc, s[100:101], v[220:221]
    s_sub_u32 s33, s33, 1
    s_cmp_eq_u32 s33, 0
    s_cbranch_scc1 main_done
    s_cmp_eq_u64 vcc, exec
    s_cbranch_scc0 Lpoll_26
    s_mov_b64 exec, -1
    s_sub_u32 s37, s14, 2
    s_mul_i32 s37, s37, 3
    s_mul_i32 s38, s13, 7
    s_add_u32 s38, s38, s37
    s_lshl_b32 s38, s38, 10
    s_add_u32 s38, s38, 7602176
    v_lshrrev_b32 v218, 1, v7
    buffer_load_dword v88, v218, s[4:7], s38 offen offset:0 sc1
    buffer_load_dword v89, v218, s[4:7], s38 offen offset:256 sc1
    buffer_load_dword v90, v218, s[4:7], s38 offen offset:512 sc1
    buffer_load_dword v91, v218, s[4:7], s38 offen offset:768 sc1
    buffer_load_dword v92, v218, s[4:7], s38 offen offset:1024 sc1
    buffer_load_dword v93, v218, s[4:7], s38 offen offset:1280 sc1
    buffer_load_dword v94, v218, s[4:7], s38 offen offset:1536 sc1
    buffer_load_dword v95, v218, s[4:7], s38 offen offset:1792 sc1
    buffer_load_dword v96, v218, s[4:7], s38 offen offset:2048 sc1
    buffer_load_dword v97, v218, s[4:7], s38 offen offset:2304 sc1
    buffer_load_dword v98, v218, s[4:7], s38 offen offset:2560 sc1
    buffer_load_dword v99, v218, s[4:7], s38 offen offset:2816 sc1
    buffer_load_dword v100, v218, s[4:7], s38 offen offset:3072 sc1
    buffer_load_dword v101, v218, s[4:7], s38 offen offset:3328 sc1
    buffer_load_dword v102, v218, s[4:7], s38 offen offset:3584 sc1
    buffer_load_dword v103, v218, s[4:7], s38 offen offset:3840 sc1
    s_lshl_b32 s37, s37, 9
    v_add_u32 v218, s37, v4
    s_sub_u32 s37, s14, 2
    s_mul_i32 s37, s37, 19456
    s_add_u32 s38, s49, s37
    s_add_u32 s34, s38, 0
    s_add_u32 m0, s37, 49152
    s_nop 0
    buffer_load_dwordx4 v0, s[4:7], s34 offen offset:0 sc1 lds
    buffer_load_dwordx4 v0, s[4:7], s34 offen offset:1024 sc1 lds
    buffer_load_dwordx4 v0, s[4:7], s34 offen offset:2048 sc1 lds
    buffer_load_dwordx4 v0, s[4:7], s34 offen offset:3072 sc1 lds
    s_add_u32 s34, s38, 4096
    s_add_u32 m0, s37, 53248
    s_nop 0
    buffer_load_dwordx4 v0, s[4:7], s34 offen offset:0 sc1 lds
    buffer_load_dwordx4 v0, s[4:7], s34 offen offset:1024 sc1 lds
    buffer_load_dwordx4 v0, s[4:7], s34 offen offset:2048 sc1 lds
    buffer_load_dwordx4 v0, s[4:7], s34 offen offset:3072 sc1 lds
    s_add_u32 s34, s38, 8192
    s_add_u32 m0, s37, 57344
    s_nop 0
    buffer_load_dwordx4 v0, s[4:7], s34 offen offset:0 sc1 lds
    buffer_load_dwordx4 v0, s[4:7], s34 offen offset:1024 sc1 lds
    buffer_load_dwordx4 v0, s[4:7], s34 offen offset:2048 sc1 lds
    buffer_load_dwordx4 v0, s[4:7], s34 offen offset:3072 sc1 lds
    s_add_u32 s34, s38, 12288
    s_add_u32 m0, s37, 61440
    s_nop 0
    buffer_load_dwordx4 v0, s[4:7], s34 offen offset:0 sc1 lds
    buffer_load_dwordx4 v0, s[4:7], s34 offen offset:1024 sc1 lds
    buffer_load_dwordx4 v0, s[4:7], s34 offen offset:2048 sc1 lds
    buffer_load_dwordx4 v0, s[4:7], s34 offen offset:3072 sc1 lds
    s_add_u32 s34, s38, 16384
    s_add_u32 m0, s37, 65536
    s_nop 0
    buffer_load_dwordx4 v0, s[4:7], s34 offen offset:0 sc1 lds
    buffer_load_dwordx4 v0, s[4:7], s34 offen offset:1024 sc1 lds
    buffer_load_dwordx4 v0, s[4:7], s34 offen offset:2048 sc1 lds
    s_waitcnt vmcnt(19)
    v_add_f32 v88, v88, v89
    v_add_f32 v90, v90, v91
    v_add_f32 v88, v88, v90
    v_mov_b32 v89, v88
    s_nop 1
    v_permlane32_swap_b32 v88, v89
    v_add_f32 v88, v88, v89
    v_cvt_pk_bf16_f32 v104, v88, v88
    v_and_b32 v89, 0xffff0000, v104
    v_sub_f32 v89, v88, v89
    v_cvt_pk_bf16_f32 v105, v89, v88
    v_lshlrev_b32 v90, 16, v105
    v_sub_f32 v90, v89, v90
    v_cvt_pk_bf16_f32 v106, v90, v89
    v_mov_b32 v107, 0
    ds_write_b128 v218, v[104:107] offset:1536
    v_add_f32 v92, v92, v93
    v_add_f32 v94, v94, v95
    v_add_f32 v92, v92, v94
    v_mov_b32 v93, v92
    s_nop 1
    v_permlane32_swap_b32 v92, v93
    v_add_f32 v92, v92, v93
    v_cvt_pk_bf16_f32 v108, v92, v92
    v_and_b32 v93, 0xffff0000, v108
    v_sub_f32 v93, v92, v93
    v_cvt_pk_bf16_f32 v109, v93, v92
    v_lshlrev_b32 v94, 16, v109
    v_sub_f32 v94, v93, v94
    v_cvt_pk_bf16_f32 v110, v94, v93
    v_mov_b32 v111, 0
    ds_write_b128 v218, v[108:111] offset:2048
    v_add_f32 v96, v96, v97
    v_add_f32 v98, v98, v99
    v_add_f32 v96, v96, v98
    v_mov_b32 v97, v96
    s_nop 1
    v_permlane32_swap_b32 v96, v97
    v_add_f32 v96, v96, v97
    v_cvt_pk_bf16_f32 v112, v96, v96
    v_and_b32 v97, 0xffff0000, v112
    v_sub_f32 v97, v96, v97
    v_cvt_pk_bf16_f32 v113, v97, v96
    v_lshlrev_b32 v98, 16, v113
    v_sub_f32 v98, v97, v98
    v_cvt_pk_bf16_f32 v114, v98, v97
    v_mov_b32 v115, 0
    ds_write_b128 v218, v[112:115] offset:2560
    v_add_f32 v100, v100, v101
    v_add_f32 v102, v102, v103
    v_add_f32 v100, v100, v102
    v_mov_b32 v101, v100
    s_nop 1
    v_permlane32_swap_b32 v100, v101
    v_add_f32 v100, v100, v101
    v_cvt_pk_bf16_f32 v116, v100, v100
    v_and_b32 v101, 0xffff0000, v116
    v_sub_f32 v101, v100, v101
    v_cvt_pk_bf16_f32 v117, v101, v100
    v_lshlrev_b32 v102, 16, v117
    v_sub_f32 v102, v101, v102
    v_cvt_pk_bf16_f32 v118, v102, v101
    v_mov_b32 v119, 0
    ds_write_b128 v218, v[116:119] offset:3072
    s_waitcnt lgkmcnt(0)
Ljoin_22:
    s_mul_i32 s37, s14, 17408
    s_add_u32 s38, s49, s37
    s_barrier
    v_mov_b32 v192, 0
    v_mov_b32 v193, 0
    v_mov_b32 v194, 0
    v_mov_b32 v195, 0
    ds_read_b128 v[16:19], v168 offset:32768
    ds_read_b128 v[20:23], v168 offset:33792
    ds_read_b128 v[24:27], v168 offset:0
    ds_read_b128 v[28:31], v168 offset:1024
    ds_read_b128 v[32:35], v168 offset:4096
    ds_read_b128 v[36:39], v168 offset:5120
    s_waitcnt lgkmcnt(5)
    v_mfma_f32_32x32x16_bf16 v[88:103], v[16:19], v[160:163], 0
    ds_read_b128 v[40:43], v168 offset:8192
    s_add_u32 s35, s21, 0
    buffer_store_dwordx4 v[192:195], v0, s[96:99], s35 offen sc1
    s_waitcnt lgkmcnt(5)
    v_mfma_f32_32x32x16_bf16 v[88:103], v[20:23], v[164:167], v[88:103]
    ds_read_b128 v[44:47], v168 offset:9216
    s_add_u32 s35, s21, 1024
    buffer_store_dwordx4 v[192:195], v0, s[96:99], s35 offen sc1
    s_waitcnt lgkmcnt(5)
    v_mfma_f32_32x32x16_bf16 v[104:119], v[24:27], v[160:163], 0
    ds_read_b128 v[48:51], v168 offset:12288
    s_waitcnt lgkmcnt(5)
    v_mfma_f32_32x32x16_bf16 v[104:119], v[28:31], v[164:167], v[104:119]
    ds_read_b128 v[52:55], v168 offset:13312
    s_add_u32 s35, s26, 114688
    buffer_store_dwordx4 v[192:195], v0, s[96:99], s35 offen sc1
    s_waitcnt lgkmcnt(5)
    v_mfma_f32_32x32x16_bf16 v[120:135], v[32:35], v[160:163], 0
    ds_read_b128 v[56:59], v168 offset:16384
    s_add_u32 s35, s26, 115712
    buffer_store_dwordx4 v[192:195], v0, s[96:99], s35 offen sc1
    s_waitcnt lgkmcnt(5)
    v_mfma_f32_32x32x16_bf16 v[120:135], v[36:39], v[164:167], v[120:135]
    ds_read_b128 v[60:63], v168 offset:17408
    s_nop 0
    v_cndmask_b32 v104, v104, v88, s[64:65]
    v_cndmask_b32 v105, v105, v89, s[66:67]
    v_cndmask_b32 v106, v106, v90, s[68:69]
    v_cndmask_b32 v107, v107, v91, s[70:71]
    v_cndmask_b32 v108, v108, v92, s[72:73]
    v_cndmask_b32 v109, v109, v93, s[74:75]
    v_cndmask_b32 v110, v110, v94, s[76:77]
    v_cndmask_b32 v111, v111, v95, s[78:79]
    v_cndmask_b32 v112, v112, v96, s[80:81]
    v_cndmask_b32 v113, v113, v97, s[82:83]
    v_cndmask_b32 v114, v114, v98, s[84:85]
    v_cndmask_b32 v115, v115, v99, s[86:87]
    v_cndmask_b32 v116, v116, v100, s[88:89]
    v_cndmask_b32 v117, v117, v101, s[90:91]
    v_cndmask_b32 v118, v118, v102, s[92:93]
    v_cndmask_b32 v119, v119, v103, s[94:95]
    s_waitcnt lgkmcnt(5)
    v_mfma_f32_32x32x16_bf16 v[88:103], v[40:43], v[160:163], 0
    ds_read_b128 v[64:67], v168 offset:20480
    s_add_u32 s35, s28, 5120
    buffer_store_dwordx4 v[192:195], v0, s[96:99], s35 offen sc1
    v_max_f32 v216, v104, v105
    v_max3_f32 v216, v216, v106, v107
    s_waitcnt lgkmcnt(5)
    v_mfma_f32_32x32x16_bf16 v[88:103], v[44:47], v[164:167], v[88:103]
    ds_read_b128 v[68:71], v168 offset:21504
    s_add_u32 s35, s28, 6144
    buffer_store_dwordx4 v[192:195], v0, s[96:99], s35 offen sc1
    v_max3_f32 v216, v216, v108, v109
    v_max3_f32 v216, v216, v110, v111
    v_max3_f32 v216, v216, v112, v113
    v_max3_f32 v216, v216, v114, v115
    v_max3_f32 v216, v216, v116, v117
    v_max3_f32 v216, v216, v118, v119
    s_waitcnt lgkmcnt(5)
    v_mfma_f32_32x32x16_bf16 v[104:119], v[48:51], v[160:163], 0
    ds_read_b128 v[72:75], v168 offset:24576
    v_max3_f32 v216, v216, v120, v121
    v_max3_f32 v216, v216, v122, v123
    v_max3_f32 v216, v216, v124, v125
    v_max3_f32 v216, v216, v126, v127
    s_waitcnt lgkmcnt(5)
    v_mfma_f32_32x32x16_bf16 v[104:119], v[52:55], v[164:167], v[104:119]
    ds_read_b128 v[76:79], v168 offset:25600
    s_add_u32 s35, s26, 229376
    buffer_store_dwordx4 v[192:195], v0, s[96:99], s35 offen sc1
    v_max3_f32 v216, v216, v128, v129
    v_max3_f32 v216, v216, v130, v131
    v_max3_f32 v216, v216, v132, v133
    v_max3_f32 v216, v216, v134, v135
    s_waitcnt lgkmcnt(5)
    v_mfma_f32_32x32x16_bf16 v[120:135], v[56:59], v[160:163], 0
    ds_read_b128 v[80:83], v168 offset:28672
    s_add_u32 s35, s26, 230400
    buffer_store_dwordx4 v[192:195], v0, s[96:99], s35 offen sc1
    v_max3_f32 v216, v216, v88, v89
    v_max3_f32 v216, v216, v90, v91
    s_waitcnt lgkmcnt(5)
    v_mfma_f32_32x32x16_bf16 v[120:135], v[60:63], v[164:167], v[120:135]
    ds_read_b128 v[84:87], v168 offset:29696
    v_max3_f32 v216, v216, v92, v93
    v_max3_f32 v216, v216, v94, v95
    v_max3_f32 v216, v216, v96, v97
    v_max3_f32 v216, v216, v98, v99
    v_max3_f32 v216, v216, v100, v101
    v_max3_f32 v216, v216, v102, v103
    s_waitcnt lgkmcnt(5)
    v_mfma_f32_32x32x16_bf16 v[88:103], v[64:67], v[160:163], 0
    v_and_b32 v218, 0xf8, v7
    s_add_u32 s35, s27, 372736
    buffer_store_dwordx2 v[192:193], v218, s[96:99], s35 offen sc1
    v_max3_f32 v216, v216, v104, v105
    v_max3_f32 v216, v216, v106, v107
    v_max3_f32 v216, v216, v108, v109
    s_waitcnt lgkmcnt(4)
    v_mfma_f32_32x32x16_bf16 v[88:103], v[68:71], v[164:167], v[88:103]
    v_and_b32 v218, 0xf8, v7
    s_add_u32 s35, s27, 401408
    buffer_store_dwordx2 v[192:193], v218, s[96:99], s35 offen sc1
    v_max3_f32 v216, v216, v110, v111
    v_max3_f32 v216, v216, v112, v113
    v_max3_f32 v216, v216, v114, v115
    v_max3_f32 v216, v216, v116, v117
    v_max3_f32 v216, v216, v118, v119
    s_waitcnt lgkmcnt(3)
    v_mfma_f32_32x32x16_bf16 v[104:119], v[72:75], v[160:163], 0
    v_max3_f32 v216, v216, v120, v121
    v_max3_f32 v216, v216, v122, v123
    v_max3_f32 v216, v216, v124, v125
    v_max3_f32 v216, v216, v126, v127
    v_max3_f32 v216, v216, v128, v129
    s_waitcnt lgkmcnt(2)
    v_mfma_f32_32x32x16_bf16 v[104:119], v[76:79], v[164:167], v[104:119]
    v_max3_f32 v216, v216, v130, v131
    v_max3_f32 v216, v216, v132, v133
    v_max3_f32 v216, v216, v134, v135
    v_max3_f32 v216, v216, v88, v89
    v_max3_f32 v216, v216, v90, v91
    s_waitcnt lgkmcnt(1)
    v_mfma_f32_32x32x16_bf16 v[120:135], v[80:83], v[160:163], 0
    v_max3_f32 v216, v216, v92, v93
    v_max3_f32 v216, v216, v94, v95
    v_max3_f32 v216, v216, v96, v97
    v_max3_f32 v216, v216, v98, v99
    v_max3_f32 v216, v216, v100, v101
    s_waitcnt lgkmcnt(0)
    v_mfma_f32_32x32x16_bf16 v[120:135], v[84:87], v[164:167], v[120:135]
    v_max3_f32 v216, v216, v102, v103
    v_max3_f32 v216, v216, v104, v105
    v_max3_f32 v216, v216, v106, v107
    v_max3_f32 v216, v216, v108, v109
    v_max3_f32 v216, v216, v110, v111
    v_max3_f32 v216, v216, v112, v113
    v_max3_f32 v216, v216, v114, v115
    v_max3_f32 v216, v216, v116, v117
    v_max3_f32 v216, v216, v118, v119
    s_nop 2
    v_max3_f32 v216, v216, v120, v121
    v_max3_f32 v216, v216, v122, v123
    v_max3_f32 v216, v216, v124, v125
    v_max3_f32 v216, v216, v126, v127
    v_max3_f32 v216, v216, v128, v129
    v_max3_f32 v216, v216, v130, v131
    v_max3_f32 v216, v216, v132, v133
    v_max3_f32 v216, v216, v134, v135
    v_mov_b32 v217, v216
    s_nop 1
    v_permlane32_swap_b32 v216, v217
    v_max_f32 v216, v216, v217
    v_sub_f32 v136, 0, v216
    v_sub_f32 v137, 0, v216
    v_sub_f32 v138, 0, v216
    v_sub_f32 v139, 0, v216
    v_sub_f32 v140, 0, v216
    v_sub_f32 v141, 0, v216
    v_sub_f32 v142, 0, v216
    v_sub_f32 v143, 0, v216
    v_sub_f32 v144, 0, v216
    v_sub_f32 v145, 0, v216
    v_sub_f32 v146, 0, v216
    v_sub_f32 v147, 0, v216
    v_sub_f32 v148, 0, v216
    v_sub_f32 v149, 0, v216
    v_sub_f32 v150, 0, v216
    v_sub_f32 v151, 0, v216
    s_cmp_lt_u32 s14, 2
    s_cbranch_scc0 Loth_27
    s_waitcnt vmcnt(10)
Loth_27:
    s_barrier
    v_mfma_f32_32x32x16_bf16 v[88:103], v[16:19], v[160:163], v[136:151]
    s_add_u32 s34, s38, 38912
    s_add_u32 m0, s37, 88064
    s_nop 0
    buffer_load_dwordx4 v0, s[4:7], s34 offen offset:0 sc1 lds
    v_mfma_f32_32x32x16_bf16 v[88:103], v[20:23], v[164:167], v[88:103]
    s_add_u32 s34, s58, 0
    buffer_load_dwordx4 a[224:227], v0, s[4:7], s34 offen sc1
    buffer_load_dwordx4 a[232:235], v0, s[4:7], s34 offen offset:1024 sc1
    v_mfma_f32_32x32x16_bf16 v[104:119], v[24:27], v[160:163], v[136:151]
    s_add_u32 s34, s38, 39936
    s_add_u32 m0, s37, 89088
    s_nop 0
    buffer_load_dwordx4 v0, s[4:7], s34 offen offset:0 sc1 lds
    v_mfma_f32_32x32x16_bf16 v[104:119], v[28:31], v[164:167], v[104:119]
    v_mfma_f32_32x32x16_bf16 v[120:135], v[32:35], v[160:163], v[136:151]
    ds_read_b128 v[192:195], v168 offset:34816
    s_add_u32 s34, s38, 40960
    s_add_u32 m0, s37, 90112
    s_nop 0
    buffer_load_dwordx4 v0, s[4:7], s34 offen offset:0 sc1 lds
    s_nop 5
    v_cndmask_b32 v104, v104, v88, s[64:65]
    v_cndmask_b32 v105, v105, v89, s[66:67]
    v_cndmask_b32 v106, v106, v90, s[68:69]
    v_cndmask_b32 v107, v107, v91, s[70:71]
    v_cndmask_b32 v108, v108, v92, s[72:73]
    v_cndmask_b32 v109, v109, v93, s[74:75]
    v_cndmask_b32 v110, v110, v94, s[76:77]
    v_mfma_f32_32x32x16_bf16 v[120:135], v[36:39], v[164:167], v[120:135]
    ds_read_b128 v[196:199], v168 offset:35840
    s_add_u32 s34, s58, 2048
    buffer_load_dwordx4 a[240:243], v0, s[4:7], s34 offen sc1
    buffer_load_dwordx4 a[248:251], v0, s[4:7], s34 offen offset:1024 sc1
    v_cndmask_b32 v111, v111, v95, s[78:79]
    v_cndmask_b32 v112, v112, v96, s[80:81]
    v_cndmask_b32 v113, v113, v97, s[82:83]
    v_cndmask_b32 v114, v114, v98, s[84:85]
    v_cndmask_b32 v115, v115, v99, s[86:87]
    v_cndmask_b32 v116, v116, v100, s[88:89]
    v_cndmask_b32 v117, v117, v101, s[90:91]
    v_cndmask_b32 v118, v118, v102, s[92:93]
    v_cndmask_b32 v119, v119, v103, s[94:95]
    v_mfma_f32_32x32x16_bf16 v[88:103], v[40:43], v[160:163], v[136:151]
    ds_read_b128 v[200:203], v168 offset:2048
    s_add_u32 s34, s38, 41984
    s_add_u32 m0, s37, 91136
    s_nop 0
    buffer_load_dwordx4 v0, s[4:7], s34 offen offset:0 sc1 lds
    v_exp_f32 v104, v104
    v_exp_f32 v105, v105
    v_exp_f32 v106, v106
    v_mfma_f32_32x32x16_bf16 v[88:103], v[44:47], v[164:167], v[88:103]
    ds_read_b128 v[204:207], v168 offset:3072
    v_exp_f32 v107, v107
    v_cvt_pk_bf16_f32 v104, v104, v105
    v_exp_f32 v108, v108
    v_exp_f32 v109, v109
    v_cvt_pk_bf16_f32 v105, v106, v107
    v_exp_f32 v110, v110
    v_exp_f32 v111, v111
    v_cvt_pk_bf16_f32 v106, v108, v109
    v_exp_f32 v112, v112
    v_exp_f32 v113, v113
    v_cvt_pk_bf16_f32 v107, v110, v111
    v_exp_f32 v114, v114
    v_exp_f32 v115, v115
    v_cvt_pk_bf16_f32 v108, v112, v113
    v_exp_f32 v116, v116
    v_exp_f32 v117, v117
    v_cvt_pk_bf16_f32 v109, v114, v115
    v_exp_f32 v118, v118
    v_exp_f32 v119, v119
    v_cvt_pk_bf16_f32 v110, v116, v117
    v_cvt_pk_bf16_f32 v111, v118, v119
    v_bfi_b32 v112, v152, 0, v104
    v_and_b32 v104, v152, v104
    v_bfi_b32 v113, v153, 0, v105
    v_and_b32 v105, v153, v105
    v_bfi_b32 v114, v154, 0, v106
    v_and_b32 v106, v154, v106
    v_bfi_b32 v115, v155, 0, v107
    v_and_b32 v107, v155, v107
    v_bfi_b32 v116, v156, 0, v108
    v_and_b32 v108, v156, v108
    v_bfi_b32 v117, v157, 0, v109
    v_and_b32 v109, v157, v109
    v_bfi_b32 v118, v158, 0, v110
    v_and_b32 v110, v158, v110
    v_bfi_b32 v119, v159, 0, v111
    v_and_b32 v111, v159, v111
    s_waitcnt lgkmcnt(3)
    v_mfma_f32_32x32x16_bf16 v[176:191], v[192:195], v[104:107], 0
    s_add_u32 s34, s38, 43008
    s_add_u32 m0, s37, 92160
    s_nop 0
    buffer_load_dwordx4 v0, s[4:7], s34 offen offset:0 sc1 lds
    v_exp_f32 v120, v120
    v_exp_f32 v121, v121
    v_exp_f32 v122, v122
    v_exp_f32 v123, v123
    s_waitcnt lgkmcnt(2)
    v_mfma_f32_32x32x16_bf16 v[176:191], v[196:199], v[108:111], v[176:191]
    s_add_u32 s34, s58, 4096
    buffer_load_dwordx4 v[224:227], v0, s[4:7], s34 offen sc1
    buffer_load_dwordx4 v[232:235], v0, s[4:7], s34 offen offset:1024 sc1
    v_cvt_pk_bf16_f32 v120, v120, v121
    v_exp_f32 v124, v124
    v_exp_f32 v125, v125
    v_cvt_pk_bf16_f32 v121, v122, v123
    v_exp_f32 v126, v126
    s_waitcnt lgkmcnt(1)
    v_mfma_f32_32x32x16_bf16 v[176:191], v[200:203], v[112:115], v[176:191]
    ds_read_b128 v[208:211], v168 offset:6144
    s_add_u32 s34, s38, 44032
    s_add_u32 m0, s37, 93184
    s_nop 0
    buffer_load_dwordx4 v0, s[4:7], s34 offen offset:0 sc1 lds
    v_exp_f32 v127, v127
    v_cvt_pk_bf16_f32 v122, v124, v125
    v_exp_f32 v128, v128
    v_exp_f32 v129, v129
    s_waitcnt lgkmcnt(1)
    v_mfma_f32_32x32x16_bf16 v[176:191], v[204:207], v[116:119], v[176:191]
    ds_read_b128 v[212:215], v168 offset:7168
    v_cvt_pk_bf16_f32 v123, v126, v127
    v_exp_f32 v130, v130
    v_exp_f32 v131, v131
    v_cvt_pk_bf16_f32 v124, v128, v129
    v_exp_f32 v132, v132
    v_mfma_f32_32x32x16_bf16 v[104:119], v[48:51], v[160:163], v[136:151]
    s_add_u32 s34, s38, 45056
    s_add_u32 m0, s37, 94208
    s_nop 0
    buffer_load_dwordx4 v0, s[4:7], s34 offen offset:0 sc1 lds
    v_exp_f32 v133, v133
    v_cvt_pk_bf16_f32 v125, v130, v131
    v_exp_f32 v134, v134
    v_exp_f32 v135, v135
    v_cvt_pk_bf16_f32 v126, v132, v133
    v_mfma_f32_32x32x16_bf16 v[104:119], v[52:55], v[164:167], v[104:119]
    s_add_u32 s34, s58, 6144
    buffer_load_dwordx4 v[240:243], v0, s[4:7], s34 offen sc1
    buffer_load_dwordx4 v[248:251], v0, s[4:7], s34 offen offset:1024 sc1
    v_cvt_pk_bf16_f32 v127, v134, v135
    v_exp_f32 v88, v88
    v_exp_f32 v89, v89
    v_exp_f32 v90, v90
    s_waitcnt lgkmcnt(1)
    v_mfma_f32_32x32x16_bf16 v[176:191], v[208:211], v[120:123], v[176:191]
    ds_read_b128 v[192:195], v168 offset:10240
    s_add_u32 s34, s38, 46080
    s_add_u32 m0, s37, 95232
    s_nop 0
    buffer_load_dwordx4 v0, s[4:7], s34 offen offset:0 sc1 lds
    v_exp_f32 v91, v91
    v_cvt_pk_bf16_f32 v88, v88, v89
    v_exp_f32 v92, v92
    v_exp_f32 v93, v93
    s_waitcnt lgkmcnt(1)
    v_mfma_f32_32x32x16_bf16 v[176:191], v[212:215], v[124:127], v[176:191]
    ds_read_b128 v[196:199], v168 offset:11264
    v_cvt_pk_bf16_f32 v89, v90, v91
    v_exp_f32 v94, v94
    v_exp_f32 v95, v95
    v_cvt_pk_bf16_f32 v90, v92, v93
    v_exp_f32 v96, v96
    v_mfma_f32_32x32x16_bf16 v[120:135], v[56:59], v[160:163], v[136:151]
    s_add_u32 s34, s38, 47104
    s_add_u32 m0, s37, 96256
    s_nop 0
    buffer_load_dwordx4 v0, s[4:7], s34 offen offset:0 sc1 lds
    v_exp_f32 v97, v97
    v_cvt_pk_bf16_f32 v91, v94, v95
    v_exp_f32 v98, v98
    v_exp_f32 v99, v99
    v_cvt_pk_bf16_f32 v92, v96, v97
    v_mfma_f32_32x32x16_bf16 v[120:135], v[60:63], v[164:167], v[120:135]
    s_add_u32 s34, s59, 0
    buffer_load_dwordx4 a[228:231], v0, s[4:7], s34 offen sc1
    buffer_load_dwordx4 a[236:239], v0, s[4:7], s34 offen offset:1024 sc1
    v_exp_f32 v100, v100
    v_exp_f32 v101, v101
    v_cvt_pk_bf16_f32 v93, v98, v99
    v_exp_f32 v102, v102
    v_exp_f32 v103, v103
    v_cvt_pk_bf16_f32 v94, v100, v101
    v_cvt_pk_bf16_f32 v95, v102, v103
    s_waitcnt lgkmcnt(1)
    v_mfma_f32_32x32x16_bf16 v[176:191], v[192:195], v[88:91], v[176:191]
    ds_read_b128 v[200:203], v168 offset:14336
    s_add_u32 s34, s38, 48128
    s_add_u32 m0, s37, 97280
    s_nop 0
    buffer_load_dwordx4 v0, s[4:7], s34 offen offset:0 sc1 lds
    v_exp_f32 v104, v104
    v_exp_f32 v105, v105
    v_exp_f32 v106, v106
    s_waitcnt lgkmcnt(1)
    v_mfma_f32_32x32x16_bf16 v[176:191], v[196:199], v[92:95], v[176:191]
    ds_read_b128 v[204:207], v168 offset:15360
    v_exp_f32 v107, v107
    v_cvt_pk_bf16_f32 v104, v104, v105
    v_exp_f32 v108, v108
    v_exp_f32 v109, v109
    v_cvt_pk_bf16_f32 v105, v106, v107
    v_mfma_f32_32x32x16_bf16 v[88:103], v[64:67], v[160:163], v[136:151]
    s_add_u32 s34, s38, 49152
    s_add_u32 m0, s37, 98304
    s_nop 0
    buffer_load_dwordx4 v0, s[4:7], s34 offen offset:0 sc1 lds
    v_exp_f32 v110, v110
    v_exp_f32 v111, v111
    v_cvt_pk_bf16_f32 v106, v108, v109
    v_exp_f32 v112, v112
    v_mfma_f32_32x32x16_bf16 v[88:103], v[68:71], v[164:167], v[88:103]
    s_add_u32 s34, s59, 2048
    buffer_load_dwordx4 a[244:247], v0, s[4:7], s34 offen sc1
    buffer_load_dwordx4 a[252:255], v0, s[4:7], s34 offen offset:1024 sc1
    v_exp_f32 v113, v113
    v_cvt_pk_bf16_f32 v107, v110, v111
    v_exp_f32 v114, v114
    v_exp_f32 v115, v115
    v_cvt_pk_bf16_f32 v108, v112, v113
    v_exp_f32 v116, v116
    v_exp_f32 v117, v117
    v_cvt_pk_bf16_f32 v109, v114, v115
    v_exp_f32 v118, v118
    v_exp_f32 v119, v119
    v_cvt_pk_bf16_f32 v110, v116, v117
    v_cvt_pk_bf16_f32 v111, v118, v119
    s_waitcnt lgkmcnt(1)
    v_mfma_f32_32x32x16_bf16 v[176:191], v[200:203], v[104:107], v[176:191]
    ds_read_b128 v[208:211], v168 offset:18432
    s_add_u32 s34, s38, 50176
    s_add_u32 m0, s37, 99328
    s_nop 0
    buffer_load_dwordx4 v0, s[4:7], s34 offen offset:0 sc1 lds
    v_exp_f32 v120, v120
    v_exp_f32 v121, v121
    v_exp_f32 v122, v122
    s_waitcnt lgkmcnt(1)
    v_mfma_f32_32x32x16_bf16 v[176:191], v[204:207], v[108:111], v[176:191]
    ds_read_b128 v[212:215], v168 offset:19456
    v_exp_f32 v123, v123
    v_cvt_pk_bf16_f32 v120, v120, v121
    v_exp_f32 v124, v124
    v_exp_f32 v125, v125
    v_cvt_pk_bf16_f32 v121, v122, v123
    v_mfma_f32_32x32x16_bf16 v[104:119], v[72:75], v[160:163], v[136:151]
    s_add_u32 s34, s38, 51200
    s_add_u32 m0, s37, 100352
    s_nop 0
    buffer_load_dwordx4 v0, s[4:7], s34 offen offset:0 sc1 lds
    v_exp_f32 v126, v126
    v_exp_f32 v127, v127
    v_cvt_pk_bf16_f32 v122, v124, v125
    v_exp_f32 v128, v128
    v_mfma_f32_32x32x16_bf16 v[104:119], v[76:79], v[164:167], v[104:119]
    s_add_u32 s34, s59, 4096
    buffer_load_dwordx4 v[228:231], v0, s[4:7], s34 offen sc1
    buffer_load_dwordx4 v[236:239], v0, s[4:7], s34 offen offset:1024 sc1
    v_exp_f32 v129, v129
    v_cvt_pk_bf16_f32 v123, v126, v127
    v_exp_f32 v130, v130
    v_exp_f32 v131, v131
    v_cvt_pk_bf16_f32 v124, v128, v129
    v_exp_f32 v132, v132
    v_exp_f32 v133, v133
    v_cvt_pk_bf16_f32 v125, v130, v131
    v_exp_f32 v134, v134
    v_exp_f32 v135, v135
    v_cvt_pk_bf16_f32 v126, v132, v133
    v_cvt_pk_bf16_f32 v127, v134, v135
    s_waitcnt lgkmcnt(1)
    v_mfma_f32_32x32x16_bf16 v[176:191], v[208:211], v[120:123], v[176:191]
    ds_read_b128 v[192:195], v168 offset:22528
    s_add_u32 s34, s38, 52224
    s_add_u32 m0, s37, 101376
    s_nop 0
    buffer_load_dwordx4 v0, s[4:7], s34 offen offset:0 sc1 lds
    v_exp_f32 v88, v88
    v_exp_f32 v89, v89
    v_exp_f32 v90, v90
    s_waitcnt lgkmcnt(1)
    v_mfma_f32_32x32x16_bf16 v[176:191], v[212:215], v[124:127], v[176:191]
    ds_read_b128 v[196:199], v168 offset:23552
    v_exp_f32 v91, v91
    v_cvt_pk_bf16_f32 v88, v88, v89
    v_exp_f32 v92, v92
    v_exp_f32 v93, v93
    v_cvt_pk_bf16_f32 v89, v90, v91
    v_mfma_f32_32x32x16_bf16 v[120:135], v[80:83], v[160:163], v[136:151]
    ds_read_b128 v[200:203], v168 offset:26624
    s_add_u32 s34, s38, 53248
    s_add_u32 m0, s37, 102400
    s_nop 0
    buffer_load_dwordx4 v0, s[4:7], s34 offen offset:0 sc1 lds
    v_exp_f32 v94, v94
    v_exp_f32 v95, v95
    v_cvt_pk_bf16_f32 v90, v92, v93
    v_exp_f32 v96, v96
    v_mfma_f32_32x32x16_bf16 v[120:135], v[84:87], v[164:167], v[120:135]
    ds_read_b128 v[204:207], v168 offset:27648
    s_add_u32 s34, s59, 6144
    buffer_load_dwordx4 v[244:247], v0, s[4:7], s34 offen sc1
    buffer_load_dwordx4 v[252:255], v0, s[4:7], s34 offen offset:1024 sc1
    v_exp_f32 v97, v97
    v_cvt_pk_bf16_f32 v91, v94, v95
    v_exp_f32 v98, v98
    v_exp_f32 v99, v99
    v_cvt_pk_bf16_f32 v92, v96, v97
    v_exp_f32 v100, v100
    v_exp_f32 v101, v101
    v_cvt_pk_bf16_f32 v93, v98, v99
    v_exp_f32 v102, v102
    v_exp_f32 v103, v103
    v_cvt_pk_bf16_f32 v94, v100, v101
    v_cvt_pk_bf16_f32 v95, v102, v103
    s_waitcnt lgkmcnt(3)
    v_mfma_f32_32x32x16_bf16 v[176:191], v[192:195], v[88:91], v[176:191]
    ds_read_b128 v[208:211], v168 offset:30720
    s_add_u32 s34, s38, 54272
    s_add_u32 m0, s37, 103424
    s_nop 0
    buffer_load_dwordx4 v0, s[4:7], s34 offen offset:0 sc1 lds
    v_exp_f32 v104, v104
    v_exp_f32 v105, v105
    v_exp_f32 v106, v106
    s_waitcnt lgkmcnt(3)
    v_mfma_f32_32x32x16_bf16 v[176:191], v[196:199], v[92:95], v[176:191]
    ds_read_b128 v[212:215], v168 offset:31744
    v_exp_f32 v107, v107
    v_cvt_pk_bf16_f32 v104, v104, v105
    v_exp_f32 v108, v108
    v_exp_f32 v109, v109
    v_cvt_pk_bf16_f32 v105, v106, v107
    v_exp_f32 v110, v110
    v_exp_f32 v111, v111
    v_cvt_pk_bf16_f32 v106, v108, v109
    v_exp_f32 v112, v112
    v_exp_f32 v113, v113
    v_cvt_pk_bf16_f32 v107, v110, v111
    v_exp_f32 v114, v114
    v_exp_f32 v115, v115
    v_cvt_pk_bf16_f32 v108, v112, v113
    v_exp_f32 v116, v116
    v_exp_f32 v117, v117
    v_cvt_pk_bf16_f32 v109, v114, v115
    v_exp_f32 v118, v118
    v_exp_f32 v119, v119
    v_cvt_pk_bf16_f32 v110, v116, v117
    v_cvt_pk_bf16_f32 v111, v118, v119
    s_waitcnt lgkmcnt(3)
    v_mfma_f32_32x32x16_bf16 v[176:191], v[200:203], v[104:107], v[176:191]
    s_add_u32 s34, s38, 55296
    s_add_u32 m0, s37, 104448
    s_nop 0
    buffer_load_dwordx4 v0, s[4:7], s34 offen offset:0 sc1 lds
    v_exp_f32 v120, v120
    v_exp_f32 v121, v121
    v_exp_f32 v122, v122
    v_exp_f32 v123, v123
    s_waitcnt lgkmcnt(2)
    v_mfma_f32_32x32x16_bf16 v[176:191], v[204:207], v[108:111], v[176:191]
    v_cvt_pk_bf16_f32 v120, v120, v121
    v_exp_f32 v124, v124
    v_exp_f32 v125, v125
    v_cvt_pk_bf16_f32 v121, v122, v123
    v_exp_f32 v126, v126
    v_exp_f32 v127, v127
    v_cvt_pk_bf16_f32 v122, v124, v125
    v_exp_f32 v128, v128
    v_exp_f32 v129, v129
    v_cvt_pk_bf16_f32 v123, v126, v127
    v_exp_f32 v130, v130
    v_exp_f32 v131, v131
    v_cvt_pk_bf16_f32 v124, v128, v129
    v_exp_f32 v132, v132
    v_exp_f32 v133, v133
    v_cvt_pk_bf16_f32 v125, v130, v131
    v_exp_f32 v134, v134
    v_exp_f32 v135, v135
    v_cvt_pk_bf16_f32 v126, v132, v133
    v_cvt_pk_bf16_f32 v127, v134, v135
    s_waitcnt lgkmcnt(1)
    v_mfma_f32_32x32x16_bf16 v[176:191], v[208:211], v[120:123], v[176:191]
    s_waitcnt lgkmcnt(0)
    v_mfma_f32_32x32x16_bf16 v[176:191], v[212:215], v[124:127], v[176:191]
    s_nop 11
    v_mov_b32 v216, v188
    v_mov_b32 v217, v188
    s_nop 1
    v_permlane32_swap_b32 v216, v217
    v_rcp_f32 v217, v217
    s_nop 0
    v_mul_f32 v176, v217, v176
    v_mul_f32 v177, v217, v177
    v_mul_f32 v178, v217, v178
    v_mul_f32 v179, v217, v179
    v_mul_f32 v180, v217, v180
    v_mul_f32 v181, v217, v181
    v_mul_f32 v182, v217, v182
    v_mul_f32 v183, v217, v183
    v_cvt_pk_bf16_f32 v176, v176, v177
    v_cvt_pk_bf16_f32 v177, v178, v179
    v_cvt_pk_bf16_f32 v178, v180, v181
    v_cvt_pk_bf16_f32 v179, v182, v183
    buffer_store_dwordx4 v[176:179], v0, s[96:99], s21 offen offset:0
    buffer_store_dwordx4 v[176:179], v0, s[0:3], s21 offen offset:0 sc1
    v_mul_f32 v184, v217, v184
    v_mul_f32 v185, v217, v185
    v_mul_f32 v186, v217, v186
    v_mul_f32 v187, v217, v187
    v_mul_f32 v188, v217, v188
    v_mul_f32 v189, v217, v189
    v_mul_f32 v190, v217, v190
    v_mul_f32 v191, v217, v191
    v_cvt_pk_bf16_f32 v184, v184, v185
    v_cvt_pk_bf16_f32 v185, v186, v187
    v_cvt_pk_bf16_f32 v186, v188, v189
    v_cvt_pk_bf16_f32 v187, v190, v191
    buffer_store_dwordx4 v[184:187], v0, s[96:99], s21 offen offset:1024
    buffer_store_dwordx4 v[184:187], v0, s[0:3], s21 offen offset:1024 sc1
    s_waitcnt vmcnt(0) lgkmcnt(0)
    s_barrier
    s_cmp_eq_u32 s14, 0
    s_cbranch_scc0 Loth_30
    s_add_u32 s34, s30, 0
    v_mov_b32 v220, s100
    v_mov_b32 v221, s101
    s_mov_b64 exec, 1
    buffer_store_dwordx2 v[220:221], v0, s[96:99], s34 offen
    buffer_store_dwordx2 v[220:221], v0, s[0:3], s34 offen sc1
    s_mov_b64 exec, -1
Loth_30:
    s_cmp_ge_u32 s13, 14
    s_cbranch_scc1 Lp3end_29
    s_add_u32 s34, s60, 0
    buffer_load_dwordx4 a[0:3], v0, s[4:7], s34 offen sc1
    buffer_load_dwordx4 a[8:11], v0, s[4:7], s34 offen offset:1024 sc1
    s_add_u32 s34, s60, 2048
    buffer_load_dwordx4 a[16:19], v0, s[4:7], s34 offen sc1
    buffer_load_dwordx4 a[24:27], v0, s[4:7], s34 offen offset:1024 sc1
    s_add_u32 s34, s61, 0
    buffer_load_dwordx4 a[4:7], v0, s[4:7], s34 offen sc1
    buffer_load_dwordx4 a[12:15], v0, s[4:7], s34 offen offset:1024 sc1
    s_add_u32 s34, s61, 2048
    buffer_load_dwordx4 a[20:23], v0, s[4:7], s34 offen sc1
    buffer_load_dwordx4 a[28:31], v0, s[4:7], s34 offen offset:1024 sc1
    v_lshlrev_b32 v16, 16, v8
    v_and_b32 v17, 0xffff0000, v8
    v_lshlrev_b32 v18, 16, v9
    v_and_b32 v19, 0xffff0000, v9
    v_lshlrev_b32 v20, 16, v10
    v_and_b32 v21, 0xffff0000, v10
    v_lshlrev_b32 v22, 16, v11
    v_and_b32 v23, 0xffff0000, v11
    v_lshlrev_b32 v24, 16, v12
    v_and_b32 v25, 0xffff0000, v12
    v_lshlrev_b32 v26, 16, v13
    v_and_b32 v27, 0xffff0000, v13
    v_lshlrev_b32 v28, 16, v14
    v_and_b32 v29, 0xffff0000, v14
    v_lshlrev_b32 v30, 16, v15
    v_and_b32 v31, 0xffff0000, v15
    s_xor_b32 s34, s14, 1
    s_mul_i32 s34, s34, 12288
    s_add_u32 s34, s34, 0
    v_add_u32 v208, s34, v0
    s_xor_b32 s34, s14, 2
    s_mul_i32 s34, s34, 12288
    s_add_u32 s34, s34, 4096
    v_add_u32 v209, s34, v0
    s_xor_b32 s34, s14, 3
    s_mul_i32 s34, s34, 12288
    s_add_u32 s34, s34, 8192
    v_add_u32 v210, s34, v0
    s_mul_i32 s34, s14, 12288
    v_add_u32 v211, s34, v0
    v_mov_b32 v212, 0
    v_mov_b32 v213, 0
    v_mov_b32 v214, 0
    v_mov_b32 v215, 0
    v_mov_b32 v216, 0x3f803f80
    v_and_b32 v217, 0xf8, v7
    s_cmp_eq_u32 s14, 0
    s_cbranch_scc0 Loth_32
    s_add_u32 s34, s29, 0
    s_mov_b32 exec_lo, 0xffff
    s_mov_b32 exec_hi, 0
Lpoll_34:
    buffer_load_dwordx2 v[220:221], v7, s[4:7], s34 offen sc1
    s_waitcnt vmcnt(0)
    s_waitcnt vmcnt(0)
    v_cmp_eq_u64 vcc, s[100:101], v[220:221]
    s_sub_u32 s33, s33, 1
    s_cmp_eq_u32 s33, 0
    s_cbranch_scc1 main_done
    s_cmp_eq_u64 vcc, exec
    s_cbranch_scc0 Lpoll_34
    s_mov_b64 exec, -1
Loth_32:
    s_barrier
    s_add_u32 s36, s22, 0
    buffer_load_dwordx4 v[80:83], v0, s[4:7], s36 offen offset:0 sc1
    s_add_u32 s37, s23, 0
    buffer_load_dwordx4 v[84:87], v0, s[4:7], s37 offen offset:0 sc1
    buffer_load_dwordx4 v[88:91], v0, s[4:7], s36 offen offset:1024 sc1
    buffer_load_dwordx4 v[92:95], v0, s[4:7], s37 offen offset:1024 sc1
    buffer_load_dwordx4 v[96:99], v0, s[4:7], s36 offen offset:2048 sc1
    buffer_load_dwordx4 v[100:103], v0, s[4:7], s37 offen offset:2048 sc1
    buffer_load_dwordx4 v[104:107], v0, s[4:7], s36 offen offset:3072 sc1
    buffer_load_dwordx4 v[108:111], v0, s[4:7], s37 offen offset:3072 sc1
    s_add_u32 s36, s22, 4096
    buffer_load_dwordx4 v[112:115], v0, s[4:7], s36 offen offset:0 sc1
    s_add_u32 s37, s23, 4096
    buffer_load_dwordx4 v[116:119], v0, s[4:7], s37 offen offset:0 sc1
    s_waitcnt vmcnt(9)
    v_mfma_f32_32x32x16_bf16 v[32:47], a[228:231], v[80:83], 0
    buffer_load_dwordx4 v[120:123], v0, s[4:7], s36 offen offset:1024 sc1
    v_mfma_f32_32x32x16_bf16 v[16:31], a[224:227], v[80:83], v[16:31]
    s_waitcnt vmcnt(9)
    v_mfma_f32_32x32x16_bf16 v[48:63], a[224:227], v[84:87], 0
    buffer_load_dwordx4 v[124:127], v0, s[4:7], s37 offen offset:1024 sc1
    v_mfma_f32_32x32x16_bf16 v[64:79], a[228:231], v[84:87], 0
    s_waitcnt vmcnt(9)
    v_mfma_f32_32x32x16_bf16 v[32:47], a[236:239], v[88:91], v[32:47]
    buffer_load_dwordx4 v[128:131], v0, s[4:7], s36 offen offset:2048 sc1
    v_mfma_f32_32x32x16_bf16 v[16:31], a[232:235], v[88:91], v[16:31]
    s_waitcnt vmcnt(9)
    v_mfma_f32_32x32x16_bf16 v[48:63], a[232:235], v[92:95], v[48:63]
    buffer_load_dwordx4 v[132:135], v0, s[4:7], s37 offen offset:2048 sc1
    v_mfma_f32_32x32x16_bf16 v[64:79], a[236:239], v[92:95], v[64:79]
    s_waitcnt vmcnt(9)
    v_mfma_f32_32x32x16_bf16 v[32:47], a[244:247], v[96:99], v[32:47]
    buffer_load_dwordx4 v[136:139], v0, s[4:7], s36 offen offset:3072 sc1
    s_add_u32 s34, s60, 4096
    buffer_load_dwordx4 a[32:35], v0, s[4:7], s34 offen sc1
    buffer_load_dwordx4 a[40:43], v0, s[4:7], s34 offen offset:1024 sc1
    v_mfma_f32_32x32x16_bf16 v[16:31], a[240:243], v[96:99], v[16:31]
    s_waitcnt vmcnt(11)
    v_mfma_f32_32x32x16_bf16 v[48:63], a[240:243], v[100:103], v[48:63]
    buffer_load_dwordx4 v[140:143], v0, s[4:7], s37 offen offset:3072 sc1
    s_add_u32 s34, s60, 6144
    buffer_load_dwordx4 a[48:51], v0, s[4:7], s34 offen sc1
    buffer_load_dwordx4 a[56:59], v0, s[4:7], s34 offen offset:1024 sc1
    v_mfma_f32_32x32x16_bf16 v[64:79], a[244:247], v[100:103], v[64:79]
    s_waitcnt vmcnt(13)
    v_mfma_f32_32x32x16_bf16 v[32:47], a[252:255], v[104:107], v[32:47]
    s_add_u32 s34, s60, 8192
    buffer_load_dwordx4 a[64:67], v0, s[4:7], s34 offen sc1
    buffer_load_dwordx4 a[72:75], v0, s[4:7], s34 offen offset:1024 sc1
    v_mfma_f32_32x32x16_bf16 v[16:31], a[248:251], v[104:107], v[16:31]
    s_waitcnt vmcnt(14)
    v_mfma_f32_32x32x16_bf16 v[48:63], a[248:251], v[108:111], v[48:63]
    s_add_u32 s34, s60, 10240
    buffer_load_dwordx4 a[80:83], v0, s[4:7], s34 offen sc1
    buffer_load_dwordx4 a[88:91], v0, s[4:7], s34 offen offset:1024 sc1
    v_mfma_f32_32x32x16_bf16 v[64:79], a[252:255], v[108:111], v[64:79]
    s_waitcnt vmcnt(15)
    v_mfma_f32_32x32x16_bf16 v[32:47], v[228:231], v[112:115], v[32:47]
    s_add_u32 s34, s60, 12288
    buffer_load_dwordx4 a[96:99], v0, s[4:7], s34 offen sc1
    buffer_load_dwordx4 a[104:107], v0, s[4:7], s34 offen offset:1024 sc1
    v_mfma_f32_32x32x16_bf16 v[16:31], v[224:227], v[112:115], v[16:31]
    s_waitcnt vmcnt(16)
    v_mfma_f32_32x32x16_bf16 v[48:63], v[224:227], v[116:119], v[48:63]
    s_add_u32 s34, s60, 14336
    buffer_load_dwordx4 a[112:115], v0, s[4:7], s34 offen sc1
    buffer_load_dwordx4 a[120:123], v0, s[4:7], s34 offen offset:1024 sc1
    v_mfma_f32_32x32x16_bf16 v[64:79], v[228:231], v[116:119], v[64:79]
    s_waitcnt vmcnt(17)
    v_mfma_f32_32x32x16_bf16 v[32:47], v[236:239], v[120:123], v[32:47]
    s_add_u32 s34, s61, 4096
    buffer_load_dwordx4 a[36:39], v0, s[4:7], s34 offen sc1
    buffer_load_dwordx4 a[44:47], v0, s[4:7], s34 offen offset:1024 sc1
    v_mfma_f32_32x32x16_bf16 v[16:31], v[232:235], v[120:123], v[16:31]
    s_waitcnt vmcnt(18)
    v_mfma_f32_32x32x16_bf16 v[48:63], v[232:235], v[124:127], v[48:63]
    s_add_u32 s34, s61, 6144
    buffer_load_dwordx4 a[52:55], v0, s[4:7], s34 offen sc1
    buffer_load_dwordx4 a[60:63], v0, s[4:7], s34 offen offset:1024 sc1
    v_mfma_f32_32x32x16_bf16 v[64:79], v[236:239], v[124:127], v[64:79]
    s_waitcnt vmcnt(19)
    v_mfma_f32_32x32x16_bf16 v[32:47], v[244:247], v[128:131], v[32:47]
    s_add_u32 s34, s61, 8192
    buffer_load_dwordx4 a[68:71], v0, s[4:7], s34 offen sc1
    buffer_load_dwordx4 a[76:79], v0, s[4:7], s34 offen offset:1024 sc1
    v_mfma_f32_32x32x16_bf16 v[16:31], v[240:243], v[128:131], v[16:31]
    s_waitcnt vmcnt(20)
    v_mfma_f32_32x32x16_bf16 v[48:63], v[240:243], v[132:135], v[48:63]
    s_add_u32 s34, s61, 10240
    buffer_load_dwordx4 a[84:87], v0, s[4:7], s34 offen sc1
    buffer_load_dwordx4 a[92:95], v0, s[4:7], s34 offen offset:1024 sc1
    v_mfma_f32_32x32x16_bf16 v[64:79], v[244:247], v[132:135], v[64:79]
    s_waitcnt vmcnt(21)
    v_mfma_f32_32x32x16_bf16 v[32:47], v[252:255], v[136:139], v[32:47]
    s_add_u32 s34, s61, 12288
    buffer_load_dwordx4 a[100:103], v0, s[4:7], s34 offen sc1
    buffer_load_dwordx4 a[108:111], v0, s[4:7], s34 offen offset:1024 sc1
    s_waitcnt vmcnt(20)
    v_mfma_f32_32x32x16_bf16 v[48:63], v[248:251], v[140:143], v[48:63]
    v_mfma_f32_32x32x16_bf16 v[64:79], v[252:255], v[140:143], v[64:79]
    s_add_u32 s34, s61, 14336
    buffer_load_dwordx4 a[116:119], v0, s[4:7], s34 offen sc1
    buffer_load_dwordx4 a[124:127], v0, s[4:7], s34 offen offset:1024 sc1
    s_nop 2
    ds_write_b128 v208, v[32:35] offset:0
    v_mfma_f32_32x32x16_bf16 v[16:31], v[248:251], v[136:139], v[16:31]
    ds_write_b128 v208, v[36:39] offset:1024
    ds_write_b128 v208, v[40:43] offset:2048
    ds_write_b128 v208, v[44:47] offset:3072
    ds_write_b128 v209, v[48:51] offset:0
    ds_write_b128 v209, v[52:55] offset:1024
    ds_write_b128 v209, v[56:59] offset:2048
    ds_write_b128 v209, v[60:63] offset:3072
    ds_write_b128 v210, v[64:67] offset:0
    ds_write_b128 v210, v[68:71] offset:1024
    ds_write_b128 v210, v[72:75] offset:2048
    ds_write_b128 v210, v[76:79] offset:3072
    s_waitcnt lgkmcnt(0)
    s_barrier
    ds_read_b128 v[80:83], v211 offset:0
    ds_read_b128 v[96:99], v211 offset:4096
    ds_read_b128 v[112:115], v211 offset:8192
    ds_read_b128 v[84:87], v211 offset:1024
    ds_read_b128 v[100:103], v211 offset:5120
    ds_read_b128 v[116:119], v211 offset:9216
    ds_read_b128 v[88:91], v211 offset:2048
    ds_read_b128 v[104:107], v211 offset:6144
    ds_read_b128 v[120:123], v211 offset:10240
    ds_read_b128 v[92:95], v211 offset:3072
    ds_read_b128 v[108:111], v211 offset:7168
    ds_read_b128 v[124:127], v211 offset:11264
    s_waitcnt lgkmcnt(11)
    v_add_f32 v16, v16, v80
    v_add_f32 v17, v17, v81
    v_add_f32 v18, v18, v82
    v_add_f32 v19, v19, v83
    s_waitcnt lgkmcnt(10)
    v_add_f32 v16, v16, v96
    v_add_f32 v17, v17, v97
    v_add_f32 v18, v18, v98
    v_add_f32 v19, v19, v99
    s_waitcnt lgkmcnt(9)
    v_add_f32 v16, v16, v112
    v_add_f32 v17, v17, v113
    v_add_f32 v18, v18, v114
    v_add_f32 v19, v19, v115
    s_waitcnt lgkmcnt(8)
    v_add_f32 v20, v20, v84
    v_add_f32 v21, v21, v85
    v_add_f32 v22, v22, v86
    v_add_f32 v23, v23, v87
    s_waitcnt lgkmcnt(7)
    v_add_f32 v20, v20, v100
    v_add_f32 v21, v21, v101
    v_add_f32 v22, v22, v102
    v_add_f32 v23, v23, v103
    s_waitcnt lgkmcnt(6)
    v_add_f32 v20, v20, v116
    v_add_f32 v21, v21, v117
    v_add_f32 v22, v22, v118
    v_add_f32 v23, v23, v119
    v_cvt_pk_bf16_f32 v8, v16, v17
    v_cvt_pk_bf16_f32 v9, v18, v19
    v_cvt_pk_bf16_f32 v10, v20, v21
    v_cvt_pk_bf16_f32 v11, v22, v23
    s_add_u32 s34, s26, 114688
    buffer_store_dwordx4 v[8:11], v0, s[96:99], s34 offen offset:0
    buffer_store_dwordx4 v[8:11], v0, s[0:3], s34 offen offset:0 sc1
    v_dot2_f32_bf16 v212, v8, v216, v212
    v_dot2_f32_bf16 v213, v8, v8, v213
    v_dot2_f32_bf16 v214, v9, v216, v214
    v_dot2_f32_bf16 v215, v9, v9, v215
    v_dot2_f32_bf16 v212, v10, v216, v212
    v_dot2_f32_bf16 v213, v10, v10, v213
    v_dot2_f32_bf16 v214, v11, v216, v214
    v_dot2_f32_bf16 v215, v11, v11, v215
    s_waitcnt lgkmcnt(5)
    v_add_f32 v24, v24, v88
    v_add_f32 v25, v25, v89
    v_add_f32 v26, v26, v90
    v_add_f32 v27, v27, v91
    s_waitcnt lgkmcnt(4)
    v_add_f32 v24, v24, v104
    v_add_f32 v25, v25, v105
    v_add_f32 v26, v26, v106
    v_add_f32 v27, v27, v107
    s_waitcnt lgkmcnt(3)
    v_add_f32 v24, v24, v120
    v_add_f32 v25, v25, v121
    v_add_f32 v26, v26, v122
    v_add_f32 v27, v27, v123
    s_waitcnt lgkmcnt(2)
    v_add_f32 v28, v28, v92
    v_add_f32 v29, v29, v93
    v_add_f32 v30, v30, v94
    v_add_f32 v31, v31, v95
    s_waitcnt lgkmcnt(1)
    v_add_f32 v28, v28, v108
    v_add_f32 v29, v29, v109
    v_add_f32 v30, v30, v110
    v_add_f32 v31, v31, v111
    s_waitcnt lgkmcnt(0)
    v_add_f32 v28, v28, v124
    v_add_f32 v29, v29, v125
    v_add_f32 v30, v30, v126
    v_add_f32 v31, v31, v127
    v_cvt_pk_bf16_f32 v12, v24, v25
    v_cvt_pk_bf16_f32 v13, v26, v27
    v_cvt_pk_bf16_f32 v14, v28, v29
    v_cvt_pk_bf16_f32 v15, v30, v31
    buffer_store_dwordx4 v[12:15], v0, s[96:99], s34 offen offset:1024
    buffer_store_dwordx4 v[12:15], v0, s[0:3], s34 offen offset:1024 sc1
    v_dot2_f32_bf16 v212, v12, v216, v212
    v_dot2_f32_bf16 v213, v12, v12, v213
    v_dot2_f32_bf16 v214, v13, v216, v214
    v_dot2_f32_bf16 v215, v13, v13, v215
    v_dot2_f32_bf16 v212, v14, v216, v212
    v_dot2_f32_bf16 v213, v14, v14, v213
    v_dot2_f32_bf16 v214, v15, v216, v214
    v_dot2_f32_bf16 v215, v15, v15, v215
    s_add_u32 s35, s27, 372736
    s_nop 0
    v_add_f32 v212, v212, v214
    v_add_f32 v213, v213, v215
    v_mov_b32 v214, v212
    v_mov_b32 v215, v213
    s_nop 0
    v_permlane32_swap_b32 v212, v214
    v_permlane32_swap_b32 v213, v215
    v_add_f32 v212, v212, v214
    v_add_f32 v213, v213, v215
    buffer_store_dwordx2 v[212:213], v217, s[96:99], s35 offen
    buffer_store_dwordx2 v[212:213], v217, s[0:3], s35 offen sc1
    s_waitcnt vmcnt(0) lgkmcnt(0)
    s_barrier
    s_cmp_eq_u32 s14, 0
    s_cbranch_scc0 Loth_35
    s_add_u32 s34, s30, 4096
    v_mov_b32 v220, s100
    v_mov_b32 v221, s101
    s_mov_b64 exec, 1
    buffer_store_dwordx2 v[220:221], v0, s[96:99], s34 offen
    buffer_store_dwordx2 v[220:221], v0, s[0:3], s34 offen sc1
    s_mov_b64 exec, -1
Loth_35:
    s_branch Lp3x_37
Lp3end_29:
    s_getpc_b64 s[34:35]
Lpcb_38:
    s_lshl_b32 s36, s14, 13
    v_lshl_add_u32 v218, v0, 3, s36
    s_mov_b32 s36, main_done - Lpcb_38
    v_min_u32 v218, s36, v218
    global_load_dword v223, v218, s[34:35]
Lp3x_37:
    s_cmp_eq_u32 s14, 0
    s_cbranch_scc0 Loth_39
    s_add_u32 s34, s29, 4096
    s_mov_b32 exec_lo, 0x3fff
    s_mov_b32 exec_hi, 0
Lpoll_41:
    buffer_load_dwordx2 v[220:221], v7, s[4:7], s34 offen sc1
    s_waitcnt vmcnt(0)
    s_waitcnt vmcnt(0)
    v_cmp_eq_u64 vcc, s[100:101], v[220:221]
    s_sub_u32 s33, s33, 1
    s_cmp_eq_u32 s33, 0
    s_cbranch_scc1 main_done
    s_cmp_eq_u64 vcc, exec
    s_cbranch_scc0 Lpoll_41
    s_mov_b64 exec, -1
Loth_39:
    s_waitcnt vmcnt(0)
    s_mul_i32 s37, s14, 12288
    s_add_u32 s38, s49, s37
    s_barrier
    s_add_u32 s36, s15, 114688
    buffer_load_dwordx4 v[16:19], v0, s[4:7], s36 offen offset:0 sc1
    buffer_load_dwordx4 v[20:23], v0, s[4:7], s36 offen offset:1024 sc1
    buffer_load_dwordx4 v[24:27], v0, s[4:7], s36 offen offset:2048 sc1
    buffer_load_dwordx4 v[28:31], v0, s[4:7], s36 offen offset:3072 sc1
    s_add_u32 s36, s15, 118784
    buffer_load_dwordx4 v[32:35], v0, s[4:7], s36 offen offset:0 sc1
    buffer_load_dwordx4 v[36:39], v0, s[4:7], s36 offen offset:1024 sc1
    buffer_load_dwordx4 v[40:43], v0, s[4:7], s36 offen offset:2048 sc1
    buffer_load_dwordx4 v[44:47], v0, s[4:7], s36 offen offset:3072 sc1
    ds_read_b128 v[192:195], v0 offset:49152
    ds_read_b128 v[196:199], v1 offset:12288
    ds_read_b128 v[200:203], v1 offset:40960
    ds_read_b128 v[204:207], v0 offset:50176
    ds_read_b128 v[208:211], v1 offset:13312
    s_waitcnt vmcnt(7) lgkmcnt(4)
    v_mfma_f32_32x32x16_bf16 v[128:143], v[192:195], v[16:19], 0
    ds_read_b128 v[192:195], v1 offset:41984
    s_add_u32 s36, s15, 122880
    buffer_load_dwordx4 v[48:51], v0, s[4:7], s36 offen offset:0 sc1
    s_waitcnt lgkmcnt(4)
    v_mfma_f32_32x32x16_bf16 v[144:159], v[196:199], v[16:19], 0
    ds_read_b128 v[196:199], v0 offset:51200
    s_waitcnt lgkmcnt(4)
    v_mfma_f32_32x32x16_bf16 v[160:175], v[200:203], v[16:19], 0
    ds_read_b128 v[200:203], v1 offset:14336
    buffer_load_dwordx4 v[52:55], v0, s[4:7], s36 offen offset:1024 sc1
    s_waitcnt vmcnt(8) lgkmcnt(4)
    v_mfma_f32_32x32x16_bf16 v[128:143], v[204:207], v[20:23], v[128:143]
    ds_read_b128 v[204:207], v1 offset:43008
    s_waitcnt lgkmcnt(4)
    v_mfma_f32_32x32x16_bf16 v[144:159], v[208:211], v[20:23], v[144:159]
    ds_read_b128 v[208:211], v0 offset:52224
    buffer_load_dwordx4 v[56:59], v0, s[4:7], s36 offen offset:2048 sc1
    s_waitcnt lgkmcnt(4)
    v_mfma_f32_32x32x16_bf16 v[160:175], v[192:195], v[20:23], v[160:175]
    ds_read_b128 v[192:195], v1 offset:15360
    s_waitcnt vmcnt(8) lgkmcnt(4)
    v_mfma_f32_32x32x16_bf16 v[128:143], v[196:199], v[24:27], v[128:143]
    ds_read_b128 v[196:199], v1 offset:44032
    buffer_load_dwordx4 v[60:63], v0, s[4:7], s36 offen offset:3072 sc1
    s_waitcnt lgkmcnt(4)
    v_mfma_f32_32x32x16_bf16 v[144:159], v[200:203], v[24:27], v[144:159]
    ds_read_b128 v[200:203], v0 offset:53248
    s_waitcnt lgkmcnt(4)
    v_mfma_f32_32x32x16_bf16 v[160:175], v[204:207], v[24:27], v[160:175]
    ds_read_b128 v[204:207], v1 offset:16384
    s_add_u32 s36, s15, 126976
    buffer_load_dwordx4 v[64:67], v0, s[4:7], s36 offen offset:0 sc1
    s_waitcnt vmcnt(9) lgkmcnt(4)
    v_mfma_f32_32x32x16_bf16 v[128:143], v[208:211], v[28:31], v[128:143]
    ds_read_b128 v[208:211], v1 offset:45056
    s_waitcnt lgkmcnt(4)
    v_mfma_f32_32x32x16_bf16 v[144:159], v[192:195], v[28:31], v[144:159]
    ds_read_b128 v[192:195], v0 offset:54272
    buffer_load_dwordx4 v[68:71], v0, s[4:7], s36 offen offset:1024 sc1
    s_waitcnt lgkmcnt(4)
    v_mfma_f32_32x32x16_bf16 v[160:175], v[196:199], v[28:31], v[160:175]
    ds_read_b128 v[196:199], v1 offset:17408
    s_waitcnt vmcnt(9) lgkmcnt(4)
    v_mfma_f32_32x32x16_bf16 v[128:143], v[200:203], v[32:35], v[128:143]
    ds_read_b128 v[200:203], v1 offset:46080
    buffer_load_dwordx4 v[72:75], v0, s[4:7], s36 offen offset:2048 sc1
    s_waitcnt lgkmcnt(4)
    v_mfma_f32_32x32x16_bf16 v[144:159], v[204:207], v[32:35], v[144:159]
    ds_read_b128 v[204:207], v0 offset:55296
    s_waitcnt lgkmcnt(4)
    v_mfma_f32_32x32x16_bf16 v[160:175], v[208:211], v[32:35], v[160:175]
    ds_read_b128 v[208:211], v1 offset:18432
    buffer_load_dwordx4 v[76:79], v0, s[4:7], s36 offen offset:3072 sc1
    s_waitcnt vmcnt(10) lgkmcnt(4)
    v_mfma_f32_32x32x16_bf16 v[128:143], v[192:195], v[36:39], v[128:143]
    ds_read_b128 v[192:195], v1 offset:47104
    s_waitcnt lgkmcnt(4)
    v_mfma_f32_32x32x16_bf16 v[144:159], v[196:199], v[36:39], v[144:159]
    ds_read_b128 v[196:199], v0 offset:56320
    s_add_u32 s35, s32, 372736
    buffer_load_dwordx2 v[176:177], v7, s[4:7], s35 offen offset:0 sc1
    s_waitcnt lgkmcnt(4)
    v_mfma_f32_32x32x16_bf16 v[160:175], v[200:203], v[36:39], v[160:175]
    ds_read_b128 v[200:203], v1 offset:19456
    s_waitcnt vmcnt(10) lgkmcnt(4)
    v_mfma_f32_32x32x16_bf16 v[128:143], v[204:207], v[40:43], v[128:143]
    ds_read_b128 v[204:207], v1 offset:48128
    buffer_load_dwordx2 v[178:179], v7, s[4:7], s35 offen offset:512 sc1
    s_waitcnt lgkmcnt(4)
    v_mfma_f32_32x32x16_bf16 v[144:159], v[208:211], v[40:43], v[144:159]
    ds_read_b128 v[208:211], v0 offset:57344
    s_waitcnt lgkmcnt(4)
    v_mfma_f32_32x32x16_bf16 v[160:175], v[192:195], v[40:43], v[160:175]
    ds_read_b128 v[192:195], v1 offset:20480
    buffer_load_dwordx2 v[180:181], v7, s[4:7], s35 offen offset:1024 sc1
    s_waitcnt vmcnt(11) lgkmcnt(4)
    v_mfma_f32_32x32x16_bf16 v[128:143], v[196:199], v[44:47], v[128:143]
    ds_read_b128 v[196:199], v1 offset:49152
    s_waitcnt lgkmcnt(4)
    v_mfma_f32_32x32x16_bf16 v[144:159], v[200:203], v[44:47], v[144:159]
    ds_read_b128 v[200:203], v0 offset:58368
    buffer_load_dwordx2 v[182:183], v7, s[4:7], s35 offen offset:1536 sc1
    s_waitcnt lgkmcnt(4)
    v_mfma_f32_32x32x16_bf16 v[160:175], v[204:207], v[44:47], v[160:175]
    ds_read_b128 v[204:207], v1 offset:21504
    s_waitcnt vmcnt(11) lgkmcnt(4)
    v_mfma_f32_32x32x16_bf16 v[128:143], v[208:211], v[48:51], v[128:143]
    ds_read_b128 v[208:211], v1 offset:50176
    buffer_load_dwordx2 v[184:185], v7, s[4:7], s35 offen offset:2048 sc1
    s_waitcnt lgkmcnt(4)
    v_mfma_f32_32x32x16_bf16 v[144:159], v[192:195], v[48:51], v[144:159]
    ds_read_b128 v[192:195], v0 offset:59392
    s_waitcnt lgkmcnt(4)
    v_mfma_f32_32x32x16_bf16 v[160:175], v[196:199], v[48:51], v[160:175]
    ds_read_b128 v[196:199], v1 offset:22528
    buffer_load_dwordx2 v[186:187], v7, s[4:7], s35 offen offset:2560 sc1
    s_waitcnt vmcnt(12) lgkmcnt(4)
    v_mfma_f32_32x32x16_bf16 v[128:143], v[200:203], v[52:55], v[128:143]
    ds_read_b128 v[200:203], v1 offset:51200
    s_waitcnt lgkmcnt(4)
    v_mfma_f32_32x32x16_bf16 v[144:159], v[204:207], v[52:55], v[144:159]
    ds_read_b128 v[204:207], v0 offset:60416
    buffer_load_dwordx2 v[188:189], v7, s[4:7], s35 offen offset:3072 sc1
    s_waitcnt lgkmcnt(4)
    v_mfma_f32_32x32x16_bf16 v[160:175], v[208:211], v[52:55], v[160:175]
    ds_read_b128 v[208:211], v1 offset:23552
    s_waitcnt vmcnt(12) lgkmcnt(4)
    v_mfma_f32_32x32x16_bf16 v[128:143], v[192:195], v[56:59], v[128:143]
    ds_read_b128 v[192:195], v1 offset:52224
    s_add_u32 s36, s15, 131072
    buffer_load_dwordx4 v[80:83], v0, s[4:7], s36 offen offset:0 sc1
    s_waitcnt lgkmcnt(4)
    v_mfma_f32_32x32x16_bf16 v[144:159], v[196:199], v[56:59], v[144:159]
    ds_read_b128 v[196:199], v0 offset:61440
    s_waitcnt lgkmcnt(4)
    v_mfma_f32_32x32x16_bf16 v[160:175], v[200:203], v[56:59], v[160:175]
    ds_read_b128 v[200:203], v1 offset:24576
    buffer_load_dwordx4 v[84:87], v0, s[4:7], s36 offen offset:1024 sc1
    s_waitcnt vmcnt(13) lgkmcnt(4)
    v_mfma_f32_32x32x16_bf16 v[128:143], v[204:207], v[60:63], v[128:143]
    ds_read_b128 v[204:207], v1 offset:53248
    s_waitcnt lgkmcnt(4)
    v_mfma_f32_32x32x16_bf16 v[144:159], v[208:211], v[60:63], v[144:159]
    ds_read_b128 v[208:211], v0 offset:62464
    buffer_load_dwordx4 v[88:91], v0, s[4:7], s36 offen offset:2048 sc1
    s_waitcnt lgkmcnt(4)
    v_mfma_f32_32x32x16_bf16 v[160:175], v[192:195], v[60:63], v[160:175]
    ds_read_b128 v[192:195], v1 offset:25600
    s_waitcnt vmcnt(13) lgkmcnt(4)
    v_mfma_f32_32x32x16_bf16 v[128:143], v[196:199], v[64:67], v[128:143]
    ds_read_b128 v[196:199], v1 offset:54272
    buffer_load_dwordx4 v[92:95], v0, s[4:7], s36 offen offset:3072 sc1
    s_waitcnt lgkmcnt(4)
    v_mfma_f32_32x32x16_bf16 v[144:159], v[200:203], v[64:67], v[144:159]
    ds_read_b128 v[200:203], v0 offset:63488
    s_waitcnt lgkmcnt(4)
    v_mfma_f32_32x32x16_bf16 v[160:175], v[204:207], v[64:67], v[160:175]
    ds_read_b128 v[204:207], v1 offset:26624
    s_add_u32 s36, s15, 135168
    buffer_load_dwordx4 v[96:99], v0, s[4:7], s36 offen offset:0 sc1
    s_waitcnt vmcnt(14) lgkmcnt(4)
    v_mfma_f32_32x32x16_bf16 v[128:143], v[208:211], v[68:71], v[128:143]
    ds_read_b128 v[208:211], v1 offset:55296
    s_waitcnt lgkmcnt(4)
    v_mfma_f32_32x32x16_bf16 v[144:159], v[192:195], v[68:71], v[144:159]
    ds_read_b128 v[192:195], v0 offset:64512
    buffer_load_dwordx4 v[100:103], v0, s[4:7], s36 offen offset:1024 sc1
    s_waitcnt lgkmcnt(4)
    v_mfma_f32_32x32x16_bf16 v[160:175], v[196:199], v[68:71], v[160:175]
    ds_read_b128 v[196:199], v1 offset:27648
    s_waitcnt vmcnt(14) lgkmcnt(4)
    v_mfma_f32_32x32x16_bf16 v[128:143], v[200:203], v[72:75], v[128:143]
    ds_read_b128 v[200:203], v1 offset:56320
    buffer_load_dwordx4 v[104:107], v0, s[4:7], s36 offen offset:2048 sc1
    s_waitcnt lgkmcnt(4)
    v_mfma_f32_32x32x16_bf16 v[144:159], v[204:207], v[72:75], v[144:159]
    ds_read_b128 v[204:207], v1 offset:0
    s_waitcnt lgkmcnt(4)
    v_mfma_f32_32x32x16_bf16 v[160:175], v[208:211], v[72:75], v[160:175]
    ds_read_b128 v[208:211], v1 offset:28672
    buffer_load_dwordx4 v[108:111], v0, s[4:7], s36 offen offset:3072 sc1
    s_waitcnt vmcnt(15) lgkmcnt(4)
    v_mfma_f32_32x32x16_bf16 v[128:143], v[192:195], v[76:79], v[128:143]
    ds_read_b128 v[192:195], v1 offset:57344
    s_waitcnt lgkmcnt(4)
    v_mfma_f32_32x32x16_bf16 v[144:159], v[196:199], v[76:79], v[144:159]
    ds_read_b128 v[196:199], v1 offset:1024
    s_add_u32 s36, s15, 139264
    buffer_load_dwordx4 v[112:115], v0, s[4:7], s36 offen offset:0 sc1
    s_waitcnt lgkmcnt(4)
    v_mfma_f32_32x32x16_bf16 v[160:175], v[200:203], v[76:79], v[160:175]
    ds_read_b128 v[200:203], v1 offset:29696
    s_waitcnt vmcnt(8) lgkmcnt(4)
    v_mfma_f32_32x32x16_bf16 v[128:143], v[204:207], v[80:83], v[128:143]
    ds_read_b128 v[204:207], v1 offset:58368
    buffer_load_dwordx4 v[116:119], v0, s[4:7], s36 offen offset:1024 sc1
    v_add_f32 v176, v176, v178
    v_add_f32 v177, v177, v179
    s_waitcnt lgkmcnt(4)
    v_mfma_f32_32x32x16_bf16 v[144:159], v[208:211], v[80:83], v[144:159]
    ds_read_b128 v[208:211], v1 offset:2048
    v_add_f32 v180, v180, v182
    v_add_f32 v181, v181, v183
    v_add_f32 v184, v184, v186
    v_add_f32 v185, v185, v187
    s_waitcnt lgkmcnt(4)
    v_mfma_f32_32x32x16_bf16 v[160:175], v[192:195], v[80:83], v[160:175]
    ds_read_b128 v[192:195], v1 offset:30720
    buffer_load_dwordx4 v[120:123], v0, s[4:7], s36 offen offset:2048 sc1
    v_add_f32 v176, v176, v180
    v_add_f32 v177, v177, v181
    s_waitcnt vmcnt(9) lgkmcnt(4)
    v_mfma_f32_32x32x16_bf16 v[128:143], v[196:199], v[84:87], v[128:143]
    ds_read_b128 v[196:199], v1 offset:59392
    v_add_f32 v184, v184, v188
    v_add_f32 v185, v185, v189
    v_add_f32 v176, v176, v184
    v_add_f32 v177, v177, v185
    s_waitcnt lgkmcnt(4)
    v_mfma_f32_32x32x16_bf16 v[144:159], v[200:203], v[84:87], v[144:159]
    ds_read_b128 v[200:203], v1 offset:3072
    buffer_load_dwordx4 v[124:127], v0, s[4:7], s36 offen offset:3072 sc1
    v_mov_b32 v178, v176
    v_mov_b32 v179, v177
    s_waitcnt lgkmcnt(4)
    v_mfma_f32_32x32x16_bf16 v[160:175], v[204:207], v[84:87], v[160:175]
    ds_read_b128 v[204:207], v1 offset:31744
    v_permlane32_swap_b32 v176, v178
    v_permlane32_swap_b32 v177, v179
    v_add_f32 v176, v176, v178
    v_add_f32 v177, v177, v179
    s_waitcnt vmcnt(9) lgkmcnt(4)
    v_mfma_f32_32x32x16_bf16 v[128:143], v[208:211], v[88:91], v[128:143]
    ds_read_b128 v[208:211], v1 offset:60416
    s_add_u32 s34, s38, 108544
    s_add_u32 m0, s37, 0
    s_nop 0
    buffer_load_dwordx4 v0, s[4:7], s34 offen offset:0 sc1 lds
    v_mul_f32 v216, s52, v176
    v_mul_f32 v219, s52, v177
    s_waitcnt lgkmcnt(4)
    v_mfma_f32_32x32x16_bf16 v[144:159], v[192:195], v[88:91], v[144:159]
    ds_read_b128 v[192:195], v1 offset:4096
    v_fma_f32 v219, -v216, v216, v219
    v_max_f32 v219, 0, v219
    v_add_f32 v219, s53, v219
    s_waitcnt lgkmcnt(4)
    v_mfma_f32_32x32x16_bf16 v[160:175], v[196:199], v[88:91], v[160:175]
    ds_read_b128 v[196:199], v1 offset:32768
    s_add_u32 s34, s38, 109568
    s_add_u32 m0, s37, 1024
    s_nop 0
    buffer_load_dwordx4 v0, s[4:7], s34 offen offset:0 sc1 lds
    v_rsq_f32 v217, v219
    s_waitcnt vmcnt(10) lgkmcnt(4)
    v_mfma_f32_32x32x16_bf16 v[128:143], v[200:203], v[92:95], v[128:143]
    ds_read_b128 v[200:203], v1 offset:61440
    v_cndmask_b32 v176, -v216, 0, s[40:41]
    v_cvt_pk_bf16_f32 v177, v176, v176
    v_and_b32 v177, 0xffff0000, v177
    v_sub_f32 v177, v176, v177
    s_waitcnt lgkmcnt(4)
    v_mfma_f32_32x32x16_bf16 v[144:159], v[204:207], v[92:95], v[144:159]
    ds_read_b128 v[204:207], v1 offset:5120
    s_add_u32 s34, s38, 110592
    s_add_u32 m0, s37, 2048
    s_nop 0
    buffer_load_dwordx4 v0, s[4:7], s34 offen offset:0 sc1 lds
    v_cvt_pk_bf16_f32 v212, v176, v177
    v_and_b32 v178, 0xffff0000, v212
    s_waitcnt lgkmcnt(4)
    v_mfma_f32_32x32x16_bf16 v[160:175], v[208:211], v[92:95], v[160:175]
    ds_read_b128 v[208:211], v1 offset:33792
    v_sub_f32 v178, v177, v178
    v_cvt_pk_bf16_f32 v213, v176, v178
    v_mov_b32 v214, v212
    v_mov_b32 v215, 0
    s_waitcnt vmcnt(10) lgkmcnt(4)
    v_mfma_f32_32x32x16_bf16 v[128:143], v[192:195], v[96:99], v[128:143]
    ds_read_b128 v[192:195], v1 offset:62464
    s_add_u32 s34, s38, 111616
    s_add_u32 m0, s37, 3072
    s_nop 0
    buffer_load_dwordx4 v0, s[4:7], s34 offen offset:0 sc1 lds
    v_mul_f32 v217, s55, v217
    s_waitcnt lgkmcnt(4)
    v_mfma_f32_32x32x16_bf16 v[144:159], v[196:199], v[96:99], v[144:159]
    ds_read_b128 v[196:199], v1 offset:6144
    s_waitcnt lgkmcnt(4)
    v_mfma_f32_32x32x16_bf16 v[160:175], v[200:203], v[96:99], v[160:175]
    ds_read_b128 v[200:203], v1 offset:34816
    s_add_u32 s34, s38, 112640
    s_add_u32 m0, s37, 4096
    s_nop 0
    buffer_load_dwordx4 v0, s[4:7], s34 offen offset:0 sc1 lds
    s_waitcnt vmcnt(11) lgkmcnt(4)
    v_mfma_f32_32x32x16_bf16 v[128:143], v[204:207], v[100:103], v[128:143]
    ds_read_b128 v[204:207], v1 offset:63488
    s_waitcnt lgkmcnt(4)
    v_mfma_f32_32x32x16_bf16 v[144:159], v[208:211], v[100:103], v[144:159]
    ds_read_b128 v[208:211], v1 offset:7168
    s_add_u32 s34, s38, 113664
    s_add_u32 m0, s37, 5120
    s_nop 0
    buffer_load_dwordx4 v0, s[4:7], s34 offen offset:0 sc1 lds
    s_waitcnt lgkmcnt(4)
    v_mfma_f32_32x32x16_bf16 v[160:175], v[192:195], v[100:103], v[160:175]
    ds_read_b128 v[192:195], v1 offset:35840
    s_waitcnt vmcnt(11) lgkmcnt(4)
    v_mfma_f32_32x32x16_bf16 v[128:143], v[196:199], v[104:107], v[128:143]
    ds_read_b128 v[196:199], v1 offset:64512
    s_add_u32 s34, s38, 114688
    s_add_u32 m0, s37, 6144
    s_nop 0
    buffer_load_dwordx4 v0, s[4:7], s34 offen offset:0 sc1 lds
    s_waitcnt lgkmcnt(4)
    v_mfma_f32_32x32x16_bf16 v[144:159], v[200:203], v[104:107], v[144:159]
    ds_read_b128 v[200:203], v1 offset:8192
    s_waitcnt lgkmcnt(4)
    v_mfma_f32_32x32x16_bf16 v[160:175], v[204:207], v[104:107], v[160:175]
    ds_read_b128 v[204:207], v1 offset:36864
    s_add_u32 s34, s38, 115712
    s_add_u32 m0, s37, 7168
    s_nop 0
    buffer_load_dwordx4 v0, s[4:7], s34 offen offset:0 sc1 lds
    s_waitcnt vmcnt(12) lgkmcnt(4)
    v_mfma_f32_32x32x16_bf16 v[128:143], v[208:211], v[108:111], v[128:143]
    ds_read_b128 v[208:211], v2 offset:0
    s_waitcnt lgkmcnt(4)
    v_mfma_f32_32x32x16_bf16 v[144:159], v[192:195], v[108:111], v[144:159]
    ds_read_b128 v[192:195], v1 offset:9216
    s_add_u32 s34, s38, 116736
    s_add_u32 m0, s37, 8192
    s_nop 0
    buffer_load_dwordx4 v0, s[4:7], s34 offen offset:0 sc1 lds
    s_waitcnt lgkmcnt(4)
    v_mfma_f32_32x32x16_bf16 v[160:175], v[196:199], v[108:111], v[160:175]
    ds_read_b128 v[196:199], v1 offset:37888
    s_waitcnt vmcnt(12) lgkmcnt(4)
    v_mfma_f32_32x32x16_bf16 v[128:143], v[200:203], v[112:115], v[128:143]
    ds_read_b128 v[200:203], v2 offset:1024
    s_add_u32 s34, s38, 117760
    s_add_u32 m0, s37, 9216
    s_nop 0
    buffer_load_dwordx4 v0, s[4:7], s34 offen offset:0 sc1 lds
    s_waitcnt lgkmcnt(4)
    v_mfma_f32_32x32x16_bf16 v[144:159], v[204:207], v[112:115], v[144:159]
    ds_read_b128 v[204:207], v1 offset:10240
    s_waitcnt lgkmcnt(4)
    v_mfma_f32_32x32x16_bf16 v[160:175], v[208:211], v[112:115], v[160:175]
    ds_read_b128 v[208:211], v1 offset:38912
    s_add_u32 s34, s38, 118784
    s_add_u32 m0, s37, 10240
    s_nop 0
    buffer_load_dwordx4 v0, s[4:7], s34 offen offset:0 sc1 lds
    s_waitcnt vmcnt(13) lgkmcnt(4)
    v_mfma_f32_32x32x16_bf16 v[128:143], v[192:195], v[116:119], v[128:143]
    ds_read_b128 v[192:195], v2 offset:2048
    s_waitcnt lgkmcnt(4)
    v_mfma_f32_32x32x16_bf16 v[144:159], v[196:199], v[116:119], v[144:159]
    ds_read_b128 v[196:199], v1 offset:11264
    s_add_u32 s34, s38, 119808
    s_add_u32 m0, s37, 11264
    s_nop 0
    buffer_load_dwordx4 v0, s[4:7], s34 offen offset:0 sc1 lds
    s_waitcnt lgkmcnt(4)
    v_mfma_f32_32x32x16_bf16 v[160:175], v[200:203], v[116:119], v[160:175]
    ds_read_b128 v[200:203], v1 offset:39936
    s_waitcnt vmcnt(13) lgkmcnt(4)
    v_mfma_f32_32x32x16_bf16 v[128:143], v[204:207], v[120:123], v[128:143]
    ds_read_b128 v[204:207], v2 offset:3072
    s_waitcnt lgkmcnt(4)
    v_mfma_f32_32x32x16_bf16 v[144:159], v[208:211], v[120:123], v[144:159]
    ds_read_b128 v[208:211], v4 offset:1536
    s_waitcnt lgkmcnt(4)
    v_mfma_f32_32x32x16_bf16 v[160:175], v[192:195], v[120:123], v[160:175]
    ds_read_b128 v[192:195], v4 offset:2048
    s_waitcnt vmcnt(12) lgkmcnt(4)
    v_mfma_f32_32x32x16_bf16 v[128:143], v[196:199], v[124:127], v[128:143]
    ds_read_b128 v[196:199], v4 offset:2560
    s_waitcnt lgkmcnt(4)
    v_mfma_f32_32x32x16_bf16 v[144:159], v[200:203], v[124:127], v[144:159]
    ds_read_b128 v[200:203], v2 offset:4096
    s_waitcnt lgkmcnt(4)
    v_mfma_f32_32x32x16_bf16 v[160:175], v[204:207], v[124:127], v[160:175]
    ds_read_b128 v[204:207], v2 offset:5120
    s_waitcnt lgkmcnt(4)
    v_mfma_f32_32x32x16_bf16 v[128:143], v[208:211], v[212:215], v[128:143]
    ds_read_b128 v[208:211], v2 offset:6144
    s_waitcnt lgkmcnt(4)
    v_mfma_f32_32x32x16_bf16 v[144:159], v[192:195], v[212:215], v[144:159]
    ds_read_b128 v[192:195], v2 offset:7168
    s_waitcnt lgkmcnt(4)
    v_mfma_f32_32x32x16_bf16 v[160:175], v[196:199], v[212:215], v[160:175]
    ds_read_b128 v[196:199], v2 offset:8192
    s_waitcnt lgkmcnt(4)
    v_mfma_f32_32x32x16_bf16 v[176:191], v[200:203], v[16:19], 0
    ds_read_b128 v[200:203], v2 offset:9216
    s_nop 1
    v_mul_f32 v136, v128, v136
    v_mul_f32 v128, v217, v128
    v_mul_f32 v137, v129, v137
    v_mul_f32 v129, v217, v129
    s_waitcnt lgkmcnt(4)
    v_mfma_f32_32x32x16_bf16 v[176:191], v[204:207], v[20:23], v[176:191]
    ds_read_b128 v[204:207], v2 offset:10240
    v_mul_f32 v138, v130, v138
    v_mul_f32 v130, v217, v130
    v_mul_f32 v139, v131, v139
    v_mul_f32 v131, v217, v131
    s_waitcnt lgkmcnt(4)
    v_mfma_f32_32x32x16_bf16 v[176:191], v[208:211], v[24:27], v[176:191]
    ds_read_b128 v[208:211], v2 offset:11264
    v_mul_f32 v140, v132, v140
    v_mul_f32 v132, v217, v132
    v_mul_f32 v141, v133, v141
    v_mul_f32 v133, v217, v133
    s_waitcnt lgkmcnt(4)
    v_mfma_f32_32x32x16_bf16 v[176:191], v[192:195], v[28:31], v[176:191]
    ds_read_b128 v[192:195], v2 offset:12288
    v_mul_f32 v142, v134, v142
    v_mul_f32 v134, v217, v134
    v_mul_f32 v143, v135, v143
    v_mul_f32 v135, v217, v135
    s_waitcnt lgkmcnt(4)
    v_mfma_f32_32x32x16_bf16 v[176:191], v[196:199], v[32:35], v[176:191]
    ds_read_b128 v[196:199], v2 offset:13312
    v_exp_f32 v128, v128
    v_exp_f32 v129, v129
    s_waitcnt lgkmcnt(4)
    v_mfma_f32_32x32x16_bf16 v[176:191], v[200:203], v[36:39], v[176:191]
    ds_read_b128 v[200:203], v2 offset:14336
    v_exp_f32 v130, v130
    v_exp_f32 v131, v131
    s_waitcnt lgkmcnt(4)
    v_mfma_f32_32x32x16_bf16 v[176:191], v[204:207], v[40:43], v[176:191]
    ds_read_b128 v[204:207], v2 offset:15360
    v_exp_f32 v132, v132
    v_exp_f32 v133, v133
    s_waitcnt lgkmcnt(4)
    v_mfma_f32_32x32x16_bf16 v[176:191], v[208:211], v[44:47], v[176:191]
    ds_read_b128 v[208:211], v2 offset:16384
    v_exp_f32 v134, v134
    v_exp_f32 v135, v135
    s_waitcnt lgkmcnt(4)
    v_mfma_f32_32x32x16_bf16 v[176:191], v[192:195], v[48:51], v[176:191]
    ds_read_b128 v[192:195], v2 offset:17408
    v_fma_f32 v128, v128, v219, v219
    v_fma_f32 v129, v129, v219, v219
    v_fma_f32 v130, v130, v219, v219
    v_fma_f32 v131, v131, v219, v219
    s_waitcnt lgkmcnt(4)
    v_mfma_f32_32x32x16_bf16 v[176:191], v[196:199], v[52:55], v[176:191]
    ds_read_b128 v[196:199], v2 offset:18432
    v_fma_f32 v132, v132, v219, v219
    v_fma_f32 v133, v133, v219, v219
    v_fma_f32 v134, v134, v219, v219
    v_fma_f32 v135, v135, v219, v219
    s_waitcnt lgkmcnt(4)
    v_mfma_f32_32x32x16_bf16 v[176:191], v[200:203], v[56:59], v[176:191]
    ds_read_b128 v[200:203], v2 offset:19456
    v_rcp_f32 v128, v128
    v_rcp_f32 v129, v129
    s_waitcnt lgkmcnt(4)
    v_mfma_f32_32x32x16_bf16 v[176:191], v[204:207], v[60:63], v[176:191]
    ds_read_b128 v[204:207], v2 offset:20480
    v_rcp_f32 v130, v130
    v_rcp_f32 v131, v131
    s_waitcnt vmcnt(0)
    s_barrier
    s_mul_i32 s37, s14, 11264
    s_add_u32 s38, s49, s37
    s_waitcnt lgkmcnt(4)
    v_mfma_f32_32x32x16_bf16 v[176:191], v[208:211], v[64:67], v[176:191]
    ds_read_b128 v[208:211], v2 offset:21504
    s_add_u32 s34, s38, 157696
    s_add_u32 m0, s37, 49152
    s_nop 0
    buffer_load_dwordx4 v0, s[4:7], s34 offen offset:0 sc1 lds
    v_rcp_f32 v132, v132
    s_waitcnt lgkmcnt(4)
    v_mfma_f32_32x32x16_bf16 v[176:191], v[192:195], v[68:71], v[176:191]
    ds_read_b128 v[192:195], v2 offset:22528
    v_rcp_f32 v133, v133
    v_rcp_f32 v134, v134
    s_waitcnt lgkmcnt(4)
    v_mfma_f32_32x32x16_bf16 v[176:191], v[196:199], v[72:75], v[176:191]
    ds_read_b128 v[196:199], v2 offset:23552
    s_add_u32 s34, s38, 158720
    s_add_u32 m0, s37, 50176
    s_nop 0
    buffer_load_dwordx4 v0, s[4:7], s34 offen offset:0 sc1 lds
    v_rcp_f32 v135, v135
    s_waitcnt lgkmcnt(4)
    v_mfma_f32_32x32x16_bf16 v[176:191], v[200:203], v[76:79], v[176:191]
    ds_read_b128 v[200:203], v2 offset:24576
    v_mul_f32 v128, v128, v136
    v_mul_f32 v129, v129, v137
    v_mul_f32 v130, v130, v138
    v_mul_f32 v131, v131, v139
    s_waitcnt lgkmcnt(4)
    v_mfma_f32_32x32x16_bf16 v[176:191], v[204:207], v[80:83], v[176:191]
    ds_read_b128 v[204:207], v2 offset:25600
    s_add_u32 s34, s38, 159744
    s_add_u32 m0, s37, 51200
    s_nop 0
    buffer_load_dwordx4 v0, s[4:7], s34 offen offset:0 sc1 lds
    v_mul_f32 v132, v132, v140
    v_mul_f32 v133, v133, v141
    s_waitcnt lgkmcnt(4)
    v_mfma_f32_32x32x16_bf16 v[176:191], v[208:211], v[84:87], v[176:191]
    ds_read_b128 v[208:211], v0 offset:0
    v_mul_f32 v134, v134, v142
    v_mul_f32 v135, v135, v143
    v_cvt_pk_bf16_f32 v128, v128, v129
    v_cvt_pk_bf16_f32 v129, v130, v131
    s_waitcnt lgkmcnt(4)
    v_mfma_f32_32x32x16_bf16 v[176:191], v[192:195], v[88:91], v[176:191]
    ds_read_b128 v[192:195], v0 offset:1024
    s_add_u32 s34, s38, 160768
    s_add_u32 m0, s37, 52224
    s_nop 0
    buffer_load_dwordx4 v0, s[4:7], s34 offen offset:0 sc1 lds
    v_cvt_pk_bf16_f32 v130, v132, v133
    v_cvt_pk_bf16_f32 v131, v134, v135
    s_add_u32 s39, s28, 0
    s_waitcnt lgkmcnt(4)
    v_mfma_f32_32x32x16_bf16 v[176:191], v[196:199], v[92:95], v[176:191]
    ds_read_b128 v[196:199], v0 offset:2048
    buffer_store_dwordx4 v[128:131], v0, s[4:7], s39 offen offset:0 sc1
    v_mul_f32 v152, v144, v152
    v_mul_f32 v144, v217, v144
    s_waitcnt lgkmcnt(4)
    v_mfma_f32_32x32x16_bf16 v[176:191], v[200:203], v[96:99], v[176:191]
    ds_read_b128 v[200:203], v0 offset:3072
    s_add_u32 s34, s38, 161792
    s_add_u32 m0, s37, 53248
    s_nop 0
    buffer_load_dwordx4 v0, s[4:7], s34 offen offset:0 sc1 lds
    v_mul_f32 v153, v145, v153
    v_mul_f32 v145, v217, v145
    s_waitcnt lgkmcnt(4)
    v_mfma_f32_32x32x16_bf16 v[176:191], v[204:207], v[100:103], v[176:191]
    ds_read_b128 v[204:207], v0 offset:4096
    v_mul_f32 v154, v146, v154
    v_mul_f32 v146, v217, v146
    v_mul_f32 v155, v147, v155
    v_mul_f32 v147, v217, v147
    s_waitcnt lgkmcnt(4)
    v_mfma_f32_32x32x16_bf16 v[176:191], v[208:211], v[104:107], v[176:191]
    ds_read_b128 v[208:211], v0 offset:5120
    s_add_u32 s34, s38, 162816
    s_add_u32 m0, s37, 54272
    s_nop 0
    buffer_load_dwordx4 v0, s[4:7], s34 offen offset:0 sc1 lds
    v_mul_f32 v156, v148, v156
    v_mul_f32 v148, v217, v148
    s_waitcnt lgkmcnt(4)
    v_mfma_f32_32x32x16_bf16 v[176:191], v[192:195], v[108:111], v[176:191]
    ds_read_b128 v[192:195], v4 offset:3072
    v_mul_f32 v157, v149, v157
    v_mul_f32 v149, v217, v149
    v_mul_f32 v158, v150, v158
    v_mul_f32 v150, v217, v150
    s_waitcnt lgkmcnt(4)
    v_mfma_f32_32x32x16_bf16 v[176:191], v[196:199], v[112:115], v[176:191]
    ds_read_b128 v[196:199], v0 offset:6144
    s_add_u32 s34, s38, 163840
    s_add_u32 m0, s37, 55296
    s_nop 0
    buffer_load_dwordx4 v0, s[4:7], s34 offen offset:0 sc1 lds
    v_mul_f32 v159, v151, v159
    v_mul_f32 v151, v217, v151
    s_waitcnt lgkmcnt(4)
    v_mfma_f32_32x32x16_bf16 v[176:191], v[200:203], v[116:119], v[176:191]
    ds_read_b128 v[200:203], v0 offset:7168
    v_exp_f32 v144, v144
    v_exp_f32 v145, v145
    s_waitcnt lgkmcnt(4)
    v_mfma_f32_32x32x16_bf16 v[176:191], v[204:207], v[120:123], v[176:191]
    ds_read_b128 v[204:207], v0 offset:8192
    s_add_u32 s34, s38, 164864
    s_add_u32 m0, s37, 56320
    s_nop 0
    buffer_load_dwordx4 v0, s[4:7], s34 offen offset:0 sc1 lds
    v_exp_f32 v146, v146
    s_waitcnt lgkmcnt(4)
    v_mfma_f32_32x32x16_bf16 v[176:191], v[208:211], v[124:127], v[176:191]
    ds_read_b128 v[208:211], v0 offset:9216
    v_exp_f32 v147, v147
    v_exp_f32 v148, v148
    s_waitcnt lgkmcnt(4)
    v_mfma_f32_32x32x16_bf16 v[176:191], v[192:195], v[212:215], v[176:191]
    ds_read_b128 v[192:195], v0 offset:10240
    s_add_u32 s34, s38, 165888
    s_add_u32 m0, s37, 57344
    s_nop 0
    buffer_load_dwordx4 v0, s[4:7], s34 offen offset:0 sc1 lds
    v_exp_f32 v149, v149
    s_waitcnt lgkmcnt(4)
    v_mfma_f32_32x32x16_bf16 v[128:143], v[196:199], v[16:19], 0
    ds_read_b128 v[196:199], v0 offset:11264
    v_exp_f32 v150, v150
    v_exp_f32 v151, v151
    s_waitcnt lgkmcnt(4)
    v_mfma_f32_32x32x16_bf16 v[128:143], v[200:203], v[20:23], v[128:143]
    ds_read_b128 v[200:203], v0 offset:12288
    s_add_u32 s34, s38, 166912
    s_add_u32 m0, s37, 58368
    s_nop 0
    buffer_load_dwordx4 v0, s[4:7], s34 offen offset:0 sc1 lds
    v_fma_f32 v144, v144, v219, v219
    v_fma_f32 v145, v145, v219, v219
    s_waitcnt lgkmcnt(4)
    v_mfma_f32_32x32x16_bf16 v[128:143], v[204:207], v[24:27], v[128:143]
    ds_read_b128 v[204:207], v0 offset:13312
    v_fma_f32 v146, v146, v219, v219
    v_fma_f32 v147, v147, v219, v219
    v_fma_f32 v148, v148, v219, v219
    v_fma_f32 v149, v149, v219, v219
    s_waitcnt lgkmcnt(4)
    v_mfma_f32_32x32x16_bf16 v[128:143], v[208:211], v[28:31], v[128:143]
    ds_read_b128 v[208:211], v0 offset:14336
    s_add_u32 s34, s38, 167936
    s_add_u32 m0, s37, 59392
    s_nop 0
    buffer_load_dwordx4 v0, s[4:7], s34 offen offset:0 sc1 lds
    v_fma_f32 v150, v150, v219, v219
    v_fma_f32 v151, v151, v219, v219
    s_waitcnt lgkmcnt(4)
    v_mfma_f32_32x32x16_bf16 v[128:143], v[192:195], v[32:35], v[128:143]
    ds_read_b128 v[192:195], v0 offset:15360
    v_rcp_f32 v144, v144
    v_rcp_f32 v145, v145
    s_waitcnt lgkmcnt(4)
    v_mfma_f32_32x32x16_bf16 v[128:143], v[196:199], v[36:39], v[128:143]
    ds_read_b128 v[196:199], v0 offset:16384
    v_rcp_f32 v146, v146
    v_rcp_f32 v147, v147
    s_waitcnt lgkmcnt(4)
    v_mfma_f32_32x32x16_bf16 v[128:143], v[200:203], v[40:43], v[128:143]
    ds_read_b128 v[200:203], v0 offset:17408
    s_add_u32 s34, s60, 16384
    buffer_load_dwordx4 a[128:131], v0, s[4:7], s34 offen sc1
    buffer_load_dwordx4 a[136:139], v0, s[4:7], s34 offen offset:1024 sc1
    v_rcp_f32 v148, v148
    s_waitcnt lgkmcnt(4)
    v_mfma_f32_32x32x16_bf16 v[128:143], v[204:207], v[44:47], v[128:143]
    ds_read_b128 v[204:207], v0 offset:18432
    v_rcp_f32 v149, v149
    v_rcp_f32 v150, v150
    s_waitcnt lgkmcnt(4)
    v_mfma_f32_32x32x16_bf16 v[128:143], v[208:211], v[48:51], v[128:143]
    ds_read_b128 v[208:211], v0 offset:19456
    v_rcp_f32 v151, v151
    v_mul_f32 v144, v144, v152
    v_mul_f32 v145, v145, v153
    s_waitcnt lgkmcnt(4)
    v_mfma_f32_32x32x16_bf16 v[128:143], v[192:195], v[52:55], v[128:143]
    ds_read_b128 v[192:195], v0 offset:20480
    v_mul_f32 v146, v146, v154
    v_mul_f32 v147, v147, v155
    v_mul_f32 v148, v148, v156
    v_mul_f32 v149, v149, v157
    s_waitcnt lgkmcnt(4)
    v_mfma_f32_32x32x16_bf16 v[128:143], v[196:199], v[56:59], v[128:143]
    ds_read_b128 v[196:199], v0 offset:21504
    v_mul_f32 v150, v150, v158
    v_mul_f32 v151, v151, v159
    v_cvt_pk_bf16_f32 v144, v144, v145
    v_cvt_pk_bf16_f32 v145, v146, v147
    s_waitcnt lgkmcnt(4)
    v_mfma_f32_32x32x16_bf16 v[128:143], v[200:203], v[60:63], v[128:143]
    ds_read_b128 v[200:203], v0 offset:22528
    s_add_u32 s34, s60, 18432
    buffer_load_dwordx4 a[144:147], v0, s[4:7], s34 offen sc1
    buffer_load_dwordx4 a[152:155], v0, s[4:7], s34 offen offset:1024 sc1
    v_cvt_pk_bf16_f32 v146, v148, v149
    v_cvt_pk_bf16_f32 v147, v150, v151
    s_waitcnt lgkmcnt(4)
    v_mfma_f32_32x32x16_bf16 v[128:143], v[204:207], v[64:67], v[128:143]
    ds_read_b128 v[204:207], v0 offset:23552
    buffer_store_dwordx4 v[144:147], v0, s[4:7], s39 offen offset:1024 sc1
    v_mul_f32 v168, v160, v168
    v_mul_f32 v160, v217, v160
    s_waitcnt lgkmcnt(4)
    v_mfma_f32_32x32x16_bf16 v[128:143], v[208:211], v[68:71], v[128:143]
    ds_read_b128 v[208:211], v0 offset:24576
    v_mul_f32 v169, v161, v169
    v_mul_f32 v161, v217, v161
    v_mul_f32 v170, v162, v170
    v_mul_f32 v162, v217, v162
    s_waitcnt lgkmcnt(4)
    v_mfma_f32_32x32x16_bf16 v[128:143], v[192:195], v[72:75], v[128:143]
    ds_read_b128 v[192:195], v0 offset:25600
    v_mul_f32 v171, v163, v171
    v_mul_f32 v163, v217, v163
    v_mul_f32 v172, v164, v172
    v_mul_f32 v164, v217, v164
    s_waitcnt lgkmcnt(4)
    v_mfma_f32_32x32x16_bf16 v[128:143], v[196:199], v[76:79], v[128:143]
    ds_read_b128 v[196:199], v0 offset:26624
    v_mul_f32 v173, v165, v173
    v_mul_f32 v165, v217, v165
    v_mul_f32 v174, v166, v174
    v_mul_f32 v166, v217, v166
    s_waitcnt lgkmcnt(4)
    v_mfma_f32_32x32x16_bf16 v[128:143], v[200:203], v[80:83], v[128:143]
    ds_read_b128 v[200:203], v0 offset:27648
    s_add_u32 s34, s60, 20480
    buffer_load_dwordx4 a[160:163], v0, s[4:7], s34 offen sc1
    buffer_load_dwordx4 a[168:171], v0, s[4:7], s34 offen offset:1024 sc1
    v_mul_f32 v175, v167, v175
    v_mul_f32 v167, v217, v167
    s_waitcnt lgkmcnt(4)
    v_mfma_f32_32x32x16_bf16 v[128:143], v[204:207], v[84:87], v[128:143]
    ds_read_b128 v[204:207], v0 offset:28672
    v_exp_f32 v160, v160
    v_exp_f32 v161, v161
    s_waitcnt lgkmcnt(4)
    v_mfma_f32_32x32x16_bf16 v[128:143], v[208:211], v[88:91], v[128:143]
    ds_read_b128 v[208:211], v0 offset:29696
    v_exp_f32 v162, v162
    v_exp_f32 v163, v163
    s_waitcnt lgkmcnt(4)
    v_mfma_f32_32x32x16_bf16 v[128:143], v[192:195], v[92:95], v[128:143]
    ds_read_b128 v[192:195], v0 offset:30720
    v_exp_f32 v164, v164
    v_exp_f32 v165, v165
    s_waitcnt lgkmcnt(4)
    v_mfma_f32_32x32x16_bf16 v[128:143], v[196:199], v[96:99], v[128:143]
    ds_read_b128 v[196:199], v0 offset:31744
    v_exp_f32 v166, v166
    v_exp_f32 v167, v167
    s_waitcnt lgkmcnt(4)
    v_mfma_f32_32x32x16_bf16 v[128:143], v[200:203], v[100:103], v[128:143]
    ds_read_b128 v[200:203], v0 offset:32768
    s_add_u32 s34, s60, 22528
    buffer_load_dwordx4 a[176:179], v0, s[4:7], s34 offen sc1
    buffer_load_dwordx4 a[184:187], v0, s[4:7], s34 offen offset:1024 sc1
    v_fma_f32 v160, v160, v219, v219
    v_fma_f32 v161, v161, v219, v219
    s_waitcnt lgkmcnt(4)
    v_mfma_f32_32x32x16_bf16 v[128:143], v[204:207], v[104:107], v[128:143]
    ds_read_b128 v[204:207], v0 offset:33792
    v_fma_f32 v162, v162, v219, v219
    v_fma_f32 v163, v163, v219, v219
    v_fma_f32 v164, v164, v219, v219
    v_fma_f32 v165, v165, v219, v219
    s_waitcnt lgkmcnt(4)
    v_mfma_f32_32x32x16_bf16 v[128:143], v[208:211], v[108:111], v[128:143]
    ds_read_b128 v[208:211], v4 offset:3584
    v_fma_f32 v166, v166, v219, v219
    v_fma_f32 v167, v167, v219, v219
    v_rcp_f32 v160, v160
    s_waitcnt lgkmcnt(4)
    v_mfma_f32_32x32x16_bf16 v[128:143], v[192:195], v[112:115], v[128:143]
    ds_read_b128 v[192:195], v0 offset:34816
    v_rcp_f32 v161, v161
    v_rcp_f32 v162, v162
    s_waitcnt lgkmcnt(4)
    v_mfma_f32_32x32x16_bf16 v[128:143], v[196:199], v[116:119], v[128:143]
    ds_read_b128 v[196:199], v0 offset:35840
    v_rcp_f32 v163, v163
    v_rcp_f32 v164, v164
    s_waitcnt lgkmcnt(4)
    v_mfma_f32_32x32x16_bf16 v[128:143], v[200:203], v[120:123], v[128:143]
    ds_read_b128 v[200:203], v0 offset:36864
    s_add_u32 s34, s60, 24576
    buffer_load_dwordx4 a[192:195], v0, s[4:7], s34 offen sc1
    buffer_load_dwordx4 a[200:203], v0, s[4:7], s34 offen offset:1024 sc1
    v_rcp_f32 v165, v165
    s_waitcnt lgkmcnt(4)
    v_mfma_f32_32x32x16_bf16 v[128:143], v[204:207], v[124:127], v[128:143]
    ds_read_b128 v[204:207], v0 offset:37888
    v_rcp_f32 v166, v166
    v_rcp_f32 v167, v167
    s_waitcnt lgkmcnt(4)
    v_mfma_f32_32x32x16_bf16 v[128:143], v[208:211], v[212:215], v[128:143]
    ds_read_b128 v[208:211], v0 offset:38912
    v_mul_f32 v160, v160, v168
    v_mul_f32 v161, v161, v169
    v_mul_f32 v162, v162, v170
    v_mul_f32 v163, v163, v171
    s_waitcnt lgkmcnt(4)
    v_mfma_f32_32x32x16_bf16 v[144:159], v[192:195], v[16:19], 0
    ds_read_b128 v[192:195], v0 offset:39936
    v_mul_f32 v164, v164, v172
    v_mul_f32 v165, v165, v173
    v_mul_f32 v166, v166, v174
    v_mul_f32 v167, v167, v175
    s_waitcnt lgkmcnt(4)
    v_mfma_f32_32x32x16_bf16 v[144:159], v[196:199], v[20:23], v[144:159]
    ds_read_b128 v[196:199], v0 offset:40960
    v_cvt_pk_bf16_f32 v160, v160, v161
    v_cvt_pk_bf16_f32 v161, v162, v163
    v_cvt_pk_bf16_f32 v162, v164, v165
    v_cvt_pk_bf16_f32 v163, v166, v167
    s_waitcnt lgkmcnt(4)
    v_mfma_f32_32x32x16_bf16 v[144:159], v[200:203], v[24:27], v[144:159]
    ds_read_b128 v[200:203], v0 offset:41984
    s_add_u32 s34, s60, 26624
    buffer_load_dwordx4 a[208:211], v0, s[4:7], s34 offen sc1
    buffer_load_dwordx4 a[216:219], v0, s[4:7], s34 offen offset:1024 sc1
    buffer_store_dwordx4 v[160:163], v0, s[4:7], s39 offen offset:2048 sc1
    s_waitcnt lgkmcnt(4)
    v_mfma_f32_32x32x16_bf16 v[144:159], v[204:207], v[28:31], v[144:159]
    ds_read_b128 v[204:207], v0 offset:43008
    v_mul_f32 v184, v176, v184
    v_mul_f32 v176, v217, v176
    v_mul_f32 v185, v177, v185
    v_mul_f32 v177, v217, v177
    s_waitcnt lgkmcnt(4)
    v_mfma_f32_32x32x16_bf16 v[144:159], v[208:211], v[32:35], v[144:159]
    ds_read_b128 v[208:211], v0 offset:44032
    v_mul_f32 v186, v178, v186
    v_mul_f32 v178, v217, v178
    v_mul_f32 v187, v179, v187
    v_mul_f32 v179, v217, v179
    s_waitcnt lgkmcnt(4)
    v_mfma_f32_32x32x16_bf16 v[144:159], v[192:195], v[36:39], v[144:159]
    ds_read_b128 v[192:195], v0 offset:45056
    v_mul_f32 v188, v180, v188
    v_mul_f32 v180, v217, v180
    v_mul_f32 v189, v181, v189
    v_mul_f32 v181, v217, v181
    s_waitcnt lgkmcnt(4)
    v_mfma_f32_32x32x16_bf16 v[144:159], v[196:199], v[40:43], v[144:159]
    ds_read_b128 v[196:199], v0 offset:46080
    v_mul_f32 v190, v182, v190
    v_mul_f32 v182, v217, v182
    v_mul_f32 v191, v183, v191
    v_mul_f32 v183, v217, v183
    s_waitcnt lgkmcnt(4)
    v_mfma_f32_32x32x16_bf16 v[144:159], v[200:203], v[44:47], v[144:159]
    ds_read_b128 v[200:203], v0 offset:47104
    s_add_u32 s34, s61, 16384
    buffer_load_dwordx4 a[132:135], v0, s[4:7], s34 offen sc1
    buffer_load_dwordx4 a[140:143], v0, s[4:7], s34 offen offset:1024 sc1
    v_exp_f32 v176, v176
    s_waitcnt lgkmcnt(4)
    v_mfma_f32_32x32x16_bf16 v[144:159], v[204:207], v[48:51], v[144:159]
    ds_read_b128 v[204:207], v0 offset:48128
    v_exp_f32 v177, v177
    v_exp_f32 v178, v178
    s_waitcnt vmcnt(16)
    s_barrier
    s_mul_i32 s37, s14, 14336
    s_add_u32 s38, s48, s37
    s_waitcnt lgkmcnt(4)
    v_mfma_f32_32x32x16_bf16 v[144:159], v[208:211], v[52:55], v[144:159]
    ds_read_b128 v[208:211], v0 offset:49152
    v_exp_f32 v179, v179
    v_exp_f32 v180, v180
    s_waitcnt lgkmcnt(4)
    v_mfma_f32_32x32x16_bf16 v[144:159], v[192:195], v[56:59], v[144:159]
    ds_read_b128 v[192:195], v0 offset:50176
    s_add_u32 s34, s38, 0
    s_add_u32 m0, s37, 100352
    s_nop 0
    buffer_load_dwordx4 v0, s[4:7], s34 offen offset:0 sc1 lds
    v_exp_f32 v181, v181
    s_waitcnt lgkmcnt(4)
    v_mfma_f32_32x32x16_bf16 v[144:159], v[196:199], v[60:63], v[144:159]
    ds_read_b128 v[196:199], v0 offset:51200
    v_exp_f32 v182, v182
    v_exp_f32 v183, v183
    s_waitcnt lgkmcnt(4)
    v_mfma_f32_32x32x16_bf16 v[144:159], v[200:203], v[64:67], v[144:159]
    ds_read_b128 v[200:203], v0 offset:52224
    s_add_u32 s34, s61, 18432
    buffer_load_dwordx4 a[148:151], v0, s[4:7], s34 offen sc1
    buffer_load_dwordx4 a[156:159], v0, s[4:7], s34 offen offset:1024 sc1
    v_fma_f32 v176, v176, v219, v219
    v_fma_f32 v177, v177, v219, v219
    s_waitcnt lgkmcnt(4)
    v_mfma_f32_32x32x16_bf16 v[144:159], v[204:207], v[68:71], v[144:159]
    ds_read_b128 v[204:207], v0 offset:53248
    s_add_u32 s34, s38, 1024
    s_add_u32 m0, s37, 101376
    s_nop 0
    buffer_load_dwordx4 v0, s[4:7], s34 offen offset:0 sc1 lds
    v_fma_f32 v178, v178, v219, v219
    v_fma_f32 v179, v179, v219, v219
    s_waitcnt lgkmcnt(4)
    v_mfma_f32_32x32x16_bf16 v[144:159], v[208:211], v[72:75], v[144:159]
    ds_read_b128 v[208:211], v0 offset:54272
    v_fma_f32 v180, v180, v219, v219
    v_fma_f32 v181, v181, v219, v219
    v_fma_f32 v182, v182, v219, v219
    v_fma_f32 v183, v183, v219, v219
    s_waitcnt lgkmcnt(4)
    v_mfma_f32_32x32x16_bf16 v[144:159], v[192:195], v[76:79], v[144:159]
    ds_read_b128 v[192:195], v0 offset:55296
    v_rcp_f32 v176, v176
    v_rcp_f32 v177, v177
    s_waitcnt lgkmcnt(4)
    v_mfma_f32_32x32x16_bf16 v[144:159], v[196:199], v[80:83], v[144:159]
    ds_read_b128 v[196:199], v0 offset:56320
    s_add_u32 s34, s38, 2048
    s_add_u32 m0, s37, 102400
    s_nop 0
    buffer_load_dwordx4 v0, s[4:7], s34 offen offset:0 sc1 lds
    v_rcp_f32 v178, v178
    s_waitcnt lgkmcnt(4)
    v_mfma_f32_32x32x16_bf16 v[144:159], v[200:203], v[84:87], v[144:159]
    ds_read_b128 v[200:203], v0 offset:57344
    s_add_u32 s34, s61, 20480
    buffer_load_dwordx4 a[164:167], v0, s[4:7], s34 offen sc1
    buffer_load_dwordx4 a[172:175], v0, s[4:7], s34 offen offset:1024 sc1
    v_rcp_f32 v179, v179
    s_waitcnt lgkmcnt(4)
    v_mfma_f32_32x32x16_bf16 v[144:159], v[204:207], v[88:91], v[144:159]
    ds_read_b128 v[204:207], v0 offset:58368
    v_rcp_f32 v180, v180
    v_rcp_f32 v181, v181
    s_waitcnt lgkmcnt(4)
    v_mfma_f32_32x32x16_bf16 v[144:159], v[208:211], v[92:95], v[144:159]
    ds_read_b128 v[208:211], v0 offset:59392
    s_add_u32 s34, s38, 3072
    s_add_u32 m0, s37, 103424
    s_nop 0
    buffer_load_dwordx4 v0, s[4:7], s34 offen offset:0 sc1 lds
    v_rcp_f32 v182, v182
    s_waitcnt lgkmcnt(4)
    v_mfma_f32_32x32x16_bf16 v[144:159], v[192:195], v[96:99], v[144:159]
    ds_read_b128 v[192:195], v0 offset:60416
    v_rcp_f32 v183, v183
    v_mul_f32 v176, v176, v184
    v_mul_f32 v177, v177, v185
    s_waitcnt lgkmcnt(4)
    v_mfma_f32_32x32x16_bf16 v[144:159], v[196:199], v[100:103], v[144:159]
    ds_read_b128 v[196:199], v0 offset:61440
    v_mul_f32 v178, v178, v186
    v_mul_f32 v179, v179, v187
    v_mul_f32 v180, v180, v188
    v_mul_f32 v181, v181, v189
    s_waitcnt lgkmcnt(4)
    v_mfma_f32_32x32x16_bf16 v[144:159], v[200:203], v[104:107], v[144:159]
    ds_read_b128 v[200:203], v0 offset:62464
    s_add_u32 s34, s38, 4096
    s_add_u32 m0, s37, 104448
    s_nop 0
    buffer_load_dwordx4 v0, s[4:7], s34 offen offset:0 sc1 lds
    v_mul_f32 v182, v182, v190
    v_mul_f32 v183, v183, v191
    s_waitcnt lgkmcnt(4)
    v_mfma_f32_32x32x16_bf16 v[144:159], v[204:207], v[108:111], v[144:159]
    ds_read_b128 v[204:207], v4 offset:4096
    s_add_u32 s34, s61, 22528
    buffer_load_dwordx4 a[180:183], v0, s[4:7], s34 offen sc1
    buffer_load_dwordx4 a[188:191], v0, s[4:7], s34 offen offset:1024 sc1
    v_cvt_pk_bf16_f32 v176, v176, v177
    v_cvt_pk_bf16_f32 v177, v178, v179
    s_waitcnt lgkmcnt(4)
    v_mfma_f32_32x32x16_bf16 v[144:159], v[208:211], v[112:115], v[144:159]
    ds_read_b128 v[208:211], v0 offset:63488
    v_cvt_pk_bf16_f32 v178, v180, v181
    v_cvt_pk_bf16_f32 v179, v182, v183
    buffer_store_dwordx4 v[176:179], v0, s[4:7], s39 offen offset:3072 sc1
    s_waitcnt lgkmcnt(4)
    v_mfma_f32_32x32x16_bf16 v[144:159], v[192:195], v[116:119], v[144:159]
    ds_read_b128 v[192:195], v0 offset:64512
    s_add_u32 s34, s38, 5120
    s_add_u32 m0, s37, 105472
    s_nop 0
    buffer_load_dwordx4 v0, s[4:7], s34 offen offset:0 sc1 lds
    v_mul_f32 v136, v128, v136
    v_mul_f32 v128, v217, v128
    s_waitcnt lgkmcnt(4)
    v_mfma_f32_32x32x16_bf16 v[144:159], v[196:199], v[120:123], v[144:159]
    ds_read_b128 v[196:199], v1 offset:0
    v_mul_f32 v137, v129, v137
    v_mul_f32 v129, v217, v129
    v_mul_f32 v138, v130, v138
    v_mul_f32 v130, v217, v130
    s_waitcnt lgkmcnt(4)
    v_mfma_f32_32x32x16_bf16 v[144:159], v[200:203], v[124:127], v[144:159]
    ds_read_b128 v[200:203], v1 offset:1024
    s_add_u32 s34, s61, 24576
    buffer_load_dwordx4 a[196:199], v0, s[4:7], s34 offen sc1
    buffer_load_dwordx4 a[204:207], v0, s[4:7], s34 offen offset:1024 sc1
    v_mul_f32 v139, v131, v139
    v_mul_f32 v131, v217, v131
    s_waitcnt lgkmcnt(4)
    v_mfma_f32_32x32x16_bf16 v[144:159], v[204:207], v[212:215], v[144:159]
    ds_read_b128 v[204:207], v1 offset:2048
    s_add_u32 s34, s38, 6144
    s_add_u32 m0, s37, 106496
    s_nop 0
    buffer_load_dwordx4 v0, s[4:7], s34 offen offset:0 sc1 lds
    v_mul_f32 v140, v132, v140
    v_mul_f32 v132, v217, v132
    s_waitcnt lgkmcnt(4)
    v_mfma_f32_32x32x16_bf16 v[160:175], v[208:211], v[16:19], 0
    ds_read_b128 v[208:211], v1 offset:3072
    v_mul_f32 v141, v133, v141
    v_mul_f32 v133, v217, v133
    v_mul_f32 v142, v134, v142
    v_mul_f32 v134, v217, v134
    s_waitcnt lgkmcnt(4)
    v_mfma_f32_32x32x16_bf16 v[160:175], v[192:195], v[20:23], v[160:175]
    ds_read_b128 v[192:195], v1 offset:4096
    v_mul_f32 v143, v135, v143
    v_mul_f32 v135, v217, v135
    v_exp_f32 v128, v128
    s_waitcnt lgkmcnt(4)
    v_mfma_f32_32x32x16_bf16 v[160:175], v[196:199], v[24:27], v[160:175]
    ds_read_b128 v[196:199], v1 offset:5120
    s_add_u32 s34, s38, 7168
    s_add_u32 m0, s37, 107520
    s_nop 0
    buffer_load_dwordx4 v0, s[4:7], s34 offen offset:0 sc1 lds
    v_exp_f32 v129, v129
    s_waitcnt lgkmcnt(4)
    v_mfma_f32_32x32x16_bf16 v[160:175], v[200:203], v[28:31], v[160:175]
    ds_read_b128 v[200:203], v1 offset:6144
    s_add_u32 s34, s61, 26624
    buffer_load_dwordx4 a[212:215], v0, s[4:7], s34 offen sc1
    buffer_load_dwordx4 a[220:223], v0, s[4:7], s34 offen offset:1024 sc1
    v_exp_f32 v130, v130
    s_waitcnt lgkmcnt(4)
    v_mfma_f32_32x32x16_bf16 v[160:175], v[204:207], v[32:35], v[160:175]
    ds_read_b128 v[204:207], v1 offset:7168
    v_exp_f32 v131, v131
    v_exp_f32 v132, v132
    s_waitcnt lgkmcnt(4)
    v_mfma_f32_32x32x16_bf16 v[160:175], v[208:211], v[36:39], v[160:175]
    ds_read_b128 v[208:211], v1 offset:8192
    s_add_u32 s34, s38, 8192
    s_add_u32 m0, s37, 108544
    s_nop 0
    buffer_load_dwordx4 v0, s[4:7], s34 offen offset:0 sc1 lds
    v_exp_f32 v133, v133
    s_waitcnt lgkmcnt(4)
    v_mfma_f32_32x32x16_bf16 v[160:175], v[192:195], v[40:43], v[160:175]
    ds_read_b128 v[192:195], v1 offset:9216
    v_exp_f32 v134, v134
    v_exp_f32 v135, v135
    s_waitcnt lgkmcnt(4)
    v_mfma_f32_32x32x16_bf16 v[160:175], v[196:199], v[44:47], v[160:175]
    ds_read_b128 v[196:199], v1 offset:10240
    v_fma_f32 v128, v128, v219, v219
    v_fma_f32 v129, v129, v219, v219
    v_fma_f32 v130, v130, v219, v219
    v_fma_f32 v131, v131, v219, v219
    s_waitcnt lgkmcnt(4)
    v_mfma_f32_32x32x16_bf16 v[160:175], v[200:203], v[48:51], v[160:175]
    ds_read_b128 v[200:203], v1 offset:11264
    s_add_u32 s34, s38, 9216
    s_add_u32 m0, s37, 109568
    s_nop 0
    buffer_load_dwordx4 v0, s[4:7], s34 offen offset:0 sc1 lds
    v_fma_f32 v132, v132, v219, v219
    v_fma_f32 v133, v133, v219, v219
    s_waitcnt lgkmcnt(4)
    v_mfma_f32_32x32x16_bf16 v[160:175], v[204:207], v[52:55], v[160:175]
    ds_read_b128 v[204:207], v1 offset:12288
    v_fma_f32 v134, v134, v219, v219
    v_fma_f32 v135, v135, v219, v219
    v_rcp_f32 v128, v128
    s_waitcnt lgkmcnt(4)
    v_mfma_f32_32x32x16_bf16 v[160:175], v[208:211], v[56:59], v[160:175]
    ds_read_b128 v[208:211], v1 offset:13312
    v_rcp_f32 v129, v129
    v_rcp_f32 v130, v130
    s_waitcnt lgkmcnt(4)
    v_mfma_f32_32x32x16_bf16 v[160:175], v[192:195], v[60:63], v[160:175]
    ds_read_b128 v[192:195], v1 offset:14336
    s_add_u32 s34, s38, 10240
    s_add_u32 m0, s37, 110592
    s_nop 0
    buffer_load_dwordx4 v0, s[4:7], s34 offen offset:0 sc1 lds
    v_rcp_f32 v131, v131
    s_waitcnt lgkmcnt(4)
    v_mfma_f32_32x32x16_bf16 v[160:175], v[196:199], v[64:67], v[160:175]
    ds_read_b128 v[196:199], v1 offset:15360
    v_rcp_f32 v132, v132
    v_rcp_f32 v133, v133
    s_waitcnt lgkmcnt(4)
    v_mfma_f32_32x32x16_bf16 v[160:175], v[200:203], v[68:71], v[160:175]
    ds_read_b128 v[200:203], v1 offset:16384
    v_rcp_f32 v134, v134
    v_rcp_f32 v135, v135
    s_waitcnt lgkmcnt(4)
    v_mfma_f32_32x32x16_bf16 v[160:175], v[204:207], v[72:75], v[160:175]
    ds_read_b128 v[204:207], v1 offset:17408
    s_add_u32 s34, s38, 11264
    s_add_u32 m0, s37, 111616
    s_nop 0
    buffer_load_dwordx4 v0, s[4:7], s34 offen offset:0 sc1 lds
    v_mul_f32 v128, v128, v136
    v_mul_f32 v129, v129, v137
    s_waitcnt lgkmcnt(4)
    v_mfma_f32_32x32x16_bf16 v[160:175], v[208:211], v[76:79], v[160:175]
    ds_read_b128 v[208:211], v1 offset:18432
    v_mul_f32 v130, v130, v138
    v_mul_f32 v131, v131, v139
    v_mul_f32 v132, v132, v140
    v_mul_f32 v133, v133, v141
    s_waitcnt lgkmcnt(4)
    v_mfma_f32_32x32x16_bf16 v[160:175], v[192:195], v[80:83], v[160:175]
    ds_read_b128 v[192:195], v1 offset:19456
    v_mul_f32 v134, v134, v142
    v_mul_f32 v135, v135, v143
    v_cvt_pk_bf16_f32 v128, v128, v129
    v_cvt_pk_bf16_f32 v129, v130, v131
    s_waitcnt lgkmcnt(4)
    v_mfma_f32_32x32x16_bf16 v[160:175], v[196:199], v[84:87], v[160:175]
    ds_read_b128 v[196:199], v1 offset:20480
    s_add_u32 s34, s38, 12288
    s_add_u32 m0, s37, 112640
    s_nop 0
    buffer_load_dwordx4 v0, s[4:7], s34 offen offset:0 sc1 lds
    v_cvt_pk_bf16_f32 v130, v132, v133
    v_cvt_pk_bf16_f32 v131, v134, v135
    s_add_u32 s39, s28, 4096
    s_waitcnt lgkmcnt(4)
    v_mfma_f32_32x32x16_bf16 v[160:175], v[200:203], v[88:91], v[160:175]
    ds_read_b128 v[200:203], v1 offset:21504
    buffer_store_dwordx4 v[128:131], v0, s[4:7], s39 offen offset:0 sc1
    v_mul_f32 v152, v144, v152
    v_mul_f32 v144, v217, v144
    s_waitcnt lgkmcnt(4)
    v_mfma_f32_32x32x16_bf16 v[160:175], v[204:207], v[92:95], v[160:175]
    ds_read_b128 v[204:207], v1 offset:22528
    v_mul_f32 v153, v145, v153
    v_mul_f32 v145, v217, v145
    v_mul_f32 v154, v146, v154
    v_mul_f32 v146, v217, v146
    s_waitcnt lgkmcnt(4)
    v_mfma_f32_32x32x16_bf16 v[160:175], v[208:211], v[96:99], v[160:175]
    ds_read_b128 v[208:211], v1 offset:23552
    s_add_u32 s34, s38, 13312
    s_add_u32 m0, s37, 113664
    s_nop 0
    buffer_load_dwordx4 v0, s[4:7], s34 offen offset:0 sc1 lds
    v_mul_f32 v155, v147, v155
    v_mul_f32 v147, v217, v147
    s_waitcnt lgkmcnt(4)
    v_mfma_f32_32x32x16_bf16 v[160:175], v[192:195], v[100:103], v[160:175]
    ds_read_b128 v[192:195], v1 offset:24576
    v_mul_f32 v156, v148, v156
    v_mul_f32 v148, v217, v148
    v_mul_f32 v157, v149, v157
    v_mul_f32 v149, v217, v149
    s_waitcnt lgkmcnt(4)
    v_mfma_f32_32x32x16_bf16 v[160:175], v[196:199], v[104:107], v[160:175]
    ds_read_b128 v[196:199], v1 offset:25600
    v_mul_f32 v158, v150, v158
    v_mul_f32 v150, v217, v150
    v_mul_f32 v159, v151, v159
    v_mul_f32 v151, v217, v151
    s_waitcnt lgkmcnt(4)
    v_mfma_f32_32x32x16_bf16 v[160:175], v[200:203], v[108:111], v[160:175]
    ds_read_b128 v[200:203], v4 offset:4608
    v_exp_f32 v144, v144
    v_exp_f32 v145, v145
    s_waitcnt lgkmcnt(4)
    v_mfma_f32_32x32x16_bf16 v[160:175], v[204:207], v[112:115], v[160:175]
    v_exp_f32 v146, v146
    v_exp_f32 v147, v147
    s_waitcnt lgkmcnt(3)
    v_mfma_f32_32x32x16_bf16 v[160:175], v[208:211], v[116:119], v[160:175]
    v_exp_f32 v148, v148
    v_exp_f32 v149, v149
    s_waitcnt lgkmcnt(2)
    v_mfma_f32_32x32x16_bf16 v[160:175], v[192:195], v[120:123], v[160:175]
    v_exp_f32 v150, v150
    v_exp_f32 v151, v151
    v_fma_f32 v144, v144, v219, v219
    s_waitcnt lgkmcnt(1)
    v_mfma_f32_32x32x16_bf16 v[160:175], v[196:199], v[124:127], v[160:175]
    v_fma_f32 v145, v145, v219, v219
    v_fma_f32 v146, v146, v219, v219
    v_fma_f32 v147, v147, v219, v219
    v_fma_f32 v148, v148, v219, v219
    v_fma_f32 v149, v149, v219, v219
    s_waitcnt lgkmcnt(0)
    v_mfma_f32_32x32x16_bf16 v[160:175], v[200:203], v[212:215], v[160:175]
    v_fma_f32 v150, v150, v219, v219
    v_fma_f32 v151, v151, v219, v219
    v_rcp_f32 v144, v144
    v_rcp_f32 v145, v145
    v_rcp_f32 v146, v146
    v_rcp_f32 v147, v147
    v_rcp_f32 v148, v148
    v_rcp_f32 v149, v149
    v_rcp_f32 v150, v150
    v_rcp_f32 v151, v151
    v_mul_f32 v144, v144, v152
    v_mul_f32 v145, v145, v153
    v_mul_f32 v146, v146, v154
    v_mul_f32 v147, v147, v155
    v_mul_f32 v148, v148, v156
    v_mul_f32 v149, v149, v157
    v_mul_f32 v150, v150, v158
    v_mul_f32 v151, v151, v159
    v_cvt_pk_bf16_f32 v144, v144, v145
    v_cvt_pk_bf16_f32 v145, v146, v147
    v_cvt_pk_bf16_f32 v146, v148, v149
    v_cvt_pk_bf16_f32 v147, v150, v151
    buffer_store_dwordx4 v[144:147], v0, s[96:99], s39 offen offset:1024
    buffer_store_dwordx4 v[144:147], v0, s[0:3], s39 offen offset:1024 sc1
    v_mul_f32 v168, v160, v168
    v_mul_f32 v160, v217, v160
    v_mul_f32 v169, v161, v169
    v_mul_f32 v161, v217, v161
    v_mul_f32 v170, v162, v170
    v_mul_f32 v162, v217, v162
    v_mul_f32 v171, v163, v171
    v_mul_f32 v163, v217, v163
    v_mul_f32 v172, v164, v172
    v_mul_f32 v164, v217, v164
    v_mul_f32 v173, v165, v173
    v_mul_f32 v165, v217, v165
    v_mul_f32 v174, v166, v174
    v_mul_f32 v166, v217, v166
    v_mul_f32 v175, v167, v175
    v_mul_f32 v167, v217, v167
    v_exp_f32 v160, v160
    v_exp_f32 v161, v161
    v_exp_f32 v162, v162
    v_exp_f32 v163, v163
    v_exp_f32 v164, v164
    v_exp_f32 v165, v165
    v_exp_f32 v166, v166
    v_exp_f32 v167, v167
    v_fma_f32 v160, v160, v219, v219
    v_fma_f32 v161, v161, v219, v219
    v_fma_f32 v162, v162, v219, v219
    v_fma_f32 v163, v163, v219, v219
    v_fma_f32 v164, v164, v219, v219
    v_fma_f32 v165, v165, v219, v219
    v_fma_f32 v166, v166, v219, v219
    v_fma_f32 v167, v167, v219, v219
    v_rcp_f32 v160, v160
    v_rcp_f32 v161, v161
    v_rcp_f32 v162, v162
    v_rcp_f32 v163, v163
    v_rcp_f32 v164, v164
    v_rcp_f32 v165, v165
    v_rcp_f32 v166, v166
    v_rcp_f32 v167, v167
    v_mul_f32 v160, v160, v168
    v_mul_f32 v161, v161, v169
    v_mul_f32 v162, v162, v170
    v_mul_f32 v163, v163, v171
    v_mul_f32 v164, v164, v172
    v_mul_f32 v165, v165, v173
    v_mul_f32 v166, v166, v174
    v_mul_f32 v167, v167, v175
    v_cvt_pk_bf16_f32 v160, v160, v161
    v_cvt_pk_bf16_f32 v161, v162, v163
    v_cvt_pk_bf16_f32 v162, v164, v165
    v_cvt_pk_bf16_f32 v163, v166, v167
    buffer_store_dwordx4 v[160:163], v0, s[96:99], s39 offen offset:2048
    buffer_store_dwordx4 v[160:163], v0, s[0:3], s39 offen offset:2048 sc1
    s_waitcnt vmcnt(0) lgkmcnt(0)
    s_barrier
    s_cmp_eq_u32 s14, 0
    s_cbranch_scc0 Loth_43
    s_add_u32 s34, s30, 8192
    v_mov_b32 v220, s100
    v_mov_b32 v221, s101
    s_mov_b64 exec, 1
    buffer_store_dwordx2 v[220:221], v0, s[96:99], s34 offen
    buffer_store_dwordx2 v[220:221], v0, s[0:3], s34 offen sc1
    s_mov_b64 exec, -1
    s_branch Ljoin_44
Loth_43:
    s_mul_i32 s37, s50, 10240
    s_add_u32 s38, s48, s37
    s_add_u32 s34, s38, 55296
    s_add_u32 m0, s37, 69632
    s_nop 0
    buffer_load_dwordx4 v0, s[4:7], s34 offen offset:0 sc1 lds
    buffer_load_dwordx4 v0, s[4:7], s34 offen offset:1024 sc1 lds
    buffer_load_dwordx4 v0, s[4:7], s34 offen offset:2048 sc1 lds
    buffer_load_dwordx4 v0, s[4:7], s34 offen offset:3072 sc1 lds
    s_add_u32 s34, s38, 59392
    s_add_u32 m0, s37, 73728
    s_nop 0
    buffer_load_dwordx4 v0, s[4:7], s34 offen offset:0 sc1 lds
    buffer_load_dwordx4 v0, s[4:7], s34 offen offset:1024 sc1 lds
    buffer_load_dwordx4 v0, s[4:7], s34 offen offset:2048 sc1 lds
    buffer_load_dwordx4 v0, s[4:7], s34 offen offset:3072 sc1 lds
    s_add_u32 s34, s38, 63488
    s_add_u32 m0, s37, 77824
    s_nop 0
    buffer_load_dwordx4 v0, s[4:7], s34 offen offset:0 sc1 lds
    buffer_load_dwordx4 v0, s[4:7], s34 offen offset:1024 sc1 lds
Ljoin_44:
    s_cmp_ge_u32 s13, 14
    s_cbranch_scc1 Lp5end_42
    v_lshlrev_b32 v16, 16, v8
    v_and_b32 v17, 0xffff0000, v8
    v_lshlrev_b32 v18, 16, v9
    v_and_b32 v19, 0xffff0000, v9
    v_lshlrev_b32 v20, 16, v10
    v_and_b32 v21, 0xffff0000, v10
    v_lshlrev_b32 v22, 16, v11
    v_and_b32 v23, 0xffff0000, v11
    v_lshlrev_b32 v24, 16, v12
    v_and_b32 v25, 0xffff0000, v12
    v_lshlrev_b32 v26, 16, v13
    v_and_b32 v27, 0xffff0000, v13
    v_lshlrev_b32 v28, 16, v14
    v_and_b32 v29, 0xffff0000, v14
    v_lshlrev_b32 v30, 16, v15
    v_and_b32 v31, 0xffff0000, v15
    s_xor_b32 s34, s14, 1
    s_mul_i32 s34, s34, 12288
    s_add_u32 s34, s34, 0
    v_add_u32 v208, s34, v0
    s_xor_b32 s34, s14, 2
    s_mul_i32 s34, s34, 12288
    s_add_u32 s34, s34, 4096
    v_add_u32 v209, s34, v0
    s_xor_b32 s34, s14, 3
    s_mul_i32 s34, s34, 12288
    s_add_u32 s34, s34, 8192
    v_add_u32 v210, s34, v0
    s_mul_i32 s34, s14, 12288
    v_add_u32 v211, s34, v0
    v_mov_b32 v212, 0
    v_mov_b32 v213, 0
    v_mov_b32 v214, 0
    v_mov_b32 v215, 0
    v_mov_b32 v216, 0x3f803f80
    v_and_b32 v217, 0xf8, v7
    s_cmp_eq_u32 s14, 0
    s_cbranch_scc0 Loth_45
    s_add_u32 s34, s29, 8192
    s_mov_b32 exec_lo, 0xffff
    s_mov_b32 exec_hi, 0
Lpoll_47:
    buffer_load_dwordx2 v[220:221], v7, s[4:7], s34 offen sc1
    s_waitcnt vmcnt(0)
    s_waitcnt vmcnt(0)
    v_cmp_eq_u64 vcc, s[100:101], v[220:221]
    s_sub_u32 s33, s33, 1
    s_cmp_eq_u32 s33, 0
    s_cbranch_scc1 main_done
    s_cmp_eq_u64 vcc, exec
    s_cbranch_scc0 Lpoll_47
    s_mov_b64 exec, -1
Loth_45:
    s_barrier
    s_add_u32 s36, s24, 0
    buffer_load_dwordx4 v[80:83], v0, s[4:7], s36 offen offset:0 sc1
    s_add_u32 s37, s25, 0
    buffer_load_dwordx4 v[84:87], v0, s[4:7], s37 offen offset:0 sc1
    buffer_load_dwordx4 v[88:91], v0, s[4:7], s36 offen offset:1024 sc1
    buffer_load_dwordx4 v[92:95], v0, s[4:7], s37 offen offset:1024 sc1
    buffer_load_dwordx4 v[96:99], v0, s[4:7], s36 offen offset:2048 sc1
    buffer_load_dwordx4 v[100:103], v0, s[4:7], s37 offen offset:2048 sc1
    buffer_load_dwordx4 v[104:107], v0, s[4:7], s36 offen offset:3072 sc1
    buffer_load_dwordx4 v[108:111], v0, s[4:7], s37 offen offset:3072 sc1
    s_add_u32 s36, s24, 4096
    buffer_load_dwordx4 v[112:115], v0, s[4:7], s36 offen offset:0 sc1
    s_add_u32 s37, s25, 4096
    buffer_load_dwordx4 v[116:119], v0, s[4:7], s37 offen offset:0 sc1
    s_waitcnt vmcnt(9)
    v_mfma_f32_32x32x16_bf16 v[32:47], a[4:7], v[80:83], 0
    buffer_load_dwordx4 v[120:123], v0, s[4:7], s36 offen offset:1024 sc1
    v_mfma_f32_32x32x16_bf16 v[16:31], a[0:3], v[80:83], v[16:31]
    s_waitcnt vmcnt(9)
    v_mfma_f32_32x32x16_bf16 v[48:63], a[0:3], v[84:87], 0
    buffer_load_dwordx4 v[124:127], v0, s[4:7], s37 offen offset:1024 sc1
    v_mfma_f32_32x32x16_bf16 v[64:79], a[4:7], v[84:87], 0
    s_waitcnt vmcnt(9)
    v_mfma_f32_32x32x16_bf16 v[32:47], a[12:15], v[88:91], v[32:47]
    buffer_load_dwordx4 v[128:131], v0, s[4:7], s36 offen offset:2048 sc1
    v_mfma_f32_32x32x16_bf16 v[16:31], a[8:11], v[88:91], v[16:31]
    s_waitcnt vmcnt(9)
    v_mfma_f32_32x32x16_bf16 v[48:63], a[8:11], v[92:95], v[48:63]
    buffer_load_dwordx4 v[132:135], v0, s[4:7], s37 offen offset:2048 sc1
    v_mfma_f32_32x32x16_bf16 v[64:79], a[12:15], v[92:95], v[64:79]
    s_waitcnt vmcnt(9)
    v_mfma_f32_32x32x16_bf16 v[32:47], a[20:23], v[96:99], v[32:47]
    buffer_load_dwordx4 v[136:139], v0, s[4:7], s36 offen offset:3072 sc1
    v_mfma_f32_32x32x16_bf16 v[16:31], a[16:19], v[96:99], v[16:31]
    s_waitcnt vmcnt(9)
    v_mfma_f32_32x32x16_bf16 v[48:63], a[16:19], v[100:103], v[48:63]
    buffer_load_dwordx4 v[140:143], v0, s[4:7], s37 offen offset:3072 sc1
    v_mfma_f32_32x32x16_bf16 v[64:79], a[20:23], v[100:103], v[64:79]
    s_waitcnt vmcnt(9)
    v_mfma_f32_32x32x16_bf16 v[32:47], a[28:31], v[104:107], v[32:47]
    s_add_u32 s36, s24, 8192
    buffer_load_dwordx4 v[144:147], v0, s[4:7], s36 offen offset:0 sc1
    v_mfma_f32_32x32x16_bf16 v[16:31], a[24:27], v[104:107], v[16:31]
    s_waitcnt vmcnt(9)
    v_mfma_f32_32x32x16_bf16 v[48:63], a[24:27], v[108:111], v[48:63]
    s_add_u32 s37, s25, 8192
    buffer_load_dwordx4 v[148:151], v0, s[4:7], s37 offen offset:0 sc1
    v_mfma_f32_32x32x16_bf16 v[64:79], a[28:31], v[108:111], v[64:79]
    s_waitcnt vmcnt(9)
    v_mfma_f32_32x32x16_bf16 v[32:47], a[36:39], v[112:115], v[32:47]
    buffer_load_dwordx4 v[152:155], v0, s[4:7], s36 offen offset:1024 sc1
    v_mfma_f32_32x32x16_bf16 v[16:31], a[32:35], v[112:115], v[16:31]
    s_waitcnt vmcnt(9)
    v_mfma_f32_32x32x16_bf16 v[48:63], a[32:35], v[116:119], v[48:63]
    buffer_load_dwordx4 v[156:159], v0, s[4:7], s37 offen offset:1024 sc1
    v_mfma_f32_32x32x16_bf16 v[64:79], a[36:39], v[116:119], v[64:79]
    s_waitcnt vmcnt(9)
    v_mfma_f32_32x32x16_bf16 v[32:47], a[44:47], v[120:123], v[32:47]
    buffer_load_dwordx4 v[160:163], v0, s[4:7], s36 offen offset:2048 sc1
    v_mfma_f32_32x32x16_bf16 v[16:31], a[40:43], v[120:123], v[16:31]
    s_waitcnt vmcnt(9)
    v_mfma_f32_32x32x16_bf16 v[48:63], a[40:43], v[124:127], v[48:63]
    buffer_load_dwordx4 v[164:167], v0, s[4:7], s37 offen offset:2048 sc1
    v_mfma_f32_32x32x16_bf16 v[64:79], a[44:47], v[124:127], v[64:79]
    s_waitcnt vmcnt(9)
    v_mfma_f32_32x32x16_bf16 v[32:47], a[52:55], v[128:131], v[32:47]
    buffer_load_dwordx4 v[168:171], v0, s[4:7], s36 offen offset:3072 sc1
    v_mfma_f32_32x32x16_bf16 v[16:31], a[48:51], v[128:131], v[16:31]
    s_waitcnt vmcnt(9)
    v_mfma_f32_32x32x16_bf16 v[48:63], a[48:51], v[132:135], v[48:63]
    buffer_load_dwordx4 v[172:175], v0, s[4:7], s37 offen offset:3072 sc1
    v_mfma_f32_32x32x16_bf16 v[64:79], a[52:55], v[132:135], v[64:79]
    s_waitcnt vmcnt(9)
    v_mfma_f32_32x32x16_bf16 v[32:47], a[60:63], v[136:139], v[32:47]
    s_add_u32 s36, s24, 12288
    buffer_load_dwordx4 v[176:179], v0, s[4:7], s36 offen offset:0 sc1
    v_mfma_f32_32x32x16_bf16 v[16:31], a[56:59], v[136:139], v[16:31]
    s_waitcnt vmcnt(9)
    v_mfma_f32_32x32x16_bf16 v[48:63], a[56:59], v[140:143], v[48:63]
    s_add_u32 s37, s25, 12288
    buffer_load_dwordx4 v[180:183], v0, s[4:7], s37 offen offset:0 sc1
    v_mfma_f32_32x32x16_bf16 v[64:79], a[60:63], v[140:143], v[64:79]
    s_waitcnt vmcnt(9)
    v_mfma_f32_32x32x16_bf16 v[32:47], a[68:71], v[144:147], v[32:47]
    buffer_load_dwordx4 v[184:187], v0, s[4:7], s36 offen offset:1024 sc1
    v_mfma_f32_32x32x16_bf16 v[16:31], a[64:67], v[144:147], v[16:31]
    s_waitcnt vmcnt(9)
    v_mfma_f32_32x32x16_bf16 v[48:63], a[64:67], v[148:151], v[48:63]
    buffer_load_dwordx4 v[188:191], v0, s[4:7], s37 offen offset:1024 sc1
    v_mfma_f32_32x32x16_bf16 v[64:79], a[68:71], v[148:151], v[64:79]
    s_waitcnt vmcnt(9)
    v_mfma_f32_32x32x16_bf16 v[32:47], a[76:79], v[152:155], v[32:47]
    buffer_load_dwordx4 v[192:195], v0, s[4:7], s36 offen offset:2048 sc1
    v_mfma_f32_32x32x16_bf16 v[16:31], a[72:75], v[152:155], v[16:31]
    s_waitcnt vmcnt(9)
    v_mfma_f32_32x32x16_bf16 v[48:63], a[72:75], v[156:159], v[48:63]
    buffer_load_dwordx4 v[196:199], v0, s[4:7], s37 offen offset:2048 sc1
    v_mfma_f32_32x32x16_bf16 v[64:79], a[76:79], v[156:159], v[64:79]
    s_waitcnt vmcnt(9)
    v_mfma_f32_32x32x16_bf16 v[32:47], a[84:87], v[160:163], v[32:47]
    buffer_load_dwordx4 v[200:203], v0, s[4:7], s36 offen offset:3072 sc1
    v_mfma_f32_32x32x16_bf16 v[16:31], a[80:83], v[160:163], v[16:31]
    s_waitcnt vmcnt(9)
    v_mfma_f32_32x32x16_bf16 v[48:63], a[80:83], v[164:167], v[48:63]
    buffer_load_dwordx4 v[204:207], v0, s[4:7], s37 offen offset:3072 sc1
    v_mfma_f32_32x32x16_bf16 v[64:79], a[84:87], v[164:167], v[64:79]
    s_waitcnt vmcnt(9)
    v_mfma_f32_32x32x16_bf16 v[32:47], a[92:95], v[168:171], v[32:47]
    s_add_u32 s36, s24, 16384
    buffer_load_dwordx4 v[80:83], v0, s[4:7], s36 offen offset:0 sc1
    v_mfma_f32_32x32x16_bf16 v[16:31], a[88:91], v[168:171], v[16:31]
    s_waitcnt vmcnt(9)
    v_mfma_f32_32x32x16_bf16 v[48:63], a[88:91], v[172:175], v[48:63]
    s_add_u32 s37, s25, 16384
    buffer_load_dwordx4 v[84:87], v0, s[4:7], s37 offen offset:0 sc1
    v_mfma_f32_32x32x16_bf16 v[64:79], a[92:95], v[172:175], v[64:79]
    s_waitcnt vmcnt(9)
    v_mfma_f32_32x32x16_bf16 v[32:47], a[100:103], v[176:179], v[32:47]
    buffer_load_dwordx4 v[88:91], v0, s[4:7], s36 offen offset:1024 sc1
    v_mfma_f32_32x32x16_bf16 v[16:31], a[96:99], v[176:179], v[16:31]
    s_waitcnt vmcnt(9)
    v_mfma_f32_32x32x16_bf16 v[48:63], a[96:99], v[180:183], v[48:63]
    buffer_load_dwordx4 v[92:95], v0, s[4:7], s37 offen offset:1024 sc1
    v_mfma_f32_32x32x16_bf16 v[64:79], a[100:103], v[180:183], v[64:79]
    s_waitcnt vmcnt(9)
    v_mfma_f32_32x32x16_bf16 v[32:47], a[108:111], v[184:187], v[32:47]
    buffer_load_dwordx4 v[96:99], v0, s[4:7], s36 offen offset:2048 sc1
    v_mfma_f32_32x32x16_bf16 v[16:31], a[104:107], v[184:187], v[16:31]
    s_waitcnt vmcnt(9)
    v_mfma_f32_32x32x16_bf16 v[48:63], a[104:107], v[188:191], v[48:63]
    buffer_load_dwordx4 v[100:103], v0, s[4:7], s37 offen offset:2048 sc1
    v_mfma_f32_32x32x16_bf16 v[64:79], a[108:111], v[188:191], v[64:79]
    s_waitcnt vmcnt(9)
    v_mfma_f32_32x32x16_bf16 v[32:47], a[116:119], v[192:195], v[32:47]
    buffer_load_dwordx4 v[104:107], v0, s[4:7], s36 offen offset:3072 sc1
    v_mfma_f32_32x32x16_bf16 v[16:31], a[112:115], v[192:195], v[16:31]
    s_waitcnt vmcnt(9)
    v_mfma_f32_32x32x16_bf16 v[48:63], a[112:115], v[196:199], v[48:63]
    buffer_load_dwordx4 v[108:111], v0, s[4:7], s37 offen offset:3072 sc1
    v_mfma_f32_32x32x16_bf16 v[64:79], a[116:119], v[196:199], v[64:79]
    s_waitcnt vmcnt(9)
    v_mfma_f32_32x32x16_bf16 v[32:47], a[124:127], v[200:203], v[32:47]
    s_add_u32 s36, s24, 20480
    buffer_load_dwordx4 v[112:115], v0, s[4:7], s36 offen offset:0 sc1
    v_mfma_f32_32x32x16_bf16 v[16:31], a[120:123], v[200:203], v[16:31]
    s_waitcnt vmcnt(9)
    v_mfma_f32_32x32x16_bf16 v[48:63], a[120:123], v[204:207], v[48:63]
    s_add_u32 s37, s25, 20480
    buffer_load_dwordx4 v[116:119], v0, s[4:7], s37 offen offset:0 sc1
    v_mfma_f32_32x32x16_bf16 v[64:79], a[124:127], v[204:207], v[64:79]
    s_waitcnt vmcnt(9)
    v_mfma_f32_32x32x16_bf16 v[32:47], a[132:135], v[80:83], v[32:47]
    buffer_load_dwordx4 v[120:123], v0, s[4:7], s36 offen offset:1024 sc1
    v_mfma_f32_32x32x16_bf16 v[16:31], a[128:131], v[80:83], v[16:31]
    s_waitcnt vmcnt(9)
    v_mfma_f32_32x32x16_bf16 v[48:63], a[128:131], v[84:87], v[48:63]
    buffer_load_dwordx4 v[124:127], v0, s[4:7], s37 offen offset:1024 sc1
    v_mfma_f32_32x32x16_bf16 v[64:79], a[132:135], v[84:87], v[64:79]
    s_waitcnt vmcnt(9)
    v_mfma_f32_32x32x16_bf16 v[32:47], a[140:143], v[88:91], v[32:47]
    buffer_load_dwordx4 v[128:131], v0, s[4:7], s36 offen offset:2048 sc1
    v_mfma_f32_32x32x16_bf16 v[16:31], a[136:139], v[88:91], v[16:31]
    s_waitcnt vmcnt(9)
    v_mfma_f32_32x32x16_bf16 v[48:63], a[136:139], v[92:95], v[48:63]
    buffer_load_dwordx4 v[132:135], v0, s[4:7], s37 offen offset:2048 sc1
    v_mfma_f32_32x32x16_bf16 v[64:79], a[140:143], v[92:95], v[64:79]
    s_waitcnt vmcnt(9)
    v_mfma_f32_32x32x16_bf16 v[32:47], a[148:151], v[96:99], v[32:47]
    buffer_load_dwordx4 v[136:139], v0, s[4:7], s36 offen offset:3072 sc1
    v_mfma_f32_32x32x16_bf16 v[16:31], a[144:147], v[96:99], v[16:31]
    s_waitcnt vmcnt(9)
    v_mfma_f32_32x32x16_bf16 v[48:63], a[144:147], v[100:103], v[48:63]
    buffer_load_dwordx4 v[140:143], v0, s[4:7], s37 offen offset:3072 sc1
    v_mfma_f32_32x32x16_bf16 v[64:79], a[148:151], v[100:103], v[64:79]
    s_waitcnt vmcnt(9)
    v_mfma_f32_32x32x16_bf16 v[32:47], a[156:159], v[104:107], v[32:47]
    s_add_u32 s36, s24, 24576
    buffer_load_dwordx4 v[144:147], v0, s[4:7], s36 offen offset:0 sc1
    v_mfma_f32_32x32x16_bf16 v[16:31], a[152:155], v[104:107], v[16:31]
    s_waitcnt vmcnt(9)
    v_mfma_f32_32x32x16_bf16 v[48:63], a[152:155], v[108:111], v[48:63]
    s_add_u32 s37, s25, 24576
    buffer_load_dwordx4 v[148:151], v0, s[4:7], s37 offen offset:0 sc1
    v_mfma_f32_32x32x16_bf16 v[64:79], a[156:159], v[108:111], v[64:79]
    s_waitcnt vmcnt(9)
    v_mfma_f32_32x32x16_bf16 v[32:47], a[164:167], v[112:115], v[32:47]
    buffer_load_dwordx4 v[152:155], v0, s[4:7], s36 offen offset:1024 sc1
    v_mfma_f32_32x32x16_bf16 v[16:31], a[160:163], v[112:115], v[16:31]
    s_waitcnt vmcnt(9)
    v_mfma_f32_32x32x16_bf16 v[48:63], a[160:163], v[116:119], v[48:63]
    buffer_load_dwordx4 v[156:159], v0, s[4:7], s37 offen offset:1024 sc1
    v_mfma_f32_32x32x16_bf16 v[64:79], a[164:167], v[116:119], v[64:79]
    s_waitcnt vmcnt(9)
    v_mfma_f32_32x32x16_bf16 v[32:47], a[172:175], v[120:123], v[32:47]
    buffer_load_dwordx4 v[160:163], v0, s[4:7], s36 offen offset:2048 sc1
    v_mfma_f32_32x32x16_bf16 v[16:31], a[168:171], v[120:123], v[16:31]
    s_waitcnt vmcnt(9)
    v_mfma_f32_32x32x16_bf16 v[48:63], a[168:171], v[124:127], v[48:63]
    buffer_load_dwordx4 v[164:167], v0, s[4:7], s37 offen offset:2048 sc1
    v_mfma_f32_32x32x16_bf16 v[64:79], a[172:175], v[124:127], v[64:79]
    s_waitcnt vmcnt(9)
    v_mfma_f32_32x32x16_bf16 v[32:47], a[180:183], v[128:131], v[32:47]
    buffer_load_dwordx4 v[168:171], v0, s[4:7], s36 offen offset:3072 sc1
    v_mfma_f32_32x32x16_bf16 v[16:31], a[176:179], v[128:131], v[16:31]
    s_waitcnt vmcnt(9)
    v_mfma_f32_32x32x16_bf16 v[48:63], a[176:179], v[132:135], v[48:63]
    buffer_load_dwordx4 v[172:175], v0, s[4:7], s37 offen offset:3072 sc1
    v_mfma_f32_32x32x16_bf16 v[64:79], a[180:183], v[132:135], v[64:79]
    s_waitcnt vmcnt(9)
    v_mfma_f32_32x32x16_bf16 v[32:47], a[188:191], v[136:139], v[32:47]
    v_mfma_f32_32x32x16_bf16 v[16:31], a[184:187], v[136:139], v[16:31]
    s_waitcnt vmcnt(8)
    v_mfma_f32_32x32x16_bf16 v[48:63], a[184:187], v[140:143], v[48:63]
    v_mfma_f32_32x32x16_bf16 v[64:79], a[188:191], v[140:143], v[64:79]
    s_waitcnt vmcnt(7)
    v_mfma_f32_32x32x16_bf16 v[32:47], a[196:199], v[144:147], v[32:47]
    v_mfma_f32_32x32x16_bf16 v[16:31], a[192:195], v[144:147], v[16:31]
    s_waitcnt vmcnt(6)
    v_mfma_f32_32x32x16_bf16 v[48:63], a[192:195], v[148:151], v[48:63]
    v_mfma_f32_32x32x16_bf16 v[64:79], a[196:199], v[148:151], v[64:79]
    s_waitcnt vmcnt(5)
    v_mfma_f32_32x32x16_bf16 v[32:47], a[204:207], v[152:155], v[32:47]
    v_mfma_f32_32x32x16_bf16 v[16:31], a[200:203], v[152:155], v[16:31]
    s_waitcnt vmcnt(4)
    v_mfma_f32_32x32x16_bf16 v[48:63], a[200:203], v[156:159], v[48:63]
    v_mfma_f32_32x32x16_bf16 v[64:79], a[204:207], v[156:159], v[64:79]
    s_waitcnt vmcnt(3)
    v_mfma_f32_32x32x16_bf16 v[32:47], a[212:215], v[160:163], v[32:47]
    v_mfma_f32_32x32x16_bf16 v[16:31], a[208:211], v[160:163], v[16:31]
    s_waitcnt vmcnt(2)
    v_mfma_f32_32x32x16_bf16 v[48:63], a[208:211], v[164:167], v[48:63]
    v_mfma_f32_32x32x16_bf16 v[64:79], a[212:215], v[164:167], v[64:79]
    s_waitcnt vmcnt(1)
    v_mfma_f32_32x32x16_bf16 v[32:47], a[220:223], v[168:171], v[32:47]
    s_waitcnt vmcnt(0)
    v_mfma_f32_32x32x16_bf16 v[48:63], a[216:219], v[172:175], v[48:63]
    v_mfma_f32_32x32x16_bf16 v[64:79], a[220:223], v[172:175], v[64:79]
    s_nop 8
    ds_write_b128 v208, v[32:35] offset:0
    ds_write_b128 v208, v[36:39] offset:1024
    v_mfma_f32_32x32x16_bf16 v[16:31], a[216:219], v[168:171], v[16:31]
    ds_write_b128 v208, v[40:43] offset:2048
    ds_write_b128 v208, v[44:47] offset:3072
    ds_write_b128 v209, v[48:51] offset:0
    ds_write_b128 v209, v[52:55] offset:1024
    ds_write_b128 v209, v[56:59] offset:2048
    ds_write_b128 v209, v[60:63] offset:3072
    ds_write_b128 v210, v[64:67] offset:0
    ds_write_b128 v210, v[68:71] offset:1024
    ds_write_b128 v210, v[72:75] offset:2048
    ds_write_b128 v210, v[76:79] offset:3072
    s_waitcnt lgkmcnt(0)
    s_barrier
    ds_read_b128 v[80:83], v211 offset:0
    ds_read_b128 v[96:99], v211 offset:4096
    ds_read_b128 v[112:115], v211 offset:8192
    ds_read_b128 v[84:87], v211 offset:1024
    ds_read_b128 v[100:103], v211 offset:5120
    ds_read_b128 v[116:119], v211 offset:9216
    ds_read_b128 v[88:91], v211 offset:2048
    ds_read_b128 v[104:107], v211 offset:6144
    ds_read_b128 v[120:123], v211 offset:10240
    ds_read_b128 v[92:95], v211 offset:3072
    ds_read_b128 v[108:111], v211 offset:7168
    ds_read_b128 v[124:127], v211 offset:11264
    s_waitcnt lgkmcnt(11)
    v_add_f32 v16, v16, v80
    v_add_f32 v17, v17, v81
    v_add_f32 v18, v18, v82
    v_add_f32 v19, v19, v83
    s_waitcnt lgkmcnt(10)
    v_add_f32 v16, v16, v96
    v_add_f32 v17, v17, v97
    v_add_f32 v18, v18, v98
    v_add_f32 v19, v19, v99
    s_waitcnt lgkmcnt(9)
    v_add_f32 v16, v16, v112
    v_add_f32 v17, v17, v113
    v_add_f32 v18, v18, v114
    v_add_f32 v19, v19, v115
    s_waitcnt lgkmcnt(8)
    v_add_f32 v20, v20, v84
    v_add_f32 v21, v21, v85
    v_add_f32 v22, v22, v86
    v_add_f32 v23, v23, v87
    s_waitcnt lgkmcnt(7)
    v_add_f32 v20, v20, v100
    v_add_f32 v21, v21, v101
    v_add_f32 v22, v22, v102
    v_add_f32 v23, v23, v103
    s_waitcnt lgkmcnt(6)
    v_add_f32 v20, v20, v116
    v_add_f32 v21, v21, v117
    v_add_f32 v22, v22, v118
    v_add_f32 v23, v23, v119
    v_cvt_pk_bf16_f32 v8, v16, v17
    v_cvt_pk_bf16_f32 v9, v18, v19
    v_cvt_pk_bf16_f32 v10, v20, v21
    v_cvt_pk_bf16_f32 v11, v22, v23
    s_add_u32 s34, s26, 229376
    buffer_store_dwordx4 v[8:11], v0, s[96:99], s34 offen offset:0
    buffer_store_dwordx4 v[8:11], v0, s[0:3], s34 offen offset:0 sc1
    v_dot2_f32_bf16 v212, v8, v216, v212
    v_dot2_f32_bf16 v213, v8, v8, v213
    v_dot2_f32_bf16 v214, v9, v216, v214
    v_dot2_f32_bf16 v215, v9, v9, v215
    v_dot2_f32_bf16 v212, v10, v216, v212
    v_dot2_f32_bf16 v213, v10, v10, v213
    v_dot2_f32_bf16 v214, v11, v216, v214
    v_dot2_f32_bf16 v215, v11, v11, v215
    s_waitcnt lgkmcnt(5)
    v_add_f32 v24, v24, v88
    v_add_f32 v25, v25, v89
    v_add_f32 v26, v26, v90
    v_add_f32 v27, v27, v91
    s_waitcnt lgkmcnt(4)
    v_add_f32 v24, v24, v104
    v_add_f32 v25, v25, v105
    v_add_f32 v26, v26, v106
    v_add_f32 v27, v27, v107
    s_waitcnt lgkmcnt(3)
    v_add_f32 v24, v24, v120
    v_add_f32 v25, v25, v121
    v_add_f32 v26, v26, v122
    v_add_f32 v27, v27, v123
    s_waitcnt lgkmcnt(2)
    v_add_f32 v28, v28, v92
    v_add_f32 v29, v29, v93
    v_add_f32 v30, v30, v94
    v_add_f32 v31, v31, v95
    s_waitcnt lgkmcnt(1)
    v_add_f32 v28, v28, v108
    v_add_f32 v29, v29, v109
    v_add_f32 v30, v30, v110
    v_add_f32 v31, v31, v111
    s_waitcnt lgkmcnt(0)
    v_add_f32 v28, v28, v124
    v_add_f32 v29, v29, v125
    v_add_f32 v30, v30, v126
    v_add_f32 v31, v31, v127
    v_cvt_pk_bf16_f32 v12, v24, v25
    v_cvt_pk_bf16_f32 v13, v26, v27
    v_cvt_pk_bf16_f32 v14, v28, v29
    v_cvt_pk_bf16_f32 v15, v30, v31
    buffer_store_dwordx4 v[12:15], v0, s[96:99], s34 offen offset:1024
    buffer_store_dwordx4 v[12:15], v0, s[0:3], s34 offen offset:1024 sc1
    v_dot2_f32_bf16 v212, v12, v216, v212
    v_dot2_f32_bf16 v213, v12, v12, v213
    v_dot2_f32_bf16 v214, v13, v216, v214
    v_dot2_f32_bf16 v215, v13, v13, v215
    v_dot2_f32_bf16 v212, v14, v216, v212
    v_dot2_f32_bf16 v213, v14, v14, v213
    v_dot2_f32_bf16 v214, v15, v216, v214
    v_dot2_f32_bf16 v215, v15, v15, v215
    s_add_u32 s35, s27, 401408
    s_nop 0
    v_add_f32 v212, v212, v214
    v_add_f32 v213, v213, v215
    v_mov_b32 v214, v212
    v_mov_b32 v215, v213
    s_nop 0
    v_permlane32_swap_b32 v212, v214
    v_permlane32_swap_b32 v213, v215
    v_add_f32 v212, v212, v214
    v_add_f32 v213, v213, v215
    buffer_store_dwordx2 v[212:213], v217, s[96:99], s35 offen
    buffer_store_dwordx2 v[212:213], v217, s[0:3], s35 offen sc1
    s_waitcnt vmcnt(0) lgkmcnt(0)
    s_barrier
    s_cmp_eq_u32 s14, 0
    s_cbranch_scc0 Loth_48
    s_add_u32 s34, s30, 12288
    v_mov_b32 v220, s100
    v_mov_b32 v221, s101
    s_mov_b64 exec, 1
    buffer_store_dwordx2 v[220:221], v0, s[96:99], s34 offen
    buffer_store_dwordx2 v[220:221], v0, s[0:3], s34 offen sc1
    s_mov_b64 exec, -1
Loth_48:
    s_branch Lp5x_50
Lp5end_42:
    s_getpc_b64 s[34:35]
Lpcb_51:
    s_lshl_b32 s36, s14, 13
    v_lshl_add_u32 v218, v0, 3, s36
    s_mov_b32 s36, main_done - Lpcb_51
    v_min_u32 v218, s36, v218
    global_load_dword v223, v218, s[34:35]
Lp5x_50:
    s_cmp_eq_u32 s14, 0
    s_cbranch_scc0 Loth_52
    s_add_u32 s34, s29, 12288
    s_mov_b32 exec_lo, 0x3fff
    s_mov_b32 exec_hi, 0
Lpoll_54:
    buffer_load_dwordx2 v[220:221], v7, s[4:7], s34 offen sc1
    s_waitcnt vmcnt(0)
    s_waitcnt vmcnt(0)
    v_cmp_eq_u64 vcc, s[100:101], v[220:221]
    s_sub_u32 s33, s33, 1
    s_cmp_eq_u32 s33, 0
    s_cbranch_scc1 main_done
    s_cmp_eq_u64 vcc, exec
    s_cbranch_scc0 Lpoll_54
    s_mov_b64 exec, -1
Loth_52:
    s_add_u32 s19, s19, 262144
    s_add_u32 s20, s20, 262144
    s_add_u32 s29, s29, 16384
    s_add_u32 s30, s30, 16384
    s_add_u32 s31, s31, 32768
    s_add_u32 s62, s62, 32768
    s_add_u32 s15, s15, s63
    s_add_u32 s32, s32, s63
    s_add_u32 s21, s21, s63
    s_add_u32 s22, s22, s63
    s_add_u32 s23, s23, s63
    s_add_u32 s24, s24, s63
    s_add_u32 s25, s25, s63
    s_add_u32 s26, s26, s63
    s_add_u32 s27, s27, s63
    s_add_u32 s28, s28, s63
    s_waitcnt vmcnt(0) lgkmcnt(0)
    s_barrier
    s_add_u32 s36, s17, 229376
    buffer_load_dwordx4 v[16:19], v0, s[4:7], s36 offen offset:0 sc1
    buffer_load_dwordx4 v[20:23], v0, s[4:7], s36 offen offset:1024 sc1
    buffer_load_dwordx4 v[24:27], v0, s[4:7], s36 offen offset:2048 sc1
    buffer_load_dwordx4 v[28:31], v0, s[4:7], s36 offen offset:3072 sc1
    s_add_u32 s36, s17, 233472
    buffer_load_dwordx4 v[32:35], v0, s[4:7], s36 offen offset:0 sc1
    buffer_load_dwordx4 v[36:39], v0, s[4:7], s36 offen offset:1024 sc1
    buffer_load_dwordx4 v[40:43], v0, s[4:7], s36 offen offset:2048 sc1
    buffer_load_dwordx4 v[44:47], v0, s[4:7], s36 offen offset:3072 sc1
    s_lshl_b32 s34, s14, 12
    v_add_u32 v220, s34, v0
    ds_read_b128 v[176:179], v1 offset:34816
    ds_read_b128 v[180:183], v1 offset:63488
    ds_read_b128 v[184:187], v1 offset:35840
    ds_read_b128 v[188:191], v1 offset:64512
    ds_read_b128 v[192:195], v1 offset:36864
    ds_read_b128 v[196:199], v2 offset:0
    s_waitcnt vmcnt(7) lgkmcnt(5)
    v_mfma_f32_32x32x16_bf16 v[128:143], v[176:179], v[16:19], 0
    ds_read_b128 v[176:179], v1 offset:37888
    s_add_u32 s36, s17, 237568
    buffer_load_dwordx4 v[48:51], v0, s[4:7], s36 offen offset:0 sc1
    s_waitcnt lgkmcnt(5)
    v_mfma_f32_32x32x16_bf16 v[144:159], v[16:19], v[180:183], 0
    ds_read_b128 v[180:183], v2 offset:1024
    buffer_load_dwordx4 v[52:55], v0, s[4:7], s36 offen offset:1024 sc1
    s_waitcnt vmcnt(8) lgkmcnt(5)
    v_mfma_f32_32x32x16_bf16 v[128:143], v[184:187], v[20:23], v[128:143]
    ds_read_b128 v[184:187], v1 offset:38912
    s_waitcnt lgkmcnt(5)
    v_mfma_f32_32x32x16_bf16 v[144:159], v[20:23], v[188:191], v[144:159]
    ds_read_b128 v[188:191], v2 offset:2048
    buffer_load_dwordx4 v[56:59], v0, s[4:7], s36 offen offset:2048 sc1
    s_waitcnt vmcnt(8) lgkmcnt(5)
    v_mfma_f32_32x32x16_bf16 v[128:143], v[192:195], v[24:27], v[128:143]
    ds_read_b128 v[192:195], v1 offset:39936
    buffer_load_dwordx4 v[60:63], v0, s[4:7], s36 offen offset:3072 sc1
    s_waitcnt lgkmcnt(5)
    v_mfma_f32_32x32x16_bf16 v[144:159], v[24:27], v[196:199], v[144:159]
    ds_read_b128 v[196:199], v2 offset:3072
    s_waitcnt vmcnt(8) lgkmcnt(5)
    v_mfma_f32_32x32x16_bf16 v[128:143], v[176:179], v[28:31], v[128:143]
    ds_read_b128 v[176:179], v1 offset:40960
    s_add_u32 s36, s17, 241664
    buffer_load_dwordx4 v[64:67], v0, s[4:7], s36 offen offset:0 sc1
    s_waitcnt lgkmcnt(5)
    v_mfma_f32_32x32x16_bf16 v[144:159], v[28:31], v[180:183], v[144:159]
    ds_read_b128 v[180:183], v2 offset:4096
    buffer_load_dwordx4 v[68:71], v0, s[4:7], s36 offen offset:1024 sc1
    s_waitcnt vmcnt(9) lgkmcnt(5)
    v_mfma_f32_32x32x16_bf16 v[128:143], v[184:187], v[32:35], v[128:143]
    ds_read_b128 v[184:187], v1 offset:41984
    s_waitcnt lgkmcnt(5)
    v_mfma_f32_32x32x16_bf16 v[144:159], v[32:35], v[188:191], v[144:159]
    ds_read_b128 v[188:191], v2 offset:5120
    buffer_load_dwordx4 v[72:75], v0, s[4:7], s36 offen offset:2048 sc1
    s_waitcnt vmcnt(9) lgkmcnt(5)
    v_mfma_f32_32x32x16_bf16 v[128:143], v[192:195], v[36:39], v[128:143]
    ds_read_b128 v[192:195], v1 offset:43008
    buffer_load_dwordx4 v[76:79], v0, s[4:7], s36 offen offset:3072 sc1
    s_waitcnt lgkmcnt(5)
    v_mfma_f32_32x32x16_bf16 v[144:159], v[36:39], v[196:199], v[144:159]
    ds_read_b128 v[196:199], v2 offset:6144
    s_waitcnt vmcnt(9) lgkmcnt(5)
    v_mfma_f32_32x32x16_bf16 v[128:143], v[176:179], v[40:43], v[128:143]
    ds_read_b128 v[176:179], v1 offset:44032
    s_add_u32 s35, s18, 401408
    buffer_load_dwordx2 v[160:161], v7, s[4:7], s35 offen offset:0 sc1
    s_waitcnt lgkmcnt(5)
    v_mfma_f32_32x32x16_bf16 v[144:159], v[40:43], v[180:183], v[144:159]
    ds_read_b128 v[180:183], v2 offset:7168
    buffer_load_dwordx2 v[162:163], v7, s[4:7], s35 offen offset:512 sc1
    s_waitcnt vmcnt(10) lgkmcnt(5)
    v_mfma_f32_32x32x16_bf16 v[128:143], v[184:187], v[44:47], v[128:143]
    ds_read_b128 v[184:187], v1 offset:45056
    s_waitcnt lgkmcnt(5)
    v_mfma_f32_32x32x16_bf16 v[144:159], v[44:47], v[188:191], v[144:159]
    ds_read_b128 v[188:191], v2 offset:8192
    buffer_load_dwordx2 v[164:165], v7, s[4:7], s35 offen offset:1024 sc1
    s_waitcnt vmcnt(10) lgkmcnt(5)
    v_mfma_f32_32x32x16_bf16 v[128:143], v[192:195], v[48:51], v[128:143]
    ds_read_b128 v[192:195], v1 offset:46080
    buffer_load_dwordx2 v[166:167], v7, s[4:7], s35 offen offset:1536 sc1
    s_waitcnt lgkmcnt(5)
    v_mfma_f32_32x32x16_bf16 v[144:159], v[48:51], v[196:199], v[144:159]
    ds_read_b128 v[196:199], v2 offset:9216
    s_waitcnt vmcnt(10) lgkmcnt(5)
    v_mfma_f32_32x32x16_bf16 v[128:143], v[176:179], v[52:55], v[128:143]
    ds_read_b128 v[176:179], v1 offset:47104
    buffer_load_dwordx2 v[168:169], v7, s[4:7], s35 offen offset:2048 sc1
    s_waitcnt lgkmcnt(5)
    v_mfma_f32_32x32x16_bf16 v[144:159], v[52:55], v[180:183], v[144:159]
    ds_read_b128 v[180:183], v2 offset:10240
    buffer_load_dwordx2 v[170:171], v7, s[4:7], s35 offen offset:2560 sc1
    s_waitcnt vmcnt(11) lgkmcnt(5)
    v_mfma_f32_32x32x16_bf16 v[128:143], v[184:187], v[56:59], v[128:143]
    ds_read_b128 v[184:187], v1 offset:48128
    s_waitcnt lgkmcnt(5)
    v_mfma_f32_32x32x16_bf16 v[144:159], v[56:59], v[188:191], v[144:159]
    ds_read_b128 v[188:191], v2 offset:11264
    buffer_load_dwordx2 v[172:173], v7, s[4:7], s35 offen offset:3072 sc1
    s_waitcnt vmcnt(11) lgkmcnt(5)
    v_mfma_f32_32x32x16_bf16 v[128:143], v[192:195], v[60:63], v[128:143]
    ds_read_b128 v[192:195], v1 offset:49152
    s_add_u32 s36, s17, 245760
    buffer_load_dwordx4 v[80:83], v0, s[4:7], s36 offen offset:0 sc1
    s_waitcnt lgkmcnt(5)
    v_mfma_f32_32x32x16_bf16 v[144:159], v[60:63], v[196:199], v[144:159]
    ds_read_b128 v[196:199], v2 offset:12288
    s_waitcnt vmcnt(11) lgkmcnt(5)
    v_mfma_f32_32x32x16_bf16 v[128:143], v[176:179], v[64:67], v[128:143]
    ds_read_b128 v[176:179], v1 offset:50176
    buffer_load_dwordx4 v[84:87], v0, s[4:7], s36 offen offset:1024 sc1
    s_waitcnt lgkmcnt(5)
    v_mfma_f32_32x32x16_bf16 v[144:159], v[64:67], v[180:183], v[144:159]
    ds_read_b128 v[180:183], v2 offset:13312
    buffer_load_dwordx4 v[88:91], v0, s[4:7], s36 offen offset:2048 sc1
    s_waitcnt vmcnt(12) lgkmcnt(5)
    v_mfma_f32_32x32x16_bf16 v[128:143], v[184:187], v[68:71], v[128:143]
    ds_read_b128 v[184:187], v1 offset:51200
    s_waitcnt lgkmcnt(5)
    v_mfma_f32_32x32x16_bf16 v[144:159], v[68:71], v[188:191], v[144:159]
    ds_read_b128 v[188:191], v2 offset:14336
    buffer_load_dwordx4 v[92:95], v0, s[4:7], s36 offen offset:3072 sc1
    s_waitcnt vmcnt(12) lgkmcnt(5)
    v_mfma_f32_32x32x16_bf16 v[128:143], v[192:195], v[72:75], v[128:143]
    ds_read_b128 v[192:195], v1 offset:52224
    s_add_u32 s36, s17, 249856
    buffer_load_dwordx4 v[96:99], v0, s[4:7], s36 offen offset:0 sc1
    s_waitcnt lgkmcnt(5)
    v_mfma_f32_32x32x16_bf16 v[144:159], v[72:75], v[196:199], v[144:159]
    ds_read_b128 v[196:199], v2 offset:15360
    s_waitcnt vmcnt(12) lgkmcnt(5)
    v_mfma_f32_32x32x16_bf16 v[128:143], v[176:179], v[76:79], v[128:143]
    ds_read_b128 v[176:179], v1 offset:53248
    buffer_load_dwordx4 v[100:103], v0, s[4:7], s36 offen offset:1024 sc1
    s_waitcnt lgkmcnt(5)
    v_mfma_f32_32x32x16_bf16 v[144:159], v[76:79], v[180:183], v[144:159]
    ds_read_b128 v[180:183], v2 offset:16384
    buffer_load_dwordx4 v[104:107], v0, s[4:7], s36 offen offset:2048 sc1
    s_waitcnt vmcnt(6) lgkmcnt(5)
    v_mfma_f32_32x32x16_bf16 v[128:143], v[184:187], v[80:83], v[128:143]
    ds_read_b128 v[184:187], v1 offset:54272
    s_waitcnt lgkmcnt(5)
    v_mfma_f32_32x32x16_bf16 v[144:159], v[80:83], v[188:191], v[144:159]
    ds_read_b128 v[188:191], v2 offset:17408
    buffer_load_dwordx4 v[108:111], v0, s[4:7], s36 offen offset:3072 sc1
    s_waitcnt vmcnt(6) lgkmcnt(5)
    v_mfma_f32_32x32x16_bf16 v[128:143], v[192:195], v[84:87], v[128:143]
    ds_read_b128 v[192:195], v1 offset:55296
    s_add_u32 s36, s17, 253952
    buffer_load_dwordx4 v[112:115], v0, s[4:7], s36 offen offset:0 sc1
    s_waitcnt lgkmcnt(5)
    v_mfma_f32_32x32x16_bf16 v[144:159], v[84:87], v[196:199], v[144:159]
    ds_read_b128 v[196:199], v2 offset:18432
    v_add_f32 v160, v160, v162
    v_add_f32 v161, v161, v163
    v_add_f32 v164, v164, v166
    v_add_f32 v165, v165, v167
    s_waitcnt vmcnt(6) lgkmcnt(5)
    v_mfma_f32_32x32x16_bf16 v[128:143], v[176:179], v[88:91], v[128:143]
    ds_read_b128 v[176:179], v1 offset:56320
    buffer_load_dwordx4 v[116:119], v0, s[4:7], s36 offen offset:1024 sc1
    v_add_f32 v168, v168, v170
    v_add_f32 v169, v169, v171
    s_waitcnt lgkmcnt(5)
    v_mfma_f32_32x32x16_bf16 v[144:159], v[88:91], v[180:183], v[144:159]
    ds_read_b128 v[180:183], v2 offset:19456
    buffer_load_dwordx4 v[120:123], v0, s[4:7], s36 offen offset:2048 sc1
    v_add_f32 v160, v160, v164
    v_add_f32 v161, v161, v165
    s_waitcnt vmcnt(7) lgkmcnt(5)
    v_mfma_f32_32x32x16_bf16 v[128:143], v[184:187], v[92:95], v[128:143]
    ds_read_b128 v[184:187], v1 offset:57344
    v_add_f32 v168, v168, v172
    v_add_f32 v169, v169, v173
    v_add_f32 v160, v160, v168
    v_add_f32 v161, v161, v169
    s_waitcnt lgkmcnt(5)
    v_mfma_f32_32x32x16_bf16 v[144:159], v[92:95], v[188:191], v[144:159]
    ds_read_b128 v[188:191], v2 offset:20480
    buffer_load_dwordx4 v[124:127], v0, s[4:7], s36 offen offset:3072 sc1
    v_mov_b32 v162, v160
    v_mov_b32 v163, v161
    s_waitcnt vmcnt(7) lgkmcnt(5)
    v_mfma_f32_32x32x16_bf16 v[128:143], v[192:195], v[96:99], v[128:143]
    ds_read_b128 v[192:195], v1 offset:58368
    v_permlane32_swap_b32 v160, v162
    v_permlane32_swap_b32 v161, v163
    v_add_f32 v160, v160, v162
    v_add_f32 v161, v161, v163
    s_waitcnt lgkmcnt(5)
    v_mfma_f32_32x32x16_bf16 v[144:159], v[96:99], v[196:199], v[144:159]
    ds_read_b128 v[196:199], v2 offset:21504
    v_mul_f32 v216, s52, v160
    v_mul_f32 v219, s52, v161
    v_fma_f32 v219, -v216, v216, v219
    v_max_f32 v219, 0, v219
    s_waitcnt vmcnt(6) lgkmcnt(5)
    v_mfma_f32_32x32x16_bf16 v[128:143], v[176:179], v[100:103], v[128:143]
    ds_read_b128 v[176:179], v1 offset:59392
    v_add_f32 v219, s53, v219
    v_rsq_f32 v217, v219
    v_cndmask_b32 v160, -v216, 0, s[40:41]
    s_waitcnt lgkmcnt(5)
    v_mfma_f32_32x32x16_bf16 v[144:159], v[100:103], v[180:183], v[144:159]
    ds_read_b128 v[180:183], v2 offset:22528
    v_cvt_pk_bf16_f32 v161, v160, v160
    v_and_b32 v161, 0xffff0000, v161
    v_sub_f32 v161, v160, v161
    v_cvt_pk_bf16_f32 v212, v160, v161
    s_waitcnt vmcnt(5) lgkmcnt(5)
    v_mfma_f32_32x32x16_bf16 v[128:143], v[184:187], v[104:107], v[128:143]
    ds_read_b128 v[184:187], v1 offset:60416
    v_and_b32 v162, 0xffff0000, v212
    v_sub_f32 v162, v161, v162
    v_cvt_pk_bf16_f32 v213, v160, v162
    v_mov_b32 v214, v212
    s_waitcnt lgkmcnt(5)
    v_mfma_f32_32x32x16_bf16 v[144:159], v[104:107], v[188:191], v[144:159]
    ds_read_b128 v[188:191], v2 offset:23552
    v_mov_b32 v215, 0
    ds_write_b32 v3, v217
    ds_read_b128 v[200:203], v6 offset:0
    ds_read_b128 v[204:207], v6 offset:32
    s_waitcnt vmcnt(4) lgkmcnt(8)
    v_mfma_f32_32x32x16_bf16 v[128:143], v[192:195], v[108:111], v[128:143]
    ds_read_b128 v[192:195], v1 offset:61440
    ds_read_b128 v[208:211], v6 offset:64
    v_mul_f32 v219, s54, v217
    s_waitcnt lgkmcnt(9)
    v_mfma_f32_32x32x16_bf16 v[144:159], v[108:111], v[196:199], v[144:159]
    ds_read_b128 v[196:199], v2 offset:24576
    s_waitcnt vmcnt(3) lgkmcnt(9)
    v_mfma_f32_32x32x16_bf16 v[128:143], v[176:179], v[112:115], v[128:143]
    ds_read_b128 v[176:179], v1 offset:62464
    s_waitcnt lgkmcnt(9)
    v_mfma_f32_32x32x16_bf16 v[144:159], v[112:115], v[180:183], v[144:159]
    ds_read_b128 v[180:183], v2 offset:25600
    s_waitcnt vmcnt(2) lgkmcnt(9)
    v_mfma_f32_32x32x16_bf16 v[128:143], v[184:187], v[116:119], v[128:143]
    ds_read_b128 v[184:187], v4 offset:0
    s_waitcnt lgkmcnt(9)
    v_mfma_f32_32x32x16_bf16 v[144:159], v[116:119], v[188:191], v[144:159]
    ds_read_b128 v[188:191], v4 offset:512
    s_waitcnt vmcnt(1) lgkmcnt(6)
    v_mfma_f32_32x32x16_bf16 v[128:143], v[192:195], v[120:123], v[128:143]
    ds_read_b128 v[192:195], v1 offset:6144
    s_waitcnt lgkmcnt(5)
    v_mfma_f32_32x32x16_bf16 v[144:159], v[120:123], v[196:199], v[144:159]
    ds_read_b128 v[196:199], v1 offset:7168
    s_waitcnt vmcnt(0) lgkmcnt(5)
    v_mfma_f32_32x32x16_bf16 v[128:143], v[176:179], v[124:127], v[128:143]
    ds_read_b128 v[176:179], v1 offset:8192
    s_waitcnt lgkmcnt(5)
    v_mfma_f32_32x32x16_bf16 v[144:159], v[124:127], v[180:183], v[144:159]
    ds_read_b128 v[180:183], v1 offset:9216
    s_waitcnt lgkmcnt(5)
    v_mfma_f32_32x32x16_bf16 v[128:143], v[184:187], v[212:215], v[128:143]
    ds_read_b128 v[184:187], v1 offset:10240
    s_waitcnt lgkmcnt(5)
    v_mfma_f32_32x32x16_bf16 v[144:159], v[212:215], v[188:191], v[144:159]
    ds_read_b128 v[188:191], v1 offset:11264
    s_waitcnt lgkmcnt(5)
    v_mfma_f32_32x32x16_bf16 v[160:175], v[192:195], v[16:19], 0
    ds_read_b128 v[192:195], v1 offset:12288
    s_nop 4
    v_mul_f32 v128, v217, v128
    v_mul_f32 v129, v217, v129
    v_mul_f32 v130, v217, v130
    v_mul_f32 v131, v217, v131
    v_mul_f32 v132, v217, v132
    v_mul_f32 v133, v217, v133
    v_mul_f32 v134, v217, v134
    v_mul_f32 v135, v217, v135
    s_waitcnt lgkmcnt(5)
    v_mfma_f32_32x32x16_bf16 v[160:175], v[196:199], v[20:23], v[160:175]
    ds_read_b128 v[196:199], v1 offset:13312
    v_mul_f32 v136, v217, v136
    v_mul_f32 v137, v217, v137
    v_mul_f32 v138, v217, v138
    v_mul_f32 v139, v217, v139
    v_mul_f32 v140, v217, v140
    v_mul_f32 v141, v217, v141
    v_mul_f32 v142, v217, v142
    v_mul_f32 v143, v217, v143
    s_waitcnt lgkmcnt(5)
    v_mfma_f32_32x32x16_bf16 v[160:175], v[176:179], v[24:27], v[160:175]
    ds_read_b128 v[176:179], v1 offset:14336
    v_cvt_pk_bf16_f32 v128, v128, v129
    v_cvt_pk_bf16_f32 v129, v130, v131
    v_cvt_pk_bf16_f32 v130, v132, v133
    v_cvt_pk_bf16_f32 v131, v134, v135
    v_cvt_pk_bf16_f32 v132, v136, v137
    v_cvt_pk_bf16_f32 v133, v138, v139
    v_cvt_pk_bf16_f32 v134, v140, v141
    v_cvt_pk_bf16_f32 v135, v142, v143
    s_waitcnt lgkmcnt(5)
    v_mfma_f32_32x32x16_bf16 v[160:175], v[180:183], v[28:31], v[160:175]
    ds_read_b128 v[180:183], v1 offset:15360
    ds_read_b128 v[136:139], v6 offset:96
    buffer_store_dwordx4 v[128:131], v0, s[4:7], s19 offen sc1
    buffer_store_dwordx4 v[132:135], v0, s[4:7], s19 offen offset:1024 sc1
    v_fma_f32 v144, v144, v200, v5
    v_fma_f32 v145, v145, v201, v5
    v_fma_f32 v146, v146, v202, v5
    v_fma_f32 v147, v147, v203, v5
    v_fma_f32 v148, v148, v204, v5
    s_waitcnt lgkmcnt(6)
    v_mfma_f32_32x32x16_bf16 v[160:175], v[184:187], v[32:35], v[160:175]
    ds_read_b128 v[184:187], v1 offset:16384
    v_fma_f32 v149, v149, v205, v5
    v_fma_f32 v150, v150, v206, v5
    v_fma_f32 v151, v151, v207, v5
    v_fma_f32 v152, v152, v208, v5
    v_fma_f32 v153, v153, v209, v5
    v_fma_f32 v154, v154, v210, v5
    v_fma_f32 v155, v155, v211, v5
    s_waitcnt lgkmcnt(1)
    v_fma_f32 v156, v156, v136, v5
    v_mfma_f32_32x32x16_bf16 v[160:175], v[188:191], v[36:39], v[160:175]
    ds_read_b128 v[188:191], v1 offset:17408
    v_fma_f32 v157, v157, v137, v5
    v_fma_f32 v158, v158, v138, v5
    v_fma_f32 v159, v159, v139, v5
    v_cvt_pk_bf16_f32 v144, v144, v145
    v_cvt_pk_bf16_f32 v145, v146, v147
    v_cvt_pk_bf16_f32 v146, v148, v149
    v_cvt_pk_bf16_f32 v147, v150, v151
    v_cvt_pk_bf16_f32 v148, v152, v153
    v_mfma_f32_32x32x16_bf16 v[160:175], v[192:195], v[40:43], v[160:175]
    ds_read_b128 v[192:195], v1 offset:18432
    v_cvt_pk_bf16_f32 v149, v154, v155
    v_cvt_pk_bf16_f32 v150, v156, v157
    v_cvt_pk_bf16_f32 v151, v158, v159
    buffer_store_dwordx4 v[144:147], v0, s[4:7], s19 offen offset:2048 sc1
    buffer_store_dwordx4 v[148:151], v0, s[4:7], s19 offen offset:3072 sc1
    ds_write_b128 v220, v[128:131] offset:32768
    v_mfma_f32_32x32x16_bf16 v[160:175], v[196:199], v[44:47], v[160:175]
    ds_read_b128 v[196:199], v1 offset:19456
    ds_write_b128 v220, v[132:135] offset:33792
    ds_write_b128 v220, v[144:147] offset:34816
    ds_write_b128 v220, v[148:151] offset:35840
    v_mov_b32 v216, 0xffff
    v_mfma_f32_32x32x16_bf16 v[160:175], v[176:179], v[48:51], v[160:175]
    ds_read_b128 v[176:179], v1 offset:20480
    v_mov_b32 v218, 0xffff0000
    v_cndmask_b32 v152, 0, v216, s[64:65]
    v_cndmask_b32 v221, 0, v218, s[66:67]
    v_or_b32 v152, v152, v221
    v_mfma_f32_32x32x16_bf16 v[160:175], v[180:183], v[52:55], v[160:175]
    ds_read_b128 v[180:183], v1 offset:21504
    v_cndmask_b32 v153, 0, v216, s[68:69]
    v_cndmask_b32 v221, 0, v218, s[70:71]
    v_or_b32 v153, v153, v221
    v_cndmask_b32 v154, 0, v216, s[72:73]
    s_waitcnt lgkmcnt(9)
    v_mfma_f32_32x32x16_bf16 v[160:175], v[184:187], v[56:59], v[160:175]
    ds_read_b128 v[184:187], v1 offset:22528
    v_cndmask_b32 v221, 0, v218, s[74:75]
    v_or_b32 v154, v154, v221
    v_cndmask_b32 v155, 0, v216, s[76:77]
    v_cndmask_b32 v221, 0, v218, s[78:79]
    s_waitcnt lgkmcnt(9)
    v_mfma_f32_32x32x16_bf16 v[160:175], v[188:191], v[60:63], v[160:175]
    ds_read_b128 v[188:191], v1 offset:23552
    v_or_b32 v155, v155, v221
    v_cndmask_b32 v156, 0, v216, s[80:81]
    v_cndmask_b32 v221, 0, v218, s[82:83]
    v_or_b32 v156, v156, v221
    s_waitcnt lgkmcnt(9)
    v_mfma_f32_32x32x16_bf16 v[160:175], v[192:195], v[64:67], v[160:175]
    ds_read_b128 v[192:195], v1 offset:24576
    v_cndmask_b32 v157, 0, v216, s[84:85]
    v_cndmask_b32 v221, 0, v218, s[86:87]
    v_or_b32 v157, v157, v221
    v_cndmask_b32 v158, 0, v216, s[88:89]
    s_waitcnt lgkmcnt(8)
    v_mfma_f32_32x32x16_bf16 v[160:175], v[196:199], v[68:71], v[160:175]
    ds_read_b128 v[196:199], v1 offset:25600
    v_cndmask_b32 v221, 0, v218, s[90:91]
    v_or_b32 v158, v158, v221
    v_cndmask_b32 v159, 0, v216, s[92:93]
    v_cndmask_b32 v221, 0, v218, s[94:95]
    s_waitcnt lgkmcnt(5)
    v_mfma_f32_32x32x16_bf16 v[160:175], v[176:179], v[72:75], v[160:175]
    ds_read_b128 v[176:179], v1 offset:26624
    v_or_b32 v159, v159, v221
    s_waitcnt lgkmcnt(5)
    v_mfma_f32_32x32x16_bf16 v[160:175], v[180:183], v[76:79], v[160:175]
    ds_read_b128 v[180:183], v1 offset:27648
    s_waitcnt lgkmcnt(5)
    v_mfma_f32_32x32x16_bf16 v[160:175], v[184:187], v[80:83], v[160:175]
    ds_read_b128 v[184:187], v1 offset:28672
    s_waitcnt lgkmcnt(5)
    v_mfma_f32_32x32x16_bf16 v[160:175], v[188:191], v[84:87], v[160:175]
    ds_read_b128 v[188:191], v1 offset:29696
    s_waitcnt lgkmcnt(5)
    v_mfma_f32_32x32x16_bf16 v[160:175], v[192:195], v[88:91], v[160:175]
    ds_read_b128 v[192:195], v1 offset:30720
    s_waitcnt lgkmcnt(5)
    v_mfma_f32_32x32x16_bf16 v[160:175], v[196:199], v[92:95], v[160:175]
    ds_read_b128 v[196:199], v1 offset:31744
    s_waitcnt lgkmcnt(5)
    v_mfma_f32_32x32x16_bf16 v[160:175], v[176:179], v[96:99], v[160:175]
    ds_read_b128 v[176:179], v1 offset:32768
    s_waitcnt lgkmcnt(5)
    v_mfma_f32_32x32x16_bf16 v[160:175], v[180:183], v[100:103], v[160:175]
    ds_read_b128 v[180:183], v1 offset:33792
    s_waitcnt lgkmcnt(5)
    v_mfma_f32_32x32x16_bf16 v[160:175], v[184:187], v[104:107], v[160:175]
    ds_read_b128 v[184:187], v4 offset:1024
    s_waitcnt lgkmcnt(5)
    v_mfma_f32_32x32x16_bf16 v[160:175], v[188:191], v[108:111], v[160:175]
    s_waitcnt lgkmcnt(4)
    v_mfma_f32_32x32x16_bf16 v[160:175], v[192:195], v[112:115], v[160:175]
    s_waitcnt lgkmcnt(3)
    v_mfma_f32_32x32x16_bf16 v[160:175], v[196:199], v[116:119], v[160:175]
    s_waitcnt lgkmcnt(2)
    v_mfma_f32_32x32x16_bf16 v[160:175], v[176:179], v[120:123], v[160:175]
    s_waitcnt lgkmcnt(1)
    v_mfma_f32_32x32x16_bf16 v[160:175], v[180:183], v[124:127], v[160:175]
    s_waitcnt lgkmcnt(0)
    v_mfma_f32_32x32x16_bf16 v[160:175], v[184:187], v[212:215], v[160:175]
    v_mov_b32 v176, v220
    s_waitcnt vmcnt(0)
    s_waitcnt lgkmcnt(0)
    s_barrier
    s_cmp_eq_u32 s14, 0
    s_cbranch_scc0 Loth_55
    s_add_u32 s34, s62, 0
    v_mov_b32 v220, s100
    v_mov_b32 v221, s101
    s_mov_b64 exec, 1
    buffer_store_dwordx2 v[220:221], v0, s[4:7], s34 offen sc1
    s_mov_b64 exec, -1
Loth_55:
    s_nop 5
    v_mul_f32 v160, v219, v160
    v_mul_f32 v161, v219, v161
    v_mul_f32 v162, v219, v162
    v_mul_f32 v163, v219, v163
    v_mul_f32 v164, v219, v164
    v_mul_f32 v165, v219, v165
    v_mul_f32 v166, v219, v166
    v_mul_f32 v167, v219, v167
    v_mul_f32 v168, v219, v168
    v_mul_f32 v169, v219, v169
    v_mul_f32 v170, v219, v170
    v_mul_f32 v171, v219, v171
    v_mul_f32 v172, v219, v172
    v_mul_f32 v173, v219, v173
    v_mul_f32 v174, v219, v174
    v_mul_f32 v175, v219, v175
    v_mov_b32 v221, s56
    v_cndmask_b32 v172, v172, v221, s[40:41]
    v_cvt_pk_bf16_f32 v160, v160, v161
    v_cvt_pk_bf16_f32 v161, v162, v163
    v_cvt_pk_bf16_f32 v162, v164, v165
    v_cvt_pk_bf16_f32 v163, v166, v167
    v_cvt_pk_bf16_f32 v164, v168, v169
    v_cvt_pk_bf16_f32 v165, v170, v171
    v_cvt_pk_bf16_f32 v166, v172, v173
    v_cvt_pk_bf16_f32 v167, v174, v175
    v_mov_b32 v168, v176
    s_cmp_lt_u32 s14, 2
    s_cbranch_scc0 Loth_57
    s_lshl_b32 s37, s14, 14
    s_sub_u32 s37, 16384, s37
    s_cmp_le_u32 s12, s14
    s_cbranch_scc1 Lfill_59
    s_add_u32 s34, s31, 0
    s_mov_b32 exec_lo, 1
    s_mov_b32 exec_hi, 0
Lpoll_61:
    buffer_load_dwordx2 v[220:221], v7, s[4:7], s34 offen sc1
    s_waitcnt vmcnt(0)
    s_waitcnt vmcnt(0)
    v_cmp_eq_u64 vcc, s[100:101], v[220:221]
    s_sub_u32 s33, s33, 1
    s_cmp_eq_u32 s33, 0
    s_cbranch_scc1 main_done
    s_cmp_eq_u64 vcc, exec
    s_cbranch_scc0 Lpoll_61
    s_mov_b64 exec, -1
    s_add_u32 s34, s20, 0
    s_add_u32 m0, s37, 0
    s_nop 0
    buffer_load_dwordx4 v0, s[4:7], s34 offen offset:0 sc1 lds
    buffer_load_dwordx4 v0, s[4:7], s34 offen offset:1024 sc1 lds
    s_add_u32 s34, s20, 4096
    s_add_u32 m0, s37, 4096
    s_nop 0
    buffer_load_dwordx4 v0, s[4:7], s34 offen offset:0 sc1 lds
    buffer_load_dwordx4 v0, s[4:7], s34 offen offset:1024 sc1 lds
    s_add_u32 s34, s20, 8192
    s_add_u32 m0, s37, 8192
    s_nop 0
    buffer_load_dwordx4 v0, s[4:7], s34 offen offset:0 sc1 lds
    buffer_load_dwordx4 v0, s[4:7], s34 offen offset:1024 sc1 lds
    s_add_u32 s34, s20, 12288
    s_add_u32 m0, s37, 12288
    s_nop 0
    buffer_load_dwordx4 v0, s[4:7], s34 offen offset:0 sc1 lds
    buffer_load_dwordx4 v0, s[4:7], s34 offen offset:1024 sc1 lds
    s_add_u32 s34, s20, 2048
    s_add_u32 m0, s37, 2048
    s_nop 0
    buffer_load_dwordx4 v0, s[4:7], s34 offen offset:0 sc1 lds
    buffer_load_dwordx4 v0, s[4:7], s34 offen offset:1024 sc1 lds
    s_add_u32 s34, s20, 6144
    s_add_u32 m0, s37, 6144
    s_nop 0
    buffer_load_dwordx4 v0, s[4:7], s34 offen offset:0 sc1 lds
    buffer_load_dwordx4 v0, s[4:7], s34 offen offset:1024 sc1 lds
    s_add_u32 s34, s20, 10240
    s_add_u32 m0, s37, 10240
    s_nop 0
    buffer_load_dwordx4 v0, s[4:7], s34 offen offset:0 sc1 lds
    buffer_load_dwordx4 v0, s[4:7], s34 offen offset:1024 sc1 lds
    s_add_u32 s34, s20, 14336
    s_add_u32 m0, s37, 14336
    s_nop 0
    buffer_load_dwordx4 v0, s[4:7], s34 offen offset:0 sc1 lds
    buffer_load_dwordx4 v0, s[4:7], s34 offen offset:1024 sc1 lds
    s_waitcnt vmcnt(8)
    s_branch Lhalo_60
Lfill_59:
    v_add_u32 v220, s37, v0
    v_mov_b32 v88, 0
    v_mov_b32 v89, 0
    v_mov_b32 v90, 0
    v_mov_b32 v91, 0
    v_mov_b32 v92, 0
    v_mov_b32 v93, 0
    v_mov_b32 v94, 0
    v_mov_b32 v95, 0
    v_mov_b32 v221, 0x3f80
    v_cndmask_b32 v94, 0, v221, s[40:41]
    ds_write_b128 v220, v[88:91] offset:0
    ds_write_b128 v220, v[92:95] offset:1024
    ds_write_b128 v220, v[88:91] offset:2048
    ds_write_b128 v220, v[88:91] offset:3072
    ds_write_b128 v220, v[88:91] offset:4096
    ds_write_b128 v220, v[92:95] offset:5120
    ds_write_b128 v220, v[88:91] offset:6144
    ds_write_b128 v220, v[88:91] offset:7168
    ds_write_b128 v220, v[88:91] offset:8192
    ds_write_b128 v220, v[92:95] offset:9216
    ds_write_b128 v220, v[88:91] offset:10240
    ds_write_b128 v220, v[88:91] offset:11264
    ds_write_b128 v220, v[88:91] offset:12288
    ds_write_b128 v220, v[92:95] offset:13312
    ds_write_b128 v220, v[88:91] offset:14336
    ds_write_b128 v220, v[88:91] offset:15360
    s_waitcnt lgkmcnt(0)
Lhalo_60:
    s_branch Ljoin_58
Loth_57:
    s_sub_u32 s37, s14, 2
    s_mul_i32 s37, s37, 19456
    s_add_u32 s38, s49, s37
    s_add_u32 s34, s38, 0
    s_add_u32 m0, s37, 49152
    s_nop 0
    buffer_load_dwordx4 v0, s[4:7], s34 offen offset:0 sc1 lds
    buffer_load_dwordx4 v0, s[4:7], s34 offen offset:1024 sc1 lds
    buffer_load_dwordx4 v0, s[4:7], s34 offen offset:2048 sc1 lds
    buffer_load_dwordx4 v0, s[4:7], s34 offen offset:3072 sc1 lds
    s_add_u32 s34, s38, 4096
    s_add_u32 m0, s37, 53248
    s_nop 0
    buffer_load_dwordx4 v0, s[4:7], s34 offen offset:0 sc1 lds
    buffer_load_dwordx4 v0, s[4:7], s34 offen offset:1024 sc1 lds
    buffer_load_dwordx4 v0, s[4:7], s34 offen offset:2048 sc1 lds
    buffer_load_dwordx4 v0, s[4:7], s34 offen offset:3072 sc1 lds
    s_add_u32 s34, s38, 8192
    s_add_u32 m0, s37, 57344
    s_nop 0
    buffer_load_dwordx4 v0, s[4:7], s34 offen offset:0 sc1 lds
    buffer_load_dwordx4 v0, s[4:7], s34 offen offset:1024 sc1 lds
    buffer_load_dwordx4 v0, s[4:7], s34 offen offset:2048 sc1 lds
    buffer_load_dwordx4 v0, s[4:7], s34 offen offset:3072 sc1 lds
    s_add_u32 s34, s38, 12288
    s_add_u32 m0, s37, 61440
    s_nop 0
    buffer_load_dwordx4 v0, s[4:7], s34 offen offset:0 sc1 lds
    buffer_load_dwordx4 v0, s[4:7], s34 offen offset:1024 sc1 lds
    buffer_load_dwordx4 v0, s[4:7], s34 offen offset:2048 sc1 lds
    buffer_load_dwordx4 v0, s[4:7], s34 offen offset:3072 sc1 lds
    s_add_u32 s34, s38, 16384
    s_add_u32 m0, s37, 65536
    s_nop 0
    buffer_load_dwordx4 v0, s[4:7], s34 offen offset:0 sc1 lds
    buffer_load_dwordx4 v0, s[4:7], s34 offen offset:1024 sc1 lds
    buffer_load_dwordx4 v0, s[4:7], s34 offen offset:2048 sc1 lds
Ljoin_58:
    s_mul_i32 s37, s14, 17408
    s_add_u32 s38, s49, s37
    s_barrier
    ds_read_b128 v[16:19], v168 offset:32768
    ds_read_b128 v[20:23], v168 offset:33792
    ds_read_b128 v[24:27], v168 offset:0
    ds_read_b128 v[28:31], v168 offset:1024
    ds_read_b128 v[32:35], v168 offset:4096
    ds_read_b128 v[36:39], v168 offset:5120
    s_waitcnt lgkmcnt(5)
    v_mfma_f32_32x32x16_bf16 v[88:103], v[16:19], v[160:163], 0
    ds_read_b128 v[40:43], v168 offset:8192
    s_waitcnt lgkmcnt(5)
    v_mfma_f32_32x32x16_bf16 v[88:103], v[20:23], v[164:167], v[88:103]
    ds_read_b128 v[44:47], v168 offset:9216
    s_waitcnt lgkmcnt(5)
    v_mfma_f32_32x32x16_bf16 v[104:119], v[24:27], v[160:163], 0
    ds_read_b128 v[48:51], v168 offset:12288
    s_waitcnt lgkmcnt(5)
    v_mfma_f32_32x32x16_bf16 v[104:119], v[28:31], v[164:167], v[104:119]
    ds_read_b128 v[52:55], v168 offset:13312
    s_waitcnt lgkmcnt(5)
    v_mfma_f32_32x32x16_bf16 v[120:135], v[32:35], v[160:163], 0
    ds_read_b128 v[56:59], v168 offset:16384
    s_waitcnt lgkmcnt(5)
    v_mfma_f32_32x32x16_bf16 v[120:135], v[36:39], v[164:167], v[120:135]
    ds_read_b128 v[60:63], v168 offset:17408
    s_nop 4
    v_cndmask_b32 v104, v104, v88, s[64:65]
    v_cndmask_b32 v105, v105, v89, s[66:67]
    v_cndmask_b32 v106, v106, v90, s[68:69]
    v_cndmask_b32 v107, v107, v91, s[70:71]
    v_cndmask_b32 v108, v108, v92, s[72:73]
    v_cndmask_b32 v109, v109, v93, s[74:75]
    v_cndmask_b32 v110, v110, v94, s[76:77]
    v_cndmask_b32 v111, v111, v95, s[78:79]
    v_cndmask_b32 v112, v112, v96, s[80:81]
    v_cndmask_b32 v113, v113, v97, s[82:83]
    v_cndmask_b32 v114, v114, v98, s[84:85]
    v_cndmask_b32 v115, v115, v99, s[86:87]
    v_cndmask_b32 v116, v116, v100, s[88:89]
    v_cndmask_b32 v117, v117, v101, s[90:91]
    v_cndmask_b32 v118, v118, v102, s[92:93]
    v_cndmask_b32 v119, v119, v103, s[94:95]
    s_waitcnt lgkmcnt(5)
    v_mfma_f32_32x32x16_bf16 v[88:103], v[40:43], v[160:163], 0
    ds_read_b128 v[64:67], v168 offset:20480
    v_max_f32 v216, v104, v105
    v_max3_f32 v216, v216, v106, v107
    v_max3_f32 v216, v216, v108, v109
    v_max3_f32 v216, v216, v110, v111
    s_waitcnt lgkmcnt(5)
    v_mfma_f32_32x32x16_bf16 v[88:103], v[44:47], v[164:167], v[88:103]
    ds_read_b128 v[68:71], v168 offset:21504
    v_max3_f32 v216, v216, v112, v113
    v_max3_f32 v216, v216, v114, v115
    v_max3_f32 v216, v216, v116, v117
    v_max3_f32 v216, v216, v118, v119
    s_waitcnt lgkmcnt(5)
    v_mfma_f32_32x32x16_bf16 v[104:119], v[48:51], v[160:163], 0
    ds_read_b128 v[72:75], v168 offset:24576
    v_max3_f32 v216, v216, v120, v121
    v_max3_f32 v216, v216, v122, v123
    v_max3_f32 v216, v216, v124, v125
    v_max3_f32 v216, v216, v126, v127
    s_waitcnt lgkmcnt(5)
    v_mfma_f32_32x32x16_bf16 v[104:119], v[52:55], v[164:167], v[104:119]
    ds_read_b128 v[76:79], v168 offset:25600
    v_max3_f32 v216, v216, v128, v129
    v_max3_f32 v216, v216, v130, v131
    v_max3_f32 v216, v216, v132, v133
    v_max3_f32 v216, v216, v134, v135
    s_waitcnt lgkmcnt(5)
    v_mfma_f32_32x32x16_bf16 v[120:135], v[56:59], v[160:163], 0
    ds_read_b128 v[80:83], v168 offset:28672
    v_max3_f32 v216, v216, v88, v89
    v_max3_f32 v216, v216, v90, v91
    v_max3_f32 v216, v216, v92, v93
    v_max3_f32 v216, v216, v94, v95
    s_waitcnt lgkmcnt(5)
    v_mfma_f32_32x32x16_bf16 v[120:135], v[60:63], v[164:167], v[120:135]
    ds_read_b128 v[84:87], v168 offset:29696
    v_max3_f32 v216, v216, v96, v97
    v_max3_f32 v216, v216, v98, v99
    v_max3_f32 v216, v216, v100, v101
    v_max3_f32 v216, v216, v102, v103
    s_waitcnt lgkmcnt(5)
    v_mfma_f32_32x32x16_bf16 v[88:103], v[64:67], v[160:163], 0
    v_max3_f32 v216, v216, v104, v105
    v_max3_f32 v216, v216, v106, v107
    v_max3_f32 v216, v216, v108, v109
    v_max3_f32 v216, v216, v110, v111
    v_max3_f32 v216, v216, v112, v113
    s_waitcnt lgkmcnt(4)
    v_mfma_f32_32x32x16_bf16 v[88:103], v[68:71], v[164:167], v[88:103]
    v_max3_f32 v216, v216, v114, v115
    v_max3_f32 v216, v216, v116, v117
    v_max3_f32 v216, v216, v118, v119
    v_max3_f32 v216, v216, v120, v121
    v_max3_f32 v216, v216, v122, v123
    s_waitcnt lgkmcnt(3)
    v_mfma_f32_32x32x16_bf16 v[104:119], v[72:75], v[160:163], 0
    v_max3_f32 v216, v216, v124, v125
    v_max3_f32 v216, v216, v126, v127
    v_max3_f32 v216, v216, v128, v129
    v_max3_f32 v216, v216, v130, v131
    v_max3_f32 v216, v216, v132, v133
    s_waitcnt lgkmcnt(2)
    v_mfma_f32_32x32x16_bf16 v[104:119], v[76:79], v[164:167], v[104:119]
    v_max3_f32 v216, v216, v134, v135
    v_max3_f32 v216, v216, v88, v89
    v_max3_f32 v216, v216, v90, v91
    v_max3_f32 v216, v216, v92, v93
    v_max3_f32 v216, v216, v94, v95
    s_waitcnt lgkmcnt(1)
    v_mfma_f32_32x32x16_bf16 v[120:135], v[80:83], v[160:163], 0
    v_max3_f32 v216, v216, v96, v97
    v_max3_f32 v216, v216, v98, v99
    v_max3_f32 v216, v216, v100, v101
    v_max3_f32 v216, v216, v102, v103
    s_waitcnt lgkmcnt(0)
    v_mfma_f32_32x32x16_bf16 v[120:135], v[84:87], v[164:167], v[120:135]
    v_max3_f32 v216, v216, v104, v105
    v_max3_f32 v216, v216, v106, v107
    v_max3_f32 v216, v216, v108, v109
    v_max3_f32 v216, v216, v110, v111
    v_max3_f32 v216, v216, v112, v113
    v_max3_f32 v216, v216, v114, v115
    v_max3_f32 v216, v216, v116, v117
    v_max3_f32 v216, v216, v118, v119
    s_nop 3
    v_max3_f32 v216, v216, v120, v121
    v_max3_f32 v216, v216, v122, v123
    v_max3_f32 v216, v216, v124, v125
    v_max3_f32 v216, v216, v126, v127
    v_max3_f32 v216, v216, v128, v129
    v_max3_f32 v216, v216, v130, v131
    v_max3_f32 v216, v216, v132, v133
    v_max3_f32 v216, v216, v134, v135
    v_mov_b32 v217, v216
    s_nop 1
    v_permlane32_swap_b32 v216, v217
    v_max_f32 v216, v216, v217
    v_sub_f32 v136, 0, v216
    v_sub_f32 v137, 0, v216
    v_sub_f32 v138, 0, v216
    v_sub_f32 v139, 0, v216
    v_sub_f32 v140, 0, v216
    v_sub_f32 v141, 0, v216
    v_sub_f32 v142, 0, v216
    v_sub_f32 v143, 0, v216
    v_sub_f32 v144, 0, v216
    v_sub_f32 v145, 0, v216
    v_sub_f32 v146, 0, v216
    v_sub_f32 v147, 0, v216
    v_sub_f32 v148, 0, v216
    v_sub_f32 v149, 0, v216
    v_sub_f32 v150, 0, v216
    v_sub_f32 v151, 0, v216
    s_cmp_lt_u32 s14, 2
    s_cbranch_scc0 Loth_62
    s_waitcnt vmcnt(0)
Loth_62:
    s_barrier
    v_mfma_f32_32x32x16_bf16 v[88:103], v[16:19], v[160:163], v[136:151]
    s_add_u32 s34, s38, 38912
    s_add_u32 m0, s37, 88064
    s_nop 0
    buffer_load_dwordx4 v0, s[4:7], s34 offen offset:0 sc1 lds
    v_mfma_f32_32x32x16_bf16 v[88:103], v[20:23], v[164:167], v[88:103]
    v_mfma_f32_32x32x16_bf16 v[104:119], v[24:27], v[160:163], v[136:151]
    s_add_u32 s34, s38, 39936
    s_add_u32 m0, s37, 89088
    s_nop 0
    buffer_load_dwordx4 v0, s[4:7], s34 offen offset:0 sc1 lds
    v_mfma_f32_32x32x16_bf16 v[104:119], v[28:31], v[164:167], v[104:119]
    v_mfma_f32_32x32x16_bf16 v[120:135], v[32:35], v[160:163], v[136:151]
    ds_read_b128 v[192:195], v168 offset:34816
    s_add_u32 s34, s38, 40960
    s_add_u32 m0, s37, 90112
    s_nop 0
    buffer_load_dwordx4 v0, s[4:7], s34 offen offset:0 sc1 lds
    s_nop 5
    v_cndmask_b32 v104, v104, v88, s[64:65]
    v_cndmask_b32 v105, v105, v89, s[66:67]
    v_cndmask_b32 v106, v106, v90, s[68:69]
    v_cndmask_b32 v107, v107, v91, s[70:71]
    v_cndmask_b32 v108, v108, v92, s[72:73]
    v_cndmask_b32 v109, v109, v93, s[74:75]
    v_cndmask_b32 v110, v110, v94, s[76:77]
    v_mfma_f32_32x32x16_bf16 v[120:135], v[36:39], v[164:167], v[120:135]
    ds_read_b128 v[196:199], v168 offset:35840
    v_cndmask_b32 v111, v111, v95, s[78:79]
    v_cndmask_b32 v112, v112, v96, s[80:81]
    v_cndmask_b32 v113, v113, v97, s[82:83]
    v_cndmask_b32 v114, v114, v98, s[84:85]
    v_cndmask_b32 v115, v115, v99, s[86:87]
    v_cndmask_b32 v116, v116, v100, s[88:89]
    v_cndmask_b32 v117, v117, v101, s[90:91]
    v_cndmask_b32 v118, v118, v102, s[92:93]
    v_cndmask_b32 v119, v119, v103, s[94:95]
    v_mfma_f32_32x32x16_bf16 v[88:103], v[40:43], v[160:163], v[136:151]
    ds_read_b128 v[200:203], v168 offset:2048
    s_add_u32 s34, s38, 41984
    s_add_u32 m0, s37, 91136
    s_nop 0
    buffer_load_dwordx4 v0, s[4:7], s34 offen offset:0 sc1 lds
    v_exp_f32 v104, v104
    v_exp_f32 v105, v105
    v_exp_f32 v106, v106
    v_mfma_f32_32x32x16_bf16 v[88:103], v[44:47], v[164:167], v[88:103]
    ds_read_b128 v[204:207], v168 offset:3072
    v_exp_f32 v107, v107
    v_cvt_pk_bf16_f32 v104, v104, v105
    v_exp_f32 v108, v108
    v_exp_f32 v109, v109
    v_cvt_pk_bf16_f32 v105, v106, v107
    v_exp_f32 v110, v110
    v_exp_f32 v111, v111
    v_cvt_pk_bf16_f32 v106, v108, v109
    v_exp_f32 v112, v112
    v_exp_f32 v113, v113
    v_cvt_pk_bf16_f32 v107, v110, v111
    v_exp_f32 v114, v114
    v_exp_f32 v115, v115
    v_cvt_pk_bf16_f32 v108, v112, v113
    v_exp_f32 v116, v116
    v_exp_f32 v117, v117
    v_cvt_pk_bf16_f32 v109, v114, v115
    v_exp_f32 v118, v118
    v_exp_f32 v119, v119
    v_cvt_pk_bf16_f32 v110, v116, v117
    v_cvt_pk_bf16_f32 v111, v118, v119
    v_bfi_b32 v112, v152, 0, v104
    v_and_b32 v104, v152, v104
    v_bfi_b32 v113, v153, 0, v105
    v_and_b32 v105, v153, v105
    v_bfi_b32 v114, v154, 0, v106
    v_and_b32 v106, v154, v106
    v_bfi_b32 v115, v155, 0, v107
    v_and_b32 v107, v155, v107
    v_bfi_b32 v116, v156, 0, v108
    v_and_b32 v108, v156, v108
    v_bfi_b32 v117, v157, 0, v109
    v_and_b32 v109, v157, v109
    v_bfi_b32 v118, v158, 0, v110
    v_and_b32 v110, v158, v110
    v_bfi_b32 v119, v159, 0, v111
    v_and_b32 v111, v159, v111
    s_waitcnt lgkmcnt(3)
    v_mfma_f32_32x32x16_bf16 v[176:191], v[192:195], v[104:107], 0
    s_add_u32 s34, s38, 43008
    s_add_u32 m0, s37, 92160
    s_nop 0
    buffer_load_dwordx4 v0, s[4:7], s34 offen offset:0 sc1 lds
    v_exp_f32 v120, v120
    v_exp_f32 v121, v121
    v_exp_f32 v122, v122
    v_exp_f32 v123, v123
    s_waitcnt lgkmcnt(2)
    v_mfma_f32_32x32x16_bf16 v[176:191], v[196:199], v[108:111], v[176:191]
    v_cvt_pk_bf16_f32 v120, v120, v121
    v_exp_f32 v124, v124
    v_exp_f32 v125, v125
    v_cvt_pk_bf16_f32 v121, v122, v123
    v_exp_f32 v126, v126
    v_exp_f32 v127, v127
    s_waitcnt lgkmcnt(1)
    v_mfma_f32_32x32x16_bf16 v[176:191], v[200:203], v[112:115], v[176:191]
    ds_read_b128 v[208:211], v168 offset:6144
    s_add_u32 s34, s38, 44032
    s_add_u32 m0, s37, 93184
    s_nop 0
    buffer_load_dwordx4 v0, s[4:7], s34 offen offset:0 sc1 lds
    v_cvt_pk_bf16_f32 v122, v124, v125
    v_exp_f32 v128, v128
    v_exp_f32 v129, v129
    v_cvt_pk_bf16_f32 v123, v126, v127
    s_waitcnt lgkmcnt(1)
    v_mfma_f32_32x32x16_bf16 v[176:191], v[204:207], v[116:119], v[176:191]
    ds_read_b128 v[212:215], v168 offset:7168
    v_exp_f32 v130, v130
    v_exp_f32 v131, v131
    v_cvt_pk_bf16_f32 v124, v128, v129
    v_exp_f32 v132, v132
    v_exp_f32 v133, v133
    v_mfma_f32_32x32x16_bf16 v[104:119], v[48:51], v[160:163], v[136:151]
    s_add_u32 s34, s38, 45056
    s_add_u32 m0, s37, 94208
    s_nop 0
    buffer_load_dwordx4 v0, s[4:7], s34 offen offset:0 sc1 lds
    v_cvt_pk_bf16_f32 v125, v130, v131
    v_exp_f32 v134, v134
    v_exp_f32 v135, v135
    v_cvt_pk_bf16_f32 v126, v132, v133
    v_cvt_pk_bf16_f32 v127, v134, v135
    v_mfma_f32_32x32x16_bf16 v[104:119], v[52:55], v[164:167], v[104:119]
    v_exp_f32 v88, v88
    v_exp_f32 v89, v89
    v_exp_f32 v90, v90
    v_exp_f32 v91, v91
    v_cvt_pk_bf16_f32 v88, v88, v89
    s_waitcnt lgkmcnt(1)
    v_mfma_f32_32x32x16_bf16 v[176:191], v[208:211], v[120:123], v[176:191]
    ds_read_b128 v[192:195], v168 offset:10240
    s_add_u32 s34, s38, 46080
    s_add_u32 m0, s37, 95232
    s_nop 0
    buffer_load_dwordx4 v0, s[4:7], s34 offen offset:0 sc1 lds
    v_exp_f32 v92, v92
    v_exp_f32 v93, v93
    v_cvt_pk_bf16_f32 v89, v90, v91
    v_exp_f32 v94, v94
    s_waitcnt lgkmcnt(1)
    v_mfma_f32_32x32x16_bf16 v[176:191], v[212:215], v[124:127], v[176:191]
    ds_read_b128 v[196:199], v168 offset:11264
    v_exp_f32 v95, v95
    v_cvt_pk_bf16_f32 v90, v92, v93
    v_exp_f32 v96, v96
    v_exp_f32 v97, v97
    v_cvt_pk_bf16_f32 v91, v94, v95
    v_mfma_f32_32x32x16_bf16 v[120:135], v[56:59], v[160:163], v[136:151]
    s_add_u32 s34, s38, 47104
    s_add_u32 m0, s37, 96256
    s_nop 0
    buffer_load_dwordx4 v0, s[4:7], s34 offen offset:0 sc1 lds
    v_exp_f32 v98, v98
    v_exp_f32 v99, v99
    v_cvt_pk_bf16_f32 v92, v96, v97
    v_exp_f32 v100, v100
    v_mfma_f32_32x32x16_bf16 v[120:135], v[60:63], v[164:167], v[120:135]
    v_exp_f32 v101, v101
    v_cvt_pk_bf16_f32 v93, v98, v99
    v_exp_f32 v102, v102
    v_exp_f32 v103, v103
    v_cvt_pk_bf16_f32 v94, v100, v101
    v_cvt_pk_bf16_f32 v95, v102, v103
    s_waitcnt lgkmcnt(1)
    v_mfma_f32_32x32x16_bf16 v[176:191], v[192:195], v[88:91], v[176:191]
    ds_read_b128 v[200:203], v168 offset:14336
    s_add_u32 s34, s38, 48128
    s_add_u32 m0, s37, 97280
    s_nop 0
    buffer_load_dwordx4 v0, s[4:7], s34 offen offset:0 sc1 lds
    v_exp_f32 v104, v104
    v_exp_f32 v105, v105
    v_exp_f32 v106, v106
    s_waitcnt lgkmcnt(1)
    v_mfma_f32_32x32x16_bf16 v[176:191], v[196:199], v[92:95], v[176:191]
    ds_read_b128 v[204:207], v168 offset:15360
    v_exp_f32 v107, v107
    v_cvt_pk_bf16_f32 v104, v104, v105
    v_exp_f32 v108, v108
    v_exp_f32 v109, v109
    v_cvt_pk_bf16_f32 v105, v106, v107
    v_mfma_f32_32x32x16_bf16 v[88:103], v[64:67], v[160:163], v[136:151]
    s_add_u32 s34, s38, 49152
    s_add_u32 m0, s37, 98304
    s_nop 0
    buffer_load_dwordx4 v0, s[4:7], s34 offen offset:0 sc1 lds
    v_exp_f32 v110, v110
    v_exp_f32 v111, v111
    v_cvt_pk_bf16_f32 v106, v108, v109
    v_exp_f32 v112, v112
    v_mfma_f32_32x32x16_bf16 v[88:103], v[68:71], v[164:167], v[88:103]
    v_exp_f32 v113, v113
    v_cvt_pk_bf16_f32 v107, v110, v111
    v_exp_f32 v114, v114
    v_exp_f32 v115, v115
    v_cvt_pk_bf16_f32 v108, v112, v113
    v_exp_f32 v116, v116
    v_exp_f32 v117, v117
    v_cvt_pk_bf16_f32 v109, v114, v115
    v_exp_f32 v118, v118
    v_exp_f32 v119, v119
    v_cvt_pk_bf16_f32 v110, v116, v117
    v_cvt_pk_bf16_f32 v111, v118, v119
    s_waitcnt lgkmcnt(1)
    v_mfma_f32_32x32x16_bf16 v[176:191], v[200:203], v[104:107], v[176:191]
    ds_read_b128 v[208:211], v168 offset:18432
    s_add_u32 s34, s38, 50176
    s_add_u32 m0, s37, 99328
    s_nop 0
    buffer_load_dwordx4 v0, s[4:7], s34 offen offset:0 sc1 lds
    v_exp_f32 v120, v120
    v_exp_f32 v121, v121
    v_exp_f32 v122, v122
    s_waitcnt lgkmcnt(1)
    v_mfma_f32_32x32x16_bf16 v[176:191], v[204:207], v[108:111], v[176:191]
    ds_read_b128 v[212:215], v168 offset:19456
    v_exp_f32 v123, v123
    v_cvt_pk_bf16_f32 v120, v120, v121
    v_exp_f32 v124, v124
    v_exp_f32 v125, v125
    v_cvt_pk_bf16_f32 v121, v122, v123
    v_mfma_f32_32x32x16_bf16 v[104:119], v[72:75], v[160:163], v[136:151]
    s_add_u32 s34, s38, 51200
    s_add_u32 m0, s37, 100352
    s_nop 0
    buffer_load_dwordx4 v0, s[4:7], s34 offen offset:0 sc1 lds
    v_exp_f32 v126, v126
    v_exp_f32 v127, v127
    v_cvt_pk_bf16_f32 v122, v124, v125
    v_exp_f32 v128, v128
    v_mfma_f32_32x32x16_bf16 v[104:119], v[76:79], v[164:167], v[104:119]
    v_exp_f32 v129, v129
    v_cvt_pk_bf16_f32 v123, v126, v127
    v_exp_f32 v130, v130
    v_exp_f32 v131, v131
    v_cvt_pk_bf16_f32 v124, v128, v129
    v_exp_f32 v132, v132
    v_exp_f32 v133, v133
    v_cvt_pk_bf16_f32 v125, v130, v131
    v_exp_f32 v134, v134
    v_exp_f32 v135, v135
    v_cvt_pk_bf16_f32 v126, v132, v133
    v_cvt_pk_bf16_f32 v127, v134, v135
    s_waitcnt lgkmcnt(1)
    v_mfma_f32_32x32x16_bf16 v[176:191], v[208:211], v[120:123], v[176:191]
    ds_read_b128 v[192:195], v168 offset:22528
    s_add_u32 s34, s38, 52224
    s_add_u32 m0, s37, 101376
    s_nop 0
    buffer_load_dwordx4 v0, s[4:7], s34 offen offset:0 sc1 lds
    v_exp_f32 v88, v88
    v_exp_f32 v89, v89
    v_exp_f32 v90, v90
    s_waitcnt lgkmcnt(1)
    v_mfma_f32_32x32x16_bf16 v[176:191], v[212:215], v[124:127], v[176:191]
    ds_read_b128 v[196:199], v168 offset:23552
    v_exp_f32 v91, v91
    v_cvt_pk_bf16_f32 v88, v88, v89
    v_exp_f32 v92, v92
    v_exp_f32 v93, v93
    v_cvt_pk_bf16_f32 v89, v90, v91
    v_mfma_f32_32x32x16_bf16 v[120:135], v[80:83], v[160:163], v[136:151]
    ds_read_b128 v[200:203], v168 offset:26624
    s_add_u32 s34, s38, 53248
    s_add_u32 m0, s37, 102400
    s_nop 0
    buffer_load_dwordx4 v0, s[4:7], s34 offen offset:0 sc1 lds
    v_exp_f32 v94, v94
    v_exp_f32 v95, v95
    v_cvt_pk_bf16_f32 v90, v92, v93
    v_exp_f32 v96, v96
    v_mfma_f32_32x32x16_bf16 v[120:135], v[84:87], v[164:167], v[120:135]
    ds_read_b128 v[204:207], v168 offset:27648
    v_exp_f32 v97, v97
    v_cvt_pk_bf16_f32 v91, v94, v95
    v_exp_f32 v98, v98
    v_exp_f32 v99, v99
    v_cvt_pk_bf16_f32 v92, v96, v97
    v_exp_f32 v100, v100
    v_exp_f32 v101, v101
    v_cvt_pk_bf16_f32 v93, v98, v99
    v_exp_f32 v102, v102
    v_exp_f32 v103, v103
    v_cvt_pk_bf16_f32 v94, v100, v101
    v_cvt_pk_bf16_f32 v95, v102, v103
    s_waitcnt lgkmcnt(3)
    v_mfma_f32_32x32x16_bf16 v[176:191], v[192:195], v[88:91], v[176:191]
    ds_read_b128 v[208:211], v168 offset:30720
    s_add_u32 s34, s38, 54272
    s_add_u32 m0, s37, 103424
    s_nop 0
    buffer_load_dwordx4 v0, s[4:7], s34 offen offset:0 sc1 lds
    v_exp_f32 v104, v104
    v_exp_f32 v105, v105
    v_exp_f32 v106, v106
    s_waitcnt lgkmcnt(3)
    v_mfma_f32_32x32x16_bf16 v[176:191], v[196:199], v[92:95], v[176:191]
    ds_read_b128 v[212:215], v168 offset:31744
    v_exp_f32 v107, v107
    v_cvt_pk_bf16_f32 v104, v104, v105
    v_exp_f32 v108, v108
    v_exp_f32 v109, v109
    v_cvt_pk_bf16_f32 v105, v106, v107
    v_exp_f32 v110, v110
    v_exp_f32 v111, v111
    v_cvt_pk_bf16_f32 v106, v108, v109
    v_exp_f32 v112, v112
    v_exp_f32 v113, v113
    v_cvt_pk_bf16_f32 v107, v110, v111
    v_exp_f32 v114, v114
    v_exp_f32 v115, v115
    v_cvt_pk_bf16_f32 v108, v112, v113
    v_exp_f32 v116, v116
    v_exp_f32 v117, v117
    v_cvt_pk_bf16_f32 v109, v114, v115
    v_exp_f32 v118, v118
    v_exp_f32 v119, v119
    v_cvt_pk_bf16_f32 v110, v116, v117
    v_cvt_pk_bf16_f32 v111, v118, v119
    s_waitcnt lgkmcnt(3)
    v_mfma_f32_32x32x16_bf16 v[176:191], v[200:203], v[104:107], v[176:191]
    s_add_u32 s34, s38, 55296
    s_add_u32 m0, s37, 104448
    s_nop 0
    buffer_load_dwordx4 v0, s[4:7], s34 offen offset:0 sc1 lds
    v_exp_f32 v120, v120
    v_exp_f32 v121, v121
    v_exp_f32 v122, v122
    v_exp_f32 v123, v123
    s_waitcnt lgkmcnt(2)
    v_mfma_f32_32x32x16_bf16 v[176:191], v[204:207], v[108:111], v[176:191]
    v_cvt_pk_bf16_f32 v120, v120, v121
    v_exp_f32 v124, v124
    v_exp_f32 v125, v125
    v_cvt_pk_bf16_f32 v121, v122, v123
    v_exp_f32 v126, v126
    v_exp_f32 v127, v127
    v_cvt_pk_bf16_f32 v122, v124, v125
    v_exp_f32 v128, v128
    v_exp_f32 v129, v129
    v_cvt_pk_bf16_f32 v123, v126, v127
    v_exp_f32 v130, v130
    v_exp_f32 v131, v131
    v_cvt_pk_bf16_f32 v124, v128, v129
    v_exp_f32 v132, v132
    v_exp_f32 v133, v133
    v_cvt_pk_bf16_f32 v125, v130, v131
    v_exp_f32 v134, v134
    v_exp_f32 v135, v135
    v_cvt_pk_bf16_f32 v126, v132, v133
    v_cvt_pk_bf16_f32 v127, v134, v135
    s_waitcnt lgkmcnt(1)
    v_mfma_f32_32x32x16_bf16 v[176:191], v[208:211], v[120:123], v[176:191]
    s_waitcnt lgkmcnt(0)
    v_mfma_f32_32x32x16_bf16 v[176:191], v[212:215], v[124:127], v[176:191]
    s_nop 11
    v_mov_b32 v216, v188
    v_mov_b32 v217, v188
    s_nop 1
    v_permlane32_swap_b32 v216, v217
    v_rcp_f32 v217, v217
    s_nop 0
    v_mul_f32 v176, v217, v176
    v_mul_f32 v177, v217, v177
    v_mul_f32 v178, v217, v178
    v_mul_f32 v179, v217, v179
    v_mul_f32 v180, v217, v180
    v_mul_f32 v181, v217, v181
    v_mul_f32 v182, v217, v182
    v_mul_f32 v183, v217, v183
    v_cvt_pk_bf16_f32 v176, v176, v177
    v_cvt_pk_bf16_f32 v177, v178, v179
    v_cvt_pk_bf16_f32 v178, v180, v181
    v_cvt_pk_bf16_f32 v179, v182, v183
    buffer_store_dwordx4 v[176:179], v0, s[96:99], s21 offen offset:0
    buffer_store_dwordx4 v[176:179], v0, s[0:3], s21 offen offset:0 sc1
    v_mul_f32 v184, v217, v184
    v_mul_f32 v185, v217, v185
    v_mul_f32 v186, v217, v186
    v_mul_f32 v187, v217, v187
    v_mul_f32 v188, v217, v188
    v_mul_f32 v189, v217, v189
    v_mul_f32 v190, v217, v190
    v_mul_f32 v191, v217, v191
    v_cvt_pk_bf16_f32 v184, v184, v185
    v_cvt_pk_bf16_f32 v185, v186, v187
    v_cvt_pk_bf16_f32 v186, v188, v189
    v_cvt_pk_bf16_f32 v187, v190, v191
    buffer_store_dwordx4 v[184:187], v0, s[96:99], s21 offen offset:1024
    buffer_store_dwordx4 v[184:187], v0, s[0:3], s21 offen offset:1024 sc1
    s_waitcnt vmcnt(0) lgkmcnt(0)
    s_barrier
    s_cmp_eq_u32 s14, 0
    s_cbranch_scc0 Loth_65
    s_add_u32 s34, s30, 0
    v_mov_b32 v220, s100
    v_mov_b32 v221, s101
    s_mov_b64 exec, 1
    buffer_store_dwordx2 v[220:221], v0, s[96:99], s34 offen
    buffer_store_dwordx2 v[220:221], v0, s[0:3], s34 offen sc1
    s_mov_b64 exec, -1
Loth_65:
    s_cmp_ge_u32 s13, 14
    s_cbranch_scc1 Lp3end_64
    v_lshlrev_b32 v16, 16, v8
    v_and_b32 v17, 0xffff0000, v8
    v_lshlrev_b32 v18, 16, v9
    v_and_b32 v19, 0xffff0000, v9
    v_lshlrev_b32 v20, 16, v10
    v_and_b32 v21, 0xffff0000, v10
    v_lshlrev_b32 v22, 16, v11
    v_and_b32 v23, 0xffff0000, v11
    v_lshlrev_b32 v24, 16, v12
    v_and_b32 v25, 0xffff0000, v12
    v_lshlrev_b32 v26, 16, v13
    v_and_b32 v27, 0xffff0000, v13
    v_lshlrev_b32 v28, 16, v14
    v_and_b32 v29, 0xffff0000, v14
    v_lshlrev_b32 v30, 16, v15
    v_and_b32 v31, 0xffff0000, v15
    s_xor_b32 s34, s14, 1
    s_mul_i32 s34, s34, 12288
    s_add_u32 s34, s34, 0
    v_add_u32 v208, s34, v0
    s_xor_b32 s34, s14, 2
    s_mul_i32 s34, s34, 12288
    s_add_u32 s34, s34, 4096
    v_add_u32 v209, s34, v0
    s_xor_b32 s34, s14, 3
    s_mul_i32 s34, s34, 12288
    s_add_u32 s34, s34, 8192
    v_add_u32 v210, s34, v0
    s_mul_i32 s34, s14, 12288
    v_add_u32 v211, s34, v0
    v_mov_b32 v212, 0
    v_mov_b32 v213, 0
    v_mov_b32 v214, 0
    v_mov_b32 v215, 0
    v_mov_b32 v216, 0x3f803f80
    v_and_b32 v217, 0xf8, v7
    s_cmp_eq_u32 s14, 0
    s_cbranch_scc0 Loth_67
    s_add_u32 s34, s29, 0
    s_mov_b32 exec_lo, 0xffff
    s_mov_b32 exec_hi, 0
Lpoll_69:
    buffer_load_dwordx2 v[220:221], v7, s[4:7], s34 offen sc1
    s_waitcnt vmcnt(0)
    s_waitcnt vmcnt(0)
    v_cmp_eq_u64 vcc, s[100:101], v[220:221]
    s_sub_u32 s33, s33, 1
    s_cmp_eq_u32 s33, 0
    s_cbranch_scc1 main_done
    s_cmp_eq_u64 vcc, exec
    s_cbranch_scc0 Lpoll_69
    s_mov_b64 exec, -1
Loth_67:
    s_barrier
    s_add_u32 s36, s22, 0
    buffer_load_dwordx4 v[80:83], v0, s[4:7], s36 offen offset:0 sc1
    s_add_u32 s37, s23, 0
    buffer_load_dwordx4 v[84:87], v0, s[4:7], s37 offen offset:0 sc1
    buffer_load_dwordx4 v[88:91], v0, s[4:7], s36 offen offset:1024 sc1
    buffer_load_dwordx4 v[92:95], v0, s[4:7], s37 offen offset:1024 sc1
    buffer_load_dwordx4 v[96:99], v0, s[4:7], s36 offen offset:2048 sc1
    buffer_load_dwordx4 v[100:103], v0, s[4:7], s37 offen offset:2048 sc1
    buffer_load_dwordx4 v[104:107], v0, s[4:7], s36 offen offset:3072 sc1
    buffer_load_dwordx4 v[108:111], v0, s[4:7], s37 offen offset:3072 sc1
    s_add_u32 s36, s22, 4096
    buffer_load_dwordx4 v[112:115], v0, s[4:7], s36 offen offset:0 sc1
    s_add_u32 s37, s23, 4096
    buffer_load_dwordx4 v[116:119], v0, s[4:7], s37 offen offset:0 sc1
    s_waitcnt vmcnt(9)
    v_mfma_f32_32x32x16_bf16 v[32:47], a[228:231], v[80:83], 0
    buffer_load_dwordx4 v[120:123], v0, s[4:7], s36 offen offset:1024 sc1
    v_mfma_f32_32x32x16_bf16 v[16:31], a[224:227], v[80:83], v[16:31]
    s_waitcnt vmcnt(9)
    v_mfma_f32_32x32x16_bf16 v[48:63], a[224:227], v[84:87], 0
    buffer_load_dwordx4 v[124:127], v0, s[4:7], s37 offen offset:1024 sc1
    v_mfma_f32_32x32x16_bf16 v[64:79], a[228:231], v[84:87], 0
    s_waitcnt vmcnt(9)
    v_mfma_f32_32x32x16_bf16 v[32:47], a[236:239], v[88:91], v[32:47]
    buffer_load_dwordx4 v[128:131], v0, s[4:7], s36 offen offset:2048 sc1
    v_mfma_f32_32x32x16_bf16 v[16:31], a[232:235], v[88:91], v[16:31]
    s_waitcnt vmcnt(9)
    v_mfma_f32_32x32x16_bf16 v[48:63], a[232:235], v[92:95], v[48:63]
    buffer_load_dwordx4 v[132:135], v0, s[4:7], s37 offen offset:2048 sc1
    v_mfma_f32_32x32x16_bf16 v[64:79], a[236:239], v[92:95], v[64:79]
    s_waitcnt vmcnt(9)
    v_mfma_f32_32x32x16_bf16 v[32:47], a[244:247], v[96:99], v[32:47]
    buffer_load_dwordx4 v[136:139], v0, s[4:7], s36 offen offset:3072 sc1
    v_mfma_f32_32x32x16_bf16 v[16:31], a[240:243], v[96:99], v[16:31]
    s_waitcnt vmcnt(9)
    v_mfma_f32_32x32x16_bf16 v[48:63], a[240:243], v[100:103], v[48:63]
    buffer_load_dwordx4 v[140:143], v0, s[4:7], s37 offen offset:3072 sc1
    v_mfma_f32_32x32x16_bf16 v[64:79], a[244:247], v[100:103], v[64:79]
    s_waitcnt vmcnt(9)
    v_mfma_f32_32x32x16_bf16 v[32:47], a[252:255], v[104:107], v[32:47]
    v_mfma_f32_32x32x16_bf16 v[16:31], a[248:251], v[104:107], v[16:31]
    s_waitcnt vmcnt(8)
    v_mfma_f32_32x32x16_bf16 v[48:63], a[248:251], v[108:111], v[48:63]
    v_mfma_f32_32x32x16_bf16 v[64:79], a[252:255], v[108:111], v[64:79]
    s_waitcnt vmcnt(7)
    v_mfma_f32_32x32x16_bf16 v[32:47], v[228:231], v[112:115], v[32:47]
    v_mfma_f32_32x32x16_bf16 v[16:31], v[224:227], v[112:115], v[16:31]
    s_waitcnt vmcnt(6)
    v_mfma_f32_32x32x16_bf16 v[48:63], v[224:227], v[116:119], v[48:63]
    v_mfma_f32_32x32x16_bf16 v[64:79], v[228:231], v[116:119], v[64:79]
    s_waitcnt vmcnt(5)
    v_mfma_f32_32x32x16_bf16 v[32:47], v[236:239], v[120:123], v[32:47]
    v_mfma_f32_32x32x16_bf16 v[16:31], v[232:235], v[120:123], v[16:31]
    s_waitcnt vmcnt(4)
    v_mfma_f32_32x32x16_bf16 v[48:63], v[232:235], v[124:127], v[48:63]
    v_mfma_f32_32x32x16_bf16 v[64:79], v[236:239], v[124:127], v[64:79]
    s_waitcnt vmcnt(3)
    v_mfma_f32_32x32x16_bf16 v[32:47], v[244:247], v[128:131], v[32:47]
    v_mfma_f32_32x32x16_bf16 v[16:31], v[240:243], v[128:131], v[16:31]
    s_waitcnt vmcnt(2)
    v_mfma_f32_32x32x16_bf16 v[48:63], v[240:243], v[132:135], v[48:63]
    v_mfma_f32_32x32x16_bf16 v[64:79], v[244:247], v[132:135], v[64:79]
    s_waitcnt vmcnt(1)
    v_mfma_f32_32x32x16_bf16 v[32:47], v[252:255], v[136:139], v[32:47]
    s_waitcnt vmcnt(0)
    v_mfma_f32_32x32x16_bf16 v[48:63], v[248:251], v[140:143], v[48:63]
    v_mfma_f32_32x32x16_bf16 v[64:79], v[252:255], v[140:143], v[64:79]
    s_nop 8
    ds_write_b128 v208, v[32:35] offset:0
    ds_write_b128 v208, v[36:39] offset:1024
    v_mfma_f32_32x32x16_bf16 v[16:31], v[248:251], v[136:139], v[16:31]
    ds_write_b128 v208, v[40:43] offset:2048
    ds_write_b128 v208, v[44:47] offset:3072
    ds_write_b128 v209, v[48:51] offset:0
    ds_write_b128 v209, v[52:55] offset:1024
    ds_write_b128 v209, v[56:59] offset:2048
    ds_write_b128 v209, v[60:63] offset:3072
    ds_write_b128 v210, v[64:67] offset:0
    ds_write_b128 v210, v[68:71] offset:1024
    ds_write_b128 v210, v[72:75] offset:2048
    ds_write_b128 v210, v[76:79] offset:3072
    s_waitcnt lgkmcnt(0)
    s_barrier
    ds_read_b128 v[80:83], v211 offset:0
    ds_read_b128 v[96:99], v211 offset:4096
    ds_read_b128 v[112:115], v211 offset:8192
    ds_read_b128 v[84:87], v211 offset:1024
    ds_read_b128 v[100:103], v211 offset:5120
    ds_read_b128 v[116:119], v211 offset:9216
    ds_read_b128 v[88:91], v211 offset:2048
    ds_read_b128 v[104:107], v211 offset:6144
    ds_read_b128 v[120:123], v211 offset:10240
    ds_read_b128 v[92:95], v211 offset:3072
    ds_read_b128 v[108:111], v211 offset:7168
    ds_read_b128 v[124:127], v211 offset:11264
    s_waitcnt lgkmcnt(11)
    v_add_f32 v16, v16, v80
    v_add_f32 v17, v17, v81
    v_add_f32 v18, v18, v82
    v_add_f32 v19, v19, v83
    s_waitcnt lgkmcnt(10)
    v_add_f32 v16, v16, v96
    v_add_f32 v17, v17, v97
    v_add_f32 v18, v18, v98
    v_add_f32 v19, v19, v99
    s_waitcnt lgkmcnt(9)
    v_add_f32 v16, v16, v112
    v_add_f32 v17, v17, v113
    v_add_f32 v18, v18, v114
    v_add_f32 v19, v19, v115
    s_waitcnt lgkmcnt(8)
    v_add_f32 v20, v20, v84
    v_add_f32 v21, v21, v85
    v_add_f32 v22, v22, v86
    v_add_f32 v23, v23, v87
    s_waitcnt lgkmcnt(7)
    v_add_f32 v20, v20, v100
    v_add_f32 v21, v21, v101
    v_add_f32 v22, v22, v102
    v_add_f32 v23, v23, v103
    s_waitcnt lgkmcnt(6)
    v_add_f32 v20, v20, v116
    v_add_f32 v21, v21, v117
    v_add_f32 v22, v22, v118
    v_add_f32 v23, v23, v119
    v_cvt_pk_bf16_f32 v8, v16, v17
    v_cvt_pk_bf16_f32 v9, v18, v19
    v_cvt_pk_bf16_f32 v10, v20, v21
    v_cvt_pk_bf16_f32 v11, v22, v23
    s_add_u32 s34, s26, 114688
    buffer_store_dwordx4 v[8:11], v0, s[96:99], s34 offen offset:0
    buffer_store_dwordx4 v[8:11], v0, s[0:3], s34 offen offset:0 sc1
    v_dot2_f32_bf16 v212, v8, v216, v212
    v_dot2_f32_bf16 v213, v8, v8, v213
    v_dot2_f32_bf16 v214, v9, v216, v214
    v_dot2_f32_bf16 v215, v9, v9, v215
    v_dot2_f32_bf16 v212, v10, v216, v212
    v_dot2_f32_bf16 v213, v10, v10, v213
    v_dot2_f32_bf16 v214, v11, v216, v214
    v_dot2_f32_bf16 v215, v11, v11, v215
    s_waitcnt lgkmcnt(5)
    v_add_f32 v24, v24, v88
    v_add_f32 v25, v25, v89
    v_add_f32 v26, v26, v90
    v_add_f32 v27, v27, v91
    s_waitcnt lgkmcnt(4)
    v_add_f32 v24, v24, v104
    v_add_f32 v25, v25, v105
    v_add_f32 v26, v26, v106
    v_add_f32 v27, v27, v107
    s_waitcnt lgkmcnt(3)
    v_add_f32 v24, v24, v120
    v_add_f32 v25, v25, v121
    v_add_f32 v26, v26, v122
    v_add_f32 v27, v27, v123
    s_waitcnt lgkmcnt(2)
    v_add_f32 v28, v28, v92
    v_add_f32 v29, v29, v93
    v_add_f32 v30, v30, v94
    v_add_f32 v31, v31, v95
    s_waitcnt lgkmcnt(1)
    v_add_f32 v28, v28, v108
    v_add_f32 v29, v29, v109
    v_add_f32 v30, v30, v110
    v_add_f32 v31, v31, v111
    s_waitcnt lgkmcnt(0)
    v_add_f32 v28, v28, v124
    v_add_f32 v29, v29, v125
    v_add_f32 v30, v30, v126
    v_add_f32 v31, v31, v127
    v_cvt_pk_bf16_f32 v12, v24, v25
    v_cvt_pk_bf16_f32 v13, v26, v27
    v_cvt_pk_bf16_f32 v14, v28, v29
    v_cvt_pk_bf16_f32 v15, v30, v31
    buffer_store_dwordx4 v[12:15], v0, s[96:99], s34 offen offset:1024
    buffer_store_dwordx4 v[12:15], v0, s[0:3], s34 offen offset:1024 sc1
    v_dot2_f32_bf16 v212, v12, v216, v212
    v_dot2_f32_bf16 v213, v12, v12, v213
    v_dot2_f32_bf16 v214, v13, v216, v214
    v_dot2_f32_bf16 v215, v13, v13, v215
    v_dot2_f32_bf16 v212, v14, v216, v212
    v_dot2_f32_bf16 v213, v14, v14, v213
    v_dot2_f32_bf16 v214, v15, v216, v214
    v_dot2_f32_bf16 v215, v15, v15, v215
    s_add_u32 s35, s27, 372736
    s_nop 0
    v_add_f32 v212, v212, v214
    v_add_f32 v213, v213, v215
    v_mov_b32 v214, v212
    v_mov_b32 v215, v213
    s_nop 0
    v_permlane32_swap_b32 v212, v214
    v_permlane32_swap_b32 v213, v215
    v_add_f32 v212, v212, v214
    v_add_f32 v213, v213, v215
    buffer_store_dwordx2 v[212:213], v217, s[96:99], s35 offen
    buffer_store_dwordx2 v[212:213], v217, s[0:3], s35 offen sc1
    s_waitcnt vmcnt(0) lgkmcnt(0)
    s_barrier
    s_cmp_eq_u32 s14, 0
    s_cbranch_scc0 Loth_70
    s_add_u32 s34, s30, 4096
    v_mov_b32 v220, s100
    v_mov_b32 v221, s101
    s_mov_b64 exec, 1
    buffer_store_dwordx2 v[220:221], v0, s[96:99], s34 offen
    buffer_store_dwordx2 v[220:221], v0, s[0:3], s34 offen sc1
    s_mov_b64 exec, -1
Loth_70:
    s_branch Lp3x_72
Lp3end_64:
    s_getpc_b64 s[34:35]
Lpcb_73:
    s_lshl_b32 s36, s14, 13
    v_lshl_add_u32 v218, v0, 3, s36
    s_mov_b32 s36, main_done - Lpcb_73
    v_min_u32 v218, s36, v218
    global_load_dword v223, v218, s[34:35]
Lp3x_72:
    s_cmp_eq_u32 s14, 0
    s_cbranch_scc0 Loth_74
    s_add_u32 s34, s29, 4096
    s_mov_b32 exec_lo, 0x3fff
    s_mov_b32 exec_hi, 0
Lpoll_76:
    buffer_load_dwordx2 v[220:221], v7, s[4:7], s34 offen sc1
    s_waitcnt vmcnt(0)
    s_waitcnt vmcnt(0)
    v_cmp_eq_u64 vcc, s[100:101], v[220:221]
    s_sub_u32 s33, s33, 1
    s_cmp_eq_u32 s33, 0
    s_cbranch_scc1 main_done
    s_cmp_eq_u64 vcc, exec
    s_cbranch_scc0 Lpoll_76
    s_mov_b64 exec, -1
Loth_74:
    s_waitcnt vmcnt(0)
    s_mul_i32 s37, s14, 12288
    s_add_u32 s38, s49, s37
    s_barrier
    s_add_u32 s36, s15, 114688
    buffer_load_dwordx4 v[16:19], v0, s[4:7], s36 offen offset:0 sc1
    buffer_load_dwordx4 v[20:23], v0, s[4:7], s36 offen offset:1024 sc1
    buffer_load_dwordx4 v[24:27], v0, s[4:7], s36 offen offset:2048 sc1
    buffer_load_dwordx4 v[28:31], v0, s[4:7], s36 offen offset:3072 sc1
    s_add_u32 s36, s15, 118784
    buffer_load_dwordx4 v[32:35], v0, s[4:7], s36 offen offset:0 sc1
    buffer_load_dwordx4 v[36:39], v0, s[4:7], s36 offen offset:1024 sc1
    buffer_load_dwordx4 v[40:43], v0, s[4:7], s36 offen offset:2048 sc1
    buffer_load_dwordx4 v[44:47], v0, s[4:7], s36 offen offset:3072 sc1
    ds_read_b128 v[192:195], v0 offset:49152
    ds_read_b128 v[196:199], v1 offset:12288
    ds_read_b128 v[200:203], v1 offset:40960
    ds_read_b128 v[204:207], v0 offset:50176
    ds_read_b128 v[208:211], v1 offset:13312
    s_waitcnt vmcnt(7) lgkmcnt(4)
    v_mfma_f32_32x32x16_bf16 v[128:143], v[192:195], v[16:19], 0
    ds_read_b128 v[192:195], v1 offset:41984
    s_add_u32 s36, s15, 122880
    buffer_load_dwordx4 v[48:51], v0, s[4:7], s36 offen offset:0 sc1
    s_waitcnt lgkmcnt(4)
    v_mfma_f32_32x32x16_bf16 v[144:159], v[196:199], v[16:19], 0
    ds_read_b128 v[196:199], v0 offset:51200
    s_waitcnt lgkmcnt(4)
    v_mfma_f32_32x32x16_bf16 v[160:175], v[200:203], v[16:19], 0
    ds_read_b128 v[200:203], v1 offset:14336
    buffer_load_dwordx4 v[52:55], v0, s[4:7], s36 offen offset:1024 sc1
    s_waitcnt vmcnt(8) lgkmcnt(4)
    v_mfma_f32_32x32x16_bf16 v[128:143], v[204:207], v[20:23], v[128:143]
    ds_read_b128 v[204:207], v1 offset:43008
    s_waitcnt lgkmcnt(4)
    v_mfma_f32_32x32x16_bf16 v[144:159], v[208:211], v[20:23], v[144:159]
    ds_read_b128 v[208:211], v0 offset:52224
    buffer_load_dwordx4 v[56:59], v0, s[4:7], s36 offen offset:2048 sc1
    s_waitcnt lgkmcnt(4)
    v_mfma_f32_32x32x16_bf16 v[160:175], v[192:195], v[20:23], v[160:175]
    ds_read_b128 v[192:195], v1 offset:15360
    s_waitcnt vmcnt(8) lgkmcnt(4)
    v_mfma_f32_32x32x16_bf16 v[128:143], v[196:199], v[24:27], v[128:143]
    ds_read_b128 v[196:199], v1 offset:44032
    buffer_load_dwordx4 v[60:63], v0, s[4:7], s36 offen offset:3072 sc1
    s_waitcnt lgkmcnt(4)
    v_mfma_f32_32x32x16_bf16 v[144:159], v[200:203], v[24:27], v[144:159]
    ds_read_b128 v[200:203], v0 offset:53248
    s_waitcnt lgkmcnt(4)
    v_mfma_f32_32x32x16_bf16 v[160:175], v[204:207], v[24:27], v[160:175]
    ds_read_b128 v[204:207], v1 offset:16384
    s_add_u32 s36, s15, 126976
    buffer_load_dwordx4 v[64:67], v0, s[4:7], s36 offen offset:0 sc1
    s_waitcnt vmcnt(9) lgkmcnt(4)
    v_mfma_f32_32x32x16_bf16 v[128:143], v[208:211], v[28:31], v[128:143]
    ds_read_b128 v[208:211], v1 offset:45056
    s_waitcnt lgkmcnt(4)
    v_mfma_f32_32x32x16_bf16 v[144:159], v[192:195], v[28:31], v[144:159]
    ds_read_b128 v[192:195], v0 offset:54272
    buffer_load_dwordx4 v[68:71], v0, s[4:7], s36 offen offset:1024 sc1
    s_waitcnt lgkmcnt(4)
    v_mfma_f32_32x32x16_bf16 v[160:175], v[196:199], v[28:31], v[160:175]
    ds_read_b128 v[196:199], v1 offset:17408
    s_waitcnt vmcnt(9) lgkmcnt(4)
    v_mfma_f32_32x32x16_bf16 v[128:143], v[200:203], v[32:35], v[128:143]
    ds_read_b128 v[200:203], v1 offset:46080
    buffer_load_dwordx4 v[72:75], v0, s[4:7], s36 offen offset:2048 sc1
    s_waitcnt lgkmcnt(4)
    v_mfma_f32_32x32x16_bf16 v[144:159], v[204:207], v[32:35], v[144:159]
    ds_read_b128 v[204:207], v0 offset:55296
    s_waitcnt lgkmcnt(4)
    v_mfma_f32_32x32x16_bf16 v[160:175], v[208:211], v[32:35], v[160:175]
    ds_read_b128 v[208:211], v1 offset:18432
    buffer_load_dwordx4 v[76:79], v0, s[4:7], s36 offen offset:3072 sc1
    s_waitcnt vmcnt(10) lgkmcnt(4)
    v_mfma_f32_32x32x16_bf16 v[128:143], v[192:195], v[36:39], v[128:143]
    ds_read_b128 v[192:195], v1 offset:47104
    s_waitcnt lgkmcnt(4)
    v_mfma_f32_32x32x16_bf16 v[144:159], v[196:199], v[36:39], v[144:159]
    ds_read_b128 v[196:199], v0 offset:56320
    s_add_u32 s35, s32, 372736
    buffer_load_dwordx2 v[176:177], v7, s[4:7], s35 offen offset:0 sc1
    s_waitcnt lgkmcnt(4)
    v_mfma_f32_32x32x16_bf16 v[160:175], v[200:203], v[36:39], v[160:175]
    ds_read_b128 v[200:203], v1 offset:19456
    s_waitcnt vmcnt(10) lgkmcnt(4)
    v_mfma_f32_32x32x16_bf16 v[128:143], v[204:207], v[40:43], v[128:143]
    ds_read_b128 v[204:207], v1 offset:48128
    buffer_load_dwordx2 v[178:179], v7, s[4:7], s35 offen offset:512 sc1
    s_waitcnt lgkmcnt(4)
    v_mfma_f32_32x32x16_bf16 v[144:159], v[208:211], v[40:43], v[144:159]
    ds_read_b128 v[208:211], v0 offset:57344
    s_waitcnt lgkmcnt(4)
    v_mfma_f32_32x32x16_bf16 v[160:175], v[192:195], v[40:43], v[160:175]
    ds_read_b128 v[192:195], v1 offset:20480
    buffer_load_dwordx2 v[180:181], v7, s[4:7], s35 offen offset:1024 sc1
    s_waitcnt vmcnt(11) lgkmcnt(4)
    v_mfma_f32_32x32x16_bf16 v[128:143], v[196:199], v[44:47], v[128:143]
    ds_read_b128 v[196:199], v1 offset:49152
    s_waitcnt lgkmcnt(4)
    v_mfma_f32_32x32x16_bf16 v[144:159], v[200:203], v[44:47], v[144:159]
    ds_read_b128 v[200:203], v0 offset:58368
    buffer_load_dwordx2 v[182:183], v7, s[4:7], s35 offen offset:1536 sc1
    s_waitcnt lgkmcnt(4)
    v_mfma_f32_32x32x16_bf16 v[160:175], v[204:207], v[44:47], v[160:175]
    ds_read_b128 v[204:207], v1 offset:21504
    s_waitcnt vmcnt(11) lgkmcnt(4)
    v_mfma_f32_32x32x16_bf16 v[128:143], v[208:211], v[48:51], v[128:143]
    ds_read_b128 v[208:211], v1 offset:50176
    buffer_load_dwordx2 v[184:185], v7, s[4:7], s35 offen offset:2048 sc1
    s_waitcnt lgkmcnt(4)
    v_mfma_f32_32x32x16_bf16 v[144:159], v[192:195], v[48:51], v[144:159]
    ds_read_b128 v[192:195], v0 offset:59392
    s_waitcnt lgkmcnt(4)
    v_mfma_f32_32x32x16_bf16 v[160:175], v[196:199], v[48:51], v[160:175]
    ds_read_b128 v[196:199], v1 offset:22528
    buffer_load_dwordx2 v[186:187], v7, s[4:7], s35 offen offset:2560 sc1
    s_waitcnt vmcnt(12) lgkmcnt(4)
    v_mfma_f32_32x32x16_bf16 v[128:143], v[200:203], v[52:55], v[128:143]
    ds_read_b128 v[200:203], v1 offset:51200
    s_waitcnt lgkmcnt(4)
    v_mfma_f32_32x32x16_bf16 v[144:159], v[204:207], v[52:55], v[144:159]
    ds_read_b128 v[204:207], v0 offset:60416
    buffer_load_dwordx2 v[188:189], v7, s[4:7], s35 offen offset:3072 sc1
    s_waitcnt lgkmcnt(4)
    v_mfma_f32_32x32x16_bf16 v[160:175], v[208:211], v[52:55], v[160:175]
    ds_read_b128 v[208:211], v1 offset:23552
    s_waitcnt vmcnt(12) lgkmcnt(4)
    v_mfma_f32_32x32x16_bf16 v[128:143], v[192:195], v[56:59], v[128:143]
    ds_read_b128 v[192:195], v1 offset:52224
    s_add_u32 s36, s15, 131072
    buffer_load_dwordx4 v[80:83], v0, s[4:7], s36 offen offset:0 sc1
    s_waitcnt lgkmcnt(4)
    v_mfma_f32_32x32x16_bf16 v[144:159], v[196:199], v[56:59], v[144:159]
    ds_read_b128 v[196:199], v0 offset:61440
    s_waitcnt lgkmcnt(4)
    v_mfma_f32_32x32x16_bf16 v[160:175], v[200:203], v[56:59], v[160:175]
    ds_read_b128 v[200:203], v1 offset:24576
    buffer_load_dwordx4 v[84:87], v0, s[4:7], s36 offen offset:1024 sc1
    s_waitcnt vmcnt(13) lgkmcnt(4)
    v_mfma_f32_32x32x16_bf16 v[128:143], v[204:207], v[60:63], v[128:143]
    ds_read_b128 v[204:207], v1 offset:53248
    s_waitcnt lgkmcnt(4)
    v_mfma_f32_32x32x16_bf16 v[144:159], v[208:211], v[60:63], v[144:159]
    ds_read_b128 v[208:211], v0 offset:62464
    buffer_load_dwordx4 v[88:91], v0, s[4:7], s36 offen offset:2048 sc1
    s_waitcnt lgkmcnt(4)
    v_mfma_f32_32x32x16_bf16 v[160:175], v[192:195], v[60:63], v[160:175]
    ds_read_b128 v[192:195], v1 offset:25600
    s_waitcnt vmcnt(13) lgkmcnt(4)
    v_mfma_f32_32x32x16_bf16 v[128:143], v[196:199], v[64:67], v[128:143]
    ds_read_b128 v[196:199], v1 offset:54272
    buffer_load_dwordx4 v[92:95], v0, s[4:7], s36 offen offset:3072 sc1
    s_waitcnt lgkmcnt(4)
    v_mfma_f32_32x32x16_bf16 v[144:159], v[200:203], v[64:67], v[144:159]
    ds_read_b128 v[200:203], v0 offset:63488
    s_waitcnt lgkmcnt(4)
    v_mfma_f32_32x32x16_bf16 v[160:175], v[204:207], v[64:67], v[160:175]
    ds_read_b128 v[204:207], v1 offset:26624
    s_add_u32 s36, s15, 135168
    buffer_load_dwordx4 v[96:99], v0, s[4:7], s36 offen offset:0 sc1
    s_waitcnt vmcnt(14) lgkmcnt(4)
    v_mfma_f32_32x32x16_bf16 v[128:143], v[208:211], v[68:71], v[128:143]
    ds_read_b128 v[208:211], v1 offset:55296
    s_waitcnt lgkmcnt(4)
    v_mfma_f32_32x32x16_bf16 v[144:159], v[192:195], v[68:71], v[144:159]
    ds_read_b128 v[192:195], v0 offset:64512
    buffer_load_dwordx4 v[100:103], v0, s[4:7], s36 offen offset:1024 sc1
    s_waitcnt lgkmcnt(4)
    v_mfma_f32_32x32x16_bf16 v[160:175], v[196:199], v[68:71], v[160:175]
    ds_read_b128 v[196:199], v1 offset:27648
    s_waitcnt vmcnt(14) lgkmcnt(4)
    v_mfma_f32_32x32x16_bf16 v[128:143], v[200:203], v[72:75], v[128:143]
    ds_read_b128 v[200:203], v1 offset:56320
    buffer_load_dwordx4 v[104:107], v0, s[4:7], s36 offen offset:2048 sc1
    s_waitcnt lgkmcnt(4)
    v_mfma_f32_32x32x16_bf16 v[144:159], v[204:207], v[72:75], v[144:159]
    ds_read_b128 v[204:207], v1 offset:0
    s_waitcnt lgkmcnt(4)
    v_mfma_f32_32x32x16_bf16 v[160:175], v[208:211], v[72:75], v[160:175]
    ds_read_b128 v[208:211], v1 offset:28672
    buffer_load_dwordx4 v[108:111], v0, s[4:7], s36 offen offset:3072 sc1
    s_waitcnt vmcnt(15) lgkmcnt(4)
    v_mfma_f32_32x32x16_bf16 v[128:143], v[192:195], v[76:79], v[128:143]
    ds_read_b128 v[192:195], v1 offset:57344
    s_waitcnt lgkmcnt(4)
    v_mfma_f32_32x32x16_bf16 v[144:159], v[196:199], v[76:79], v[144:159]
    ds_read_b128 v[196:199], v1 offset:1024
    s_add_u32 s36, s15, 139264
    buffer_load_dwordx4 v[112:115], v0, s[4:7], s36 offen offset:0 sc1
    s_waitcnt lgkmcnt(4)
    v_mfma_f32_32x32x16_bf16 v[160:175], v[200:203], v[76:79], v[160:175]
    ds_read_b128 v[200:203], v1 offset:29696
    s_waitcnt vmcnt(8) lgkmcnt(4)
    v_mfma_f32_32x32x16_bf16 v[128:143], v[204:207], v[80:83], v[128:143]
    ds_read_b128 v[204:207], v1 offset:58368
    buffer_load_dwordx4 v[116:119], v0, s[4:7], s36 offen offset:1024 sc1
    v_add_f32 v176, v176, v178
    v_add_f32 v177, v177, v179
    s_waitcnt lgkmcnt(4)
    v_mfma_f32_32x32x16_bf16 v[144:159], v[208:211], v[80:83], v[144:159]
    ds_read_b128 v[208:211], v1 offset:2048
    v_add_f32 v180, v180, v182
    v_add_f32 v181, v181, v183
    v_add_f32 v184, v184, v186
    v_add_f32 v185, v185, v187
    s_waitcnt lgkmcnt(4)
    v_mfma_f32_32x32x16_bf16 v[160:175], v[192:195], v[80:83], v[160:175]
    ds_read_b128 v[192:195], v1 offset:30720
    buffer_load_dwordx4 v[120:123], v0, s[4:7], s36 offen offset:2048 sc1
    v_add_f32 v176, v176, v180
    v_add_f32 v177, v177, v181
    s_waitcnt vmcnt(9) lgkmcnt(4)
    v_mfma_f32_32x32x16_bf16 v[128:143], v[196:199], v[84:87], v[128:143]
    ds_read_b128 v[196:199], v1 offset:59392
    v_add_f32 v184, v184, v188
    v_add_f32 v185, v185, v189
    v_add_f32 v176, v176, v184
    v_add_f32 v177, v177, v185
    s_waitcnt lgkmcnt(4)
    v_mfma_f32_32x32x16_bf16 v[144:159], v[200:203], v[84:87], v[144:159]
    ds_read_b128 v[200:203], v1 offset:3072
    buffer_load_dwordx4 v[124:127], v0, s[4:7], s36 offen offset:3072 sc1
    v_mov_b32 v178, v176
    v_mov_b32 v179, v177
    s_waitcnt lgkmcnt(4)
    v_mfma_f32_32x32x16_bf16 v[160:175], v[204:207], v[84:87], v[160:175]
    ds_read_b128 v[204:207], v1 offset:31744
    v_permlane32_swap_b32 v176, v178
    v_permlane32_swap_b32 v177, v179
    v_add_f32 v176, v176, v178
    v_add_f32 v177, v177, v179
    s_waitcnt vmcnt(9) lgkmcnt(4)
    v_mfma_f32_32x32x16_bf16 v[128:143], v[208:211], v[88:91], v[128:143]
    ds_read_b128 v[208:211], v1 offset:60416
    s_add_u32 s34, s38, 108544
    s_add_u32 m0, s37, 0
    s_nop 0
    buffer_load_dwordx4 v0, s[4:7], s34 offen offset:0 sc1 lds
    v_mul_f32 v216, s52, v176
    v_mul_f32 v219, s52, v177
    s_waitcnt lgkmcnt(4)
    v_mfma_f32_32x32x16_bf16 v[144:159], v[192:195], v[88:91], v[144:159]
    ds_read_b128 v[192:195], v1 offset:4096
    v_fma_f32 v219, -v216, v216, v219
    v_max_f32 v219, 0, v219
    v_add_f32 v219, s53, v219
    s_waitcnt lgkmcnt(4)
    v_mfma_f32_32x32x16_bf16 v[160:175], v[196:199], v[88:91], v[160:175]
    ds_read_b128 v[196:199], v1 offset:32768
    s_add_u32 s34, s38, 109568
    s_add_u32 m0, s37, 1024
    s_nop 0
    buffer_load_dwordx4 v0, s[4:7], s34 offen offset:0 sc1 lds
    v_rsq_f32 v217, v219
    s_waitcnt vmcnt(10) lgkmcnt(4)
    v_mfma_f32_32x32x16_bf16 v[128:143], v[200:203], v[92:95], v[128:143]
    ds_read_b128 v[200:203], v1 offset:61440
    v_cndmask_b32 v176, -v216, 0, s[40:41]
    v_cvt_pk_bf16_f32 v177, v176, v176
    v_and_b32 v177, 0xffff0000, v177
    v_sub_f32 v177, v176, v177
    s_waitcnt lgkmcnt(4)
    v_mfma_f32_32x32x16_bf16 v[144:159], v[204:207], v[92:95], v[144:159]
    ds_read_b128 v[204:207], v1 offset:5120
    s_add_u32 s34, s38, 110592
    s_add_u32 m0, s37, 2048
    s_nop 0
    buffer_load_dwordx4 v0, s[4:7], s34 offen offset:0 sc1 lds
    v_cvt_pk_bf16_f32 v212, v176, v177
    v_and_b32 v178, 0xffff0000, v212
    s_waitcnt lgkmcnt(4)
    v_mfma_f32_32x32x16_bf16 v[160:175], v[208:211], v[92:95], v[160:175]
    ds_read_b128 v[208:211], v1 offset:33792
    v_sub_f32 v178, v177, v178
    v_cvt_pk_bf16_f32 v213, v176, v178
    v_mov_b32 v214, v212
    v_mov_b32 v215, 0
    s_waitcnt vmcnt(10) lgkmcnt(4)
    v_mfma_f32_32x32x16_bf16 v[128:143], v[192:195], v[96:99], v[128:143]
    ds_read_b128 v[192:195], v1 offset:62464
    s_add_u32 s34, s38, 111616
    s_add_u32 m0, s37, 3072
    s_nop 0
    buffer_load_dwordx4 v0, s[4:7], s34 offen offset:0 sc1 lds
    v_mul_f32 v217, s55, v217
    s_waitcnt lgkmcnt(4)
    v_mfma_f32_32x32x16_bf16 v[144:159], v[196:199], v[96:99], v[144:159]
    ds_read_b128 v[196:199], v1 offset:6144
    s_waitcnt lgkmcnt(4)
    v_mfma_f32_32x32x16_bf16 v[160:175], v[200:203], v[96:99], v[160:175]
    ds_read_b128 v[200:203], v1 offset:34816
    s_add_u32 s34, s38, 112640
    s_add_u32 m0, s37, 4096
    s_nop 0
    buffer_load_dwordx4 v0, s[4:7], s34 offen offset:0 sc1 lds
    s_waitcnt vmcnt(11) lgkmcnt(4)
    v_mfma_f32_32x32x16_bf16 v[128:143], v[204:207], v[100:103], v[128:143]
    ds_read_b128 v[204:207], v1 offset:63488
    s_waitcnt lgkmcnt(4)
    v_mfma_f32_32x32x16_bf16 v[144:159], v[208:211], v[100:103], v[144:159]
    ds_read_b128 v[208:211], v1 offset:7168
    s_add_u32 s34, s38, 113664
    s_add_u32 m0, s37, 5120
    s_nop 0
    buffer_load_dwordx4 v0, s[4:7], s34 offen offset:0 sc1 lds
    s_waitcnt lgkmcnt(4)
    v_mfma_f32_32x32x16_bf16 v[160:175], v[192:195], v[100:103], v[160:175]
    ds_read_b128 v[192:195], v1 offset:35840
    s_waitcnt vmcnt(11) lgkmcnt(4)
    v_mfma_f32_32x32x16_bf16 v[128:143], v[196:199], v[104:107], v[128:143]
    ds_read_b128 v[196:199], v1 offset:64512
    s_add_u32 s34, s38, 114688
    s_add_u32 m0, s37, 6144
    s_nop 0
    buffer_load_dwordx4 v0, s[4:7], s34 offen offset:0 sc1 lds
    s_waitcnt lgkmcnt(4)
    v_mfma_f32_32x32x16_bf16 v[144:159], v[200:203], v[104:107], v[144:159]
    ds_read_b128 v[200:203], v1 offset:8192
    s_waitcnt lgkmcnt(4)
    v_mfma_f32_32x32x16_bf16 v[160:175], v[204:207], v[104:107], v[160:175]
    ds_read_b128 v[204:207], v1 offset:36864
    s_add_u32 s34, s38, 115712
    s_add_u32 m0, s37, 7168
    s_nop 0
    buffer_load_dwordx4 v0, s[4:7], s34 offen offset:0 sc1 lds
    s_waitcnt vmcnt(12) lgkmcnt(4)
    v_mfma_f32_32x32x16_bf16 v[128:143], v[208:211], v[108:111], v[128:143]
    ds_read_b128 v[208:211], v2 offset:0
    s_waitcnt lgkmcnt(4)
    v_mfma_f32_32x32x16_bf16 v[144:159], v[192:195], v[108:111], v[144:159]
    ds_read_b128 v[192:195], v1 offset:9216
    s_add_u32 s34, s38, 116736
    s_add_u32 m0, s37, 8192
    s_nop 0
    buffer_load_dwordx4 v0, s[4:7], s34 offen offset:0 sc1 lds
    s_waitcnt lgkmcnt(4)
    v_mfma_f32_32x32x16_bf16 v[160:175], v[196:199], v[108:111], v[160:175]
    ds_read_b128 v[196:199], v1 offset:37888
    s_waitcnt vmcnt(12) lgkmcnt(4)
    v_mfma_f32_32x32x16_bf16 v[128:143], v[200:203], v[112:115], v[128:143]
    ds_read_b128 v[200:203], v2 offset:1024
    s_add_u32 s34, s38, 117760
    s_add_u32 m0, s37, 9216
    s_nop 0
    buffer_load_dwordx4 v0, s[4:7], s34 offen offset:0 sc1 lds
    s_waitcnt lgkmcnt(4)
    v_mfma_f32_32x32x16_bf16 v[144:159], v[204:207], v[112:115], v[144:159]
    ds_read_b128 v[204:207], v1 offset:10240
    s_waitcnt lgkmcnt(4)
    v_mfma_f32_32x32x16_bf16 v[160:175], v[208:211], v[112:115], v[160:175]
    ds_read_b128 v[208:211], v1 offset:38912
    s_add_u32 s34, s38, 118784
    s_add_u32 m0, s37, 10240
    s_nop 0
    buffer_load_dwordx4 v0, s[4:7], s34 offen offset:0 sc1 lds
    s_waitcnt vmcnt(13) lgkmcnt(4)
    v_mfma_f32_32x32x16_bf16 v[128:143], v[192:195], v[116:119], v[128:143]
    ds_read_b128 v[192:195], v2 offset:2048
    s_waitcnt lgkmcnt(4)
    v_mfma_f32_32x32x16_bf16 v[144:159], v[196:199], v[116:119], v[144:159]
    ds_read_b128 v[196:199], v1 offset:11264
    s_add_u32 s34, s38, 119808
    s_add_u32 m0, s37, 11264
    s_nop 0
    buffer_load_dwordx4 v0, s[4:7], s34 offen offset:0 sc1 lds
    s_waitcnt lgkmcnt(4)
    v_mfma_f32_32x32x16_bf16 v[160:175], v[200:203], v[116:119], v[160:175]
    ds_read_b128 v[200:203], v1 offset:39936
    s_waitcnt vmcnt(13) lgkmcnt(4)
    v_mfma_f32_32x32x16_bf16 v[128:143], v[204:207], v[120:123], v[128:143]
    ds_read_b128 v[204:207], v2 offset:3072
    s_waitcnt lgkmcnt(4)
    v_mfma_f32_32x32x16_bf16 v[144:159], v[208:211], v[120:123], v[144:159]
    ds_read_b128 v[208:211], v4 offset:1536
    s_waitcnt lgkmcnt(4)
    v_mfma_f32_32x32x16_bf16 v[160:175], v[192:195], v[120:123], v[160:175]
    ds_read_b128 v[192:195], v4 offset:2048
    s_waitcnt vmcnt(12) lgkmcnt(4)
    v_mfma_f32_32x32x16_bf16 v[128:143], v[196:199], v[124:127], v[128:143]
    ds_read_b128 v[196:199], v4 offset:2560
    s_waitcnt lgkmcnt(4)
    v_mfma_f32_32x32x16_bf16 v[144:159], v[200:203], v[124:127], v[144:159]
    ds_read_b128 v[200:203], v2 offset:4096
    s_waitcnt lgkmcnt(4)
    v_mfma_f32_32x32x16_bf16 v[160:175], v[204:207], v[124:127], v[160:175]
    ds_read_b128 v[204:207], v2 offset:5120
    s_waitcnt lgkmcnt(4)
    v_mfma_f32_32x32x16_bf16 v[128:143], v[208:211], v[212:215], v[128:143]
    ds_read_b128 v[208:211], v2 offset:6144
    s_waitcnt lgkmcnt(4)
    v_mfma_f32_32x32x16_bf16 v[144:159], v[192:195], v[212:215], v[144:159]
    ds_read_b128 v[192:195], v2 offset:7168
    s_waitcnt lgkmcnt(4)
    v_mfma_f32_32x32x16_bf16 v[160:175], v[196:199], v[212:215], v[160:175]
    ds_read_b128 v[196:199], v2 offset:8192
    s_waitcnt lgkmcnt(4)
    v_mfma_f32_32x32x16_bf16 v[176:191], v[200:203], v[16:19], 0
    ds_read_b128 v[200:203], v2 offset:9216
    s_nop 1
    v_mul_f32 v136, v128, v136
    v_mul_f32 v128, v217, v128
    v_mul_f32 v137, v129, v137
    v_mul_f32 v129, v217, v129
    s_waitcnt lgkmcnt(4)
    v_mfma_f32_32x32x16_bf16 v[176:191], v[204:207], v[20:23], v[176:191]
    ds_read_b128 v[204:207], v2 offset:10240
    v_mul_f32 v138, v130, v138
    v_mul_f32 v130, v217, v130
    v_mul_f32 v139, v131, v139
    v_mul_f32 v131, v217, v131
    s_waitcnt lgkmcnt(4)
    v_mfma_f32_32x32x16_bf16 v[176:191], v[208:211], v[24:27], v[176:191]
    ds_read_b128 v[208:211], v2 offset:11264
    v_mul_f32 v140, v132, v140
    v_mul_f32 v132, v217, v132
    v_mul_f32 v141, v133, v141
    v_mul_f32 v133, v217, v133
    s_waitcnt lgkmcnt(4)
    v_mfma_f32_32x32x16_bf16 v[176:191], v[192:195], v[28:31], v[176:191]
    ds_read_b128 v[192:195], v2 offset:12288
    v_mul_f32 v142, v134, v142
    v_mul_f32 v134, v217, v134
    v_mul_f32 v143, v135, v143
    v_mul_f32 v135, v217, v135
    s_waitcnt lgkmcnt(4)
    v_mfma_f32_32x32x16_bf16 v[176:191], v[196:199], v[32:35], v[176:191]
    ds_read_b128 v[196:199], v2 offset:13312
    v_exp_f32 v128, v128
    v_exp_f32 v129, v129
    s_waitcnt lgkmcnt(4)
    v_mfma_f32_32x32x16_bf16 v[176:191], v[200:203], v[36:39], v[176:191]
    ds_read_b128 v[200:203], v2 offset:14336
    v_exp_f32 v130, v130
    v_exp_f32 v131, v131
    s_waitcnt lgkmcnt(4)
    v_mfma_f32_32x32x16_bf16 v[176:191], v[204:207], v[40:43], v[176:191]
    ds_read_b128 v[204:207], v2 offset:15360
    v_exp_f32 v132, v132
    v_exp_f32 v133, v133
    s_waitcnt lgkmcnt(4)
    v_mfma_f32_32x32x16_bf16 v[176:191], v[208:211], v[44:47], v[176:191]
    ds_read_b128 v[208:211], v2 offset:16384
    v_exp_f32 v134, v134
    v_exp_f32 v135, v135
    s_waitcnt lgkmcnt(4)
    v_mfma_f32_32x32x16_bf16 v[176:191], v[192:195], v[48:51], v[176:191]
    ds_read_b128 v[192:195], v2 offset:17408
    v_fma_f32 v128, v128, v219, v219
    v_fma_f32 v129, v129, v219, v219
    v_fma_f32 v130, v130, v219, v219
    v_fma_f32 v131, v131, v219, v219
    s_waitcnt lgkmcnt(4)
    v_mfma_f32_32x32x16_bf16 v[176:191], v[196:199], v[52:55], v[176:191]
    ds_read_b128 v[196:199], v2 offset:18432
    v_fma_f32 v132, v132, v219, v219
    v_fma_f32 v133, v133, v219, v219
    v_fma_f32 v134, v134, v219, v219
    v_fma_f32 v135, v135, v219, v219
    s_waitcnt lgkmcnt(4)
    v_mfma_f32_32x32x16_bf16 v[176:191], v[200:203], v[56:59], v[176:191]
    ds_read_b128 v[200:203], v2 offset:19456
    v_rcp_f32 v128, v128
    v_rcp_f32 v129, v129
    s_waitcnt lgkmcnt(4)
    v_mfma_f32_32x32x16_bf16 v[176:191], v[204:207], v[60:63], v[176:191]
    ds_read_b128 v[204:207], v2 offset:20480
    v_rcp_f32 v130, v130
    v_rcp_f32 v131, v131
    s_waitcnt vmcnt(0)
    s_barrier
    s_mul_i32 s37, s14, 11264
    s_add_u32 s38, s49, s37
    s_waitcnt lgkmcnt(4)
    v_mfma_f32_32x32x16_bf16 v[176:191], v[208:211], v[64:67], v[176:191]
    ds_read_b128 v[208:211], v2 offset:21504
    s_add_u32 s34, s38, 157696
    s_add_u32 m0, s37, 49152
    s_nop 0
    buffer_load_dwordx4 v0, s[4:7], s34 offen offset:0 sc1 lds
    v_rcp_f32 v132, v132
    s_waitcnt lgkmcnt(4)
    v_mfma_f32_32x32x16_bf16 v[176:191], v[192:195], v[68:71], v[176:191]
    ds_read_b128 v[192:195], v2 offset:22528
    v_rcp_f32 v133, v133
    v_rcp_f32 v134, v134
    s_waitcnt lgkmcnt(4)
    v_mfma_f32_32x32x16_bf16 v[176:191], v[196:199], v[72:75], v[176:191]
    ds_read_b128 v[196:199], v2 offset:23552
    s_add_u32 s34, s38, 158720
    s_add_u32 m0, s37, 50176
    s_nop 0
    buffer_load_dwordx4 v0, s[4:7], s34 offen offset:0 sc1 lds
    v_rcp_f32 v135, v135
    s_waitcnt lgkmcnt(4)
    v_mfma_f32_32x32x16_bf16 v[176:191], v[200:203], v[76:79], v[176:191]
    ds_read_b128 v[200:203], v2 offset:24576
    v_mul_f32 v128, v128, v136
    v_mul_f32 v129, v129, v137
    v_mul_f32 v130, v130, v138
    v_mul_f32 v131, v131, v139
    s_waitcnt lgkmcnt(4)
    v_mfma_f32_32x32x16_bf16 v[176:191], v[204:207], v[80:83], v[176:191]
    ds_read_b128 v[204:207], v2 offset:25600
    s_add_u32 s34, s38, 159744
    s_add_u32 m0, s37, 51200
    s_nop 0
    buffer_load_dwordx4 v0, s[4:7], s34 offen offset:0 sc1 lds
    v_mul_f32 v132, v132, v140
    v_mul_f32 v133, v133, v141
    s_waitcnt lgkmcnt(4)
    v_mfma_f32_32x32x16_bf16 v[176:191], v[208:211], v[84:87], v[176:191]
    ds_read_b128 v[208:211], v0 offset:0
    v_mul_f32 v134, v134, v142
    v_mul_f32 v135, v135, v143
    v_cvt_pk_bf16_f32 v128, v128, v129
    v_cvt_pk_bf16_f32 v129, v130, v131
    s_waitcnt lgkmcnt(4)
    v_mfma_f32_32x32x16_bf16 v[176:191], v[192:195], v[88:91], v[176:191]
    ds_read_b128 v[192:195], v0 offset:1024
    s_add_u32 s34, s38, 160768
    s_add_u32 m0, s37, 52224
    s_nop 0
    buffer_load_dwordx4 v0, s[4:7], s34 offen offset:0 sc1 lds
    v_cvt_pk_bf16_f32 v130, v132, v133
    v_cvt_pk_bf16_f32 v131, v134, v135
    s_add_u32 s39, s28, 0
    s_waitcnt lgkmcnt(4)
    v_mfma_f32_32x32x16_bf16 v[176:191], v[196:199], v[92:95], v[176:191]
    ds_read_b128 v[196:199], v0 offset:2048
    buffer_store_dwordx4 v[128:131], v0, s[4:7], s39 offen offset:0 sc1
    v_mul_f32 v152, v144, v152
    v_mul_f32 v144, v217, v144
    s_waitcnt lgkmcnt(4)
    v_mfma_f32_32x32x16_bf16 v[176:191], v[200:203], v[96:99], v[176:191]
    ds_read_b128 v[200:203], v0 offset:3072
    s_add_u32 s34, s38, 161792
    s_add_u32 m0, s37, 53248
    s_nop 0
    buffer_load_dwordx4 v0, s[4:7], s34 offen offset:0 sc1 lds
    v_mul_f32 v153, v145, v153
    v_mul_f32 v145, v217, v145
    s_waitcnt lgkmcnt(4)
    v_mfma_f32_32x32x16_bf16 v[176:191], v[204:207], v[100:103], v[176:191]
    ds_read_b128 v[204:207], v0 offset:4096
    v_mul_f32 v154, v146, v154
    v_mul_f32 v146, v217, v146
    v_mul_f32 v155, v147, v155
    v_mul_f32 v147, v217, v147
    s_waitcnt lgkmcnt(4)
    v_mfma_f32_32x32x16_bf16 v[176:191], v[208:211], v[104:107], v[176:191]
    ds_read_b128 v[208:211], v0 offset:5120
    s_add_u32 s34, s38, 162816
    s_add_u32 m0, s37, 54272
    s_nop 0
    buffer_load_dwordx4 v0, s[4:7], s34 offen offset:0 sc1 lds
    v_mul_f32 v156, v148, v156
    v_mul_f32 v148, v217, v148
    s_waitcnt lgkmcnt(4)
    v_mfma_f32_32x32x16_bf16 v[176:191], v[192:195], v[108:111], v[176:191]
    ds_read_b128 v[192:195], v4 offset:3072
    v_mul_f32 v157, v149, v157
    v_mul_f32 v149, v217, v149
    v_mul_f32 v158, v150, v158
    v_mul_f32 v150, v217, v150
    s_waitcnt lgkmcnt(4)
    v_mfma_f32_32x32x16_bf16 v[176:191], v[196:199], v[112:115], v[176:191]
    ds_read_b128 v[196:199], v0 offset:6144
    s_add_u32 s34, s38, 163840
    s_add_u32 m0, s37, 55296
    s_nop 0
    buffer_load_dwordx4 v0, s[4:7], s34 offen offset:0 sc1 lds
    v_mul_f32 v159, v151, v159
    v_mul_f32 v151, v217, v151
    s_waitcnt lgkmcnt(4)
    v_mfma_f32_32x32x16_bf16 v[176:191], v[200:203], v[116:119], v[176:191]
    ds_read_b128 v[200:203], v0 offset:7168
    v_exp_f32 v144, v144
    v_exp_f32 v145, v145
    s_waitcnt lgkmcnt(4)
    v_mfma_f32_32x32x16_bf16 v[176:191], v[204:207], v[120:123], v[176:191]
    ds_read_b128 v[204:207], v0 offset:8192
    s_add_u32 s34, s38, 164864
    s_add_u32 m0, s37, 56320
    s_nop 0
    buffer_load_dwordx4 v0, s[4:7], s34 offen offset:0 sc1 lds
    v_exp_f32 v146, v146
    s_waitcnt lgkmcnt(4)
    v_mfma_f32_32x32x16_bf16 v[176:191], v[208:211], v[124:127], v[176:191]
    ds_read_b128 v[208:211], v0 offset:9216
    v_exp_f32 v147, v147
    v_exp_f32 v148, v148
    s_waitcnt lgkmcnt(4)
    v_mfma_f32_32x32x16_bf16 v[176:191], v[192:195], v[212:215], v[176:191]
    ds_read_b128 v[192:195], v0 offset:10240
    s_add_u32 s34, s38, 165888
    s_add_u32 m0, s37, 57344
    s_nop 0
    buffer_load_dwordx4 v0, s[4:7], s34 offen offset:0 sc1 lds
    v_exp_f32 v149, v149
    s_waitcnt lgkmcnt(4)
    v_mfma_f32_32x32x16_bf16 v[128:143], v[196:199], v[16:19], 0
    ds_read_b128 v[196:199], v0 offset:11264
    v_exp_f32 v150, v150
    v_exp_f32 v151, v151
    s_waitcnt lgkmcnt(4)
    v_mfma_f32_32x32x16_bf16 v[128:143], v[200:203], v[20:23], v[128:143]
    ds_read_b128 v[200:203], v0 offset:12288
    s_add_u32 s34, s38, 166912
    s_add_u32 m0, s37, 58368
    s_nop 0
    buffer_load_dwordx4 v0, s[4:7], s34 offen offset:0 sc1 lds
    v_fma_f32 v144, v144, v219, v219
    v_fma_f32 v145, v145, v219, v219
    s_waitcnt lgkmcnt(4)
    v_mfma_f32_32x32x16_bf16 v[128:143], v[204:207], v[24:27], v[128:143]
    ds_read_b128 v[204:207], v0 offset:13312
    v_fma_f32 v146, v146, v219, v219
    v_fma_f32 v147, v147, v219, v219
    v_fma_f32 v148, v148, v219, v219
    v_fma_f32 v149, v149, v219, v219
    s_waitcnt lgkmcnt(4)
    v_mfma_f32_32x32x16_bf16 v[128:143], v[208:211], v[28:31], v[128:143]
    ds_read_b128 v[208:211], v0 offset:14336
    s_add_u32 s34, s38, 167936
    s_add_u32 m0, s37, 59392
    s_nop 0
    buffer_load_dwordx4 v0, s[4:7], s34 offen offset:0 sc1 lds
    v_fma_f32 v150, v150, v219, v219
    v_fma_f32 v151, v151, v219, v219
    s_waitcnt lgkmcnt(4)
    v_mfma_f32_32x32x16_bf16 v[128:143], v[192:195], v[32:35], v[128:143]
    ds_read_b128 v[192:195], v0 offset:15360
    v_rcp_f32 v144, v144
    v_rcp_f32 v145, v145
    s_waitcnt lgkmcnt(4)
    v_mfma_f32_32x32x16_bf16 v[128:143], v[196:199], v[36:39], v[128:143]
    ds_read_b128 v[196:199], v0 offset:16384
    v_rcp_f32 v146, v146
    v_rcp_f32 v147, v147
    s_waitcnt lgkmcnt(4)
    v_mfma_f32_32x32x16_bf16 v[128:143], v[200:203], v[40:43], v[128:143]
    ds_read_b128 v[200:203], v0 offset:17408
    v_rcp_f32 v148, v148
    v_rcp_f32 v149, v149
    s_waitcnt lgkmcnt(4)
    v_mfma_f32_32x32x16_bf16 v[128:143], v[204:207], v[44:47], v[128:143]
    ds_read_b128 v[204:207], v0 offset:18432
    v_rcp_f32 v150, v150
    v_rcp_f32 v151, v151
    s_waitcnt lgkmcnt(4)
    v_mfma_f32_32x32x16_bf16 v[128:143], v[208:211], v[48:51], v[128:143]
    ds_read_b128 v[208:211], v0 offset:19456
    v_mul_f32 v144, v144, v152
    v_mul_f32 v145, v145, v153
    v_mul_f32 v146, v146, v154
    v_mul_f32 v147, v147, v155
    s_waitcnt lgkmcnt(4)
    v_mfma_f32_32x32x16_bf16 v[128:143], v[192:195], v[52:55], v[128:143]
    ds_read_b128 v[192:195], v0 offset:20480
    v_mul_f32 v148, v148, v156
    v_mul_f32 v149, v149, v157
    v_mul_f32 v150, v150, v158
    v_mul_f32 v151, v151, v159
    s_waitcnt lgkmcnt(4)
    v_mfma_f32_32x32x16_bf16 v[128:143], v[196:199], v[56:59], v[128:143]
    ds_read_b128 v[196:199], v0 offset:21504
    v_cvt_pk_bf16_f32 v144, v144, v145
    v_cvt_pk_bf16_f32 v145, v146, v147
    v_cvt_pk_bf16_f32 v146, v148, v149
    v_cvt_pk_bf16_f32 v147, v150, v151
    s_waitcnt lgkmcnt(4)
    v_mfma_f32_32x32x16_bf16 v[128:143], v[200:203], v[60:63], v[128:143]
    ds_read_b128 v[200:203], v0 offset:22528
    buffer_store_dwordx4 v[144:147], v0, s[4:7], s39 offen offset:1024 sc1
    v_mul_f32 v168, v160, v168
    v_mul_f32 v160, v217, v160
    s_waitcnt lgkmcnt(4)
    v_mfma_f32_32x32x16_bf16 v[128:143], v[204:207], v[64:67], v[128:143]
    ds_read_b128 v[204:207], v0 offset:23552
    v_mul_f32 v169, v161, v169
    v_mul_f32 v161, v217, v161
    v_mul_f32 v170, v162, v170
    v_mul_f32 v162, v217, v162
    s_waitcnt lgkmcnt(4)
    v_mfma_f32_32x32x16_bf16 v[128:143], v[208:211], v[68:71], v[128:143]
    ds_read_b128 v[208:211], v0 offset:24576
    v_mul_f32 v171, v163, v171
    v_mul_f32 v163, v217, v163
    v_mul_f32 v172, v164, v172
    v_mul_f32 v164, v217, v164
    s_waitcnt lgkmcnt(4)
    v_mfma_f32_32x32x16_bf16 v[128:143], v[192:195], v[72:75], v[128:143]
    ds_read_b128 v[192:195], v0 offset:25600
    v_mul_f32 v173, v165, v173
    v_mul_f32 v165, v217, v165
    v_mul_f32 v174, v166, v174
    v_mul_f32 v166, v217, v166
    s_waitcnt lgkmcnt(4)
    v_mfma_f32_32x32x16_bf16 v[128:143], v[196:199], v[76:79], v[128:143]
    ds_read_b128 v[196:199], v0 offset:26624
    v_mul_f32 v175, v167, v175
    v_mul_f32 v167, v217, v167
    v_exp_f32 v160, v160
    s_waitcnt lgkmcnt(4)
    v_mfma_f32_32x32x16_bf16 v[128:143], v[200:203], v[80:83], v[128:143]
    ds_read_b128 v[200:203], v0 offset:27648
    v_exp_f32 v161, v161
    v_exp_f32 v162, v162
    s_waitcnt lgkmcnt(4)
    v_mfma_f32_32x32x16_bf16 v[128:143], v[204:207], v[84:87], v[128:143]
    ds_read_b128 v[204:207], v0 offset:28672
    v_exp_f32 v163, v163
    v_exp_f32 v164, v164
    s_waitcnt lgkmcnt(4)
    v_mfma_f32_32x32x16_bf16 v[128:143], v[208:211], v[88:91], v[128:143]
    ds_read_b128 v[208:211], v0 offset:29696
    v_exp_f32 v165, v165
    v_exp_f32 v166, v166
    s_waitcnt lgkmcnt(4)
    v_mfma_f32_32x32x16_bf16 v[128:143], v[192:195], v[92:95], v[128:143]
    ds_read_b128 v[192:195], v0 offset:30720
    v_exp_f32 v167, v167
    v_fma_f32 v160, v160, v219, v219
    v_fma_f32 v161, v161, v219, v219
    s_waitcnt lgkmcnt(4)
    v_mfma_f32_32x32x16_bf16 v[128:143], v[196:199], v[96:99], v[128:143]
    ds_read_b128 v[196:199], v0 offset:31744
    v_fma_f32 v162, v162, v219, v219
    v_fma_f32 v163, v163, v219, v219
    v_fma_f32 v164, v164, v219, v219
    v_fma_f32 v165, v165, v219, v219
    s_waitcnt lgkmcnt(4)
    v_mfma_f32_32x32x16_bf16 v[128:143], v[200:203], v[100:103], v[128:143]
    ds_read_b128 v[200:203], v0 offset:32768
    v_fma_f32 v166, v166, v219, v219
    v_fma_f32 v167, v167, v219, v219
    v_rcp_f32 v160, v160
    s_waitcnt lgkmcnt(4)
    v_mfma_f32_32x32x16_bf16 v[128:143], v[204:207], v[104:107], v[128:143]
    ds_read_b128 v[204:207], v0 offset:33792
    v_rcp_f32 v161, v161
    v_rcp_f32 v162, v162
    s_waitcnt lgkmcnt(4)
    v_mfma_f32_32x32x16_bf16 v[128:143], v[208:211], v[108:111], v[128:143]
    ds_read_b128 v[208:211], v4 offset:3584
    v_rcp_f32 v163, v163
    v_rcp_f32 v164, v164
    s_waitcnt lgkmcnt(4)
    v_mfma_f32_32x32x16_bf16 v[128:143], v[192:195], v[112:115], v[128:143]
    ds_read_b128 v[192:195], v0 offset:34816
    v_rcp_f32 v165, v165
    v_rcp_f32 v166, v166
    s_waitcnt lgkmcnt(4)
    v_mfma_f32_32x32x16_bf16 v[128:143], v[196:199], v[116:119], v[128:143]
    ds_read_b128 v[196:199], v0 offset:35840
    v_rcp_f32 v167, v167
    v_mul_f32 v160, v160, v168
    v_mul_f32 v161, v161, v169
    s_waitcnt lgkmcnt(4)
    v_mfma_f32_32x32x16_bf16 v[128:143], v[200:203], v[120:123], v[128:143]
    ds_read_b128 v[200:203], v0 offset:36864
    v_mul_f32 v162, v162, v170
    v_mul_f32 v163, v163, v171
    v_mul_f32 v164, v164, v172
    v_mul_f32 v165, v165, v173
    s_waitcnt lgkmcnt(4)
    v_mfma_f32_32x32x16_bf16 v[128:143], v[204:207], v[124:127], v[128:143]
    ds_read_b128 v[204:207], v0 offset:37888
    v_mul_f32 v166, v166, v174
    v_mul_f32 v167, v167, v175
    v_cvt_pk_bf16_f32 v160, v160, v161
    v_cvt_pk_bf16_f32 v161, v162, v163
    s_waitcnt lgkmcnt(4)
    v_mfma_f32_32x32x16_bf16 v[128:143], v[208:211], v[212:215], v[128:143]
    ds_read_b128 v[208:211], v0 offset:38912
    v_cvt_pk_bf16_f32 v162, v164, v165
    v_cvt_pk_bf16_f32 v163, v166, v167
    buffer_store_dwordx4 v[160:163], v0, s[4:7], s39 offen offset:2048 sc1
    s_waitcnt lgkmcnt(4)
    v_mfma_f32_32x32x16_bf16 v[144:159], v[192:195], v[16:19], 0
    ds_read_b128 v[192:195], v0 offset:39936
    v_mul_f32 v184, v176, v184
    v_mul_f32 v176, v217, v176
    v_mul_f32 v185, v177, v185
    v_mul_f32 v177, v217, v177
    s_waitcnt lgkmcnt(4)
    v_mfma_f32_32x32x16_bf16 v[144:159], v[196:199], v[20:23], v[144:159]
    ds_read_b128 v[196:199], v0 offset:40960
    v_mul_f32 v186, v178, v186
    v_mul_f32 v178, v217, v178
    v_mul_f32 v187, v179, v187
    v_mul_f32 v179, v217, v179
    s_waitcnt lgkmcnt(4)
    v_mfma_f32_32x32x16_bf16 v[144:159], v[200:203], v[24:27], v[144:159]
    ds_read_b128 v[200:203], v0 offset:41984
    v_mul_f32 v188, v180, v188
    v_mul_f32 v180, v217, v180
    v_mul_f32 v189, v181, v189
    v_mul_f32 v181, v217, v181
    s_waitcnt lgkmcnt(4)
    v_mfma_f32_32x32x16_bf16 v[144:159], v[204:207], v[28:31], v[144:159]
    ds_read_b128 v[204:207], v0 offset:43008
    v_mul_f32 v190, v182, v190
    v_mul_f32 v182, v217, v182
    v_mul_f32 v191, v183, v191
    v_mul_f32 v183, v217, v183
    s_waitcnt lgkmcnt(4)
    v_mfma_f32_32x32x16_bf16 v[144:159], v[208:211], v[32:35], v[144:159]
    ds_read_b128 v[208:211], v0 offset:44032
    v_exp_f32 v176, v176
    v_exp_f32 v177, v177
    s_waitcnt lgkmcnt(4)
    v_mfma_f32_32x32x16_bf16 v[144:159], v[192:195], v[36:39], v[144:159]
    ds_read_b128 v[192:195], v0 offset:45056
    v_exp_f32 v178, v178
    v_exp_f32 v179, v179
    s_waitcnt lgkmcnt(4)
    v_mfma_f32_32x32x16_bf16 v[144:159], v[196:199], v[40:43], v[144:159]
    ds_read_b128 v[196:199], v0 offset:46080
    v_exp_f32 v180, v180
    v_exp_f32 v181, v181
    s_waitcnt lgkmcnt(4)
    v_mfma_f32_32x32x16_bf16 v[144:159], v[200:203], v[44:47], v[144:159]
    ds_read_b128 v[200:203], v0 offset:47104
    v_exp_f32 v182, v182
    v_exp_f32 v183, v183
    s_waitcnt lgkmcnt(4)
    v_mfma_f32_32x32x16_bf16 v[144:159], v[204:207], v[48:51], v[144:159]
    ds_read_b128 v[204:207], v0 offset:48128
    v_fma_f32 v176, v176, v219, v219
    v_fma_f32 v177, v177, v219, v219
    v_fma_f32 v178, v178, v219, v219
    v_fma_f32 v179, v179, v219, v219
    s_waitcnt vmcnt(2)
    s_barrier
    s_mul_i32 s37, s14, 14336
    s_add_u32 s38, s48, s37
    s_waitcnt lgkmcnt(4)
    v_mfma_f32_32x32x16_bf16 v[144:159], v[208:211], v[52:55], v[144:159]
    ds_read_b128 v[208:211], v0 offset:49152
    v_fma_f32 v180, v180, v219, v219
    v_fma_f32 v181, v181, v219, v219
    v_fma_f32 v182, v182, v219, v219
    v_fma_f32 v183, v183, v219, v219
    s_waitcnt lgkmcnt(4)
    v_mfma_f32_32x32x16_bf16 v[144:159], v[192:195], v[56:59], v[144:159]
    ds_read_b128 v[192:195], v0 offset:50176
    v_rcp_f32 v176, v176
    v_rcp_f32 v177, v177
    s_waitcnt lgkmcnt(4)
    v_mfma_f32_32x32x16_bf16 v[144:159], v[196:199], v[60:63], v[144:159]
    ds_read_b128 v[196:199], v0 offset:51200
    v_rcp_f32 v178, v178
    v_rcp_f32 v179, v179
    s_waitcnt lgkmcnt(4)
    v_mfma_f32_32x32x16_bf16 v[144:159], v[200:203], v[64:67], v[144:159]
    ds_read_b128 v[200:203], v0 offset:52224
    v_rcp_f32 v180, v180
    v_rcp_f32 v181, v181
    s_waitcnt lgkmcnt(4)
    v_mfma_f32_32x32x16_bf16 v[144:159], v[204:207], v[68:71], v[144:159]
    ds_read_b128 v[204:207], v0 offset:53248
    v_rcp_f32 v182, v182
    v_rcp_f32 v183, v183
    s_waitcnt lgkmcnt(4)
    v_mfma_f32_32x32x16_bf16 v[144:159], v[208:211], v[72:75], v[144:159]
    ds_read_b128 v[208:211], v0 offset:54272
    v_mul_f32 v176, v176, v184
    v_mul_f32 v177, v177, v185
    v_mul_f32 v178, v178, v186
    v_mul_f32 v179, v179, v187
    s_waitcnt lgkmcnt(4)
    v_mfma_f32_32x32x16_bf16 v[144:159], v[192:195], v[76:79], v[144:159]
    ds_read_b128 v[192:195], v0 offset:55296
    v_mul_f32 v180, v180, v188
    v_mul_f32 v181, v181, v189
    v_mul_f32 v182, v182, v190
    v_mul_f32 v183, v183, v191
    s_waitcnt lgkmcnt(4)
    v_mfma_f32_32x32x16_bf16 v[144:159], v[196:199], v[80:83], v[144:159]
    ds_read_b128 v[196:199], v0 offset:56320
    v_cvt_pk_bf16_f32 v176, v176, v177
    v_cvt_pk_bf16_f32 v177, v178, v179
    v_cvt_pk_bf16_f32 v178, v180, v181
    v_cvt_pk_bf16_f32 v179, v182, v183
    s_waitcnt lgkmcnt(4)
    v_mfma_f32_32x32x16_bf16 v[144:159], v[200:203], v[84:87], v[144:159]
    ds_read_b128 v[200:203], v0 offset:57344
    buffer_store_dwordx4 v[176:179], v0, s[4:7], s39 offen offset:3072 sc1
    v_mul_f32 v136, v128, v136
    v_mul_f32 v128, v217, v128
    s_waitcnt lgkmcnt(4)
    v_mfma_f32_32x32x16_bf16 v[144:159], v[204:207], v[88:91], v[144:159]
    ds_read_b128 v[204:207], v0 offset:58368
    v_mul_f32 v137, v129, v137
    v_mul_f32 v129, v217, v129
    v_mul_f32 v138, v130, v138
    v_mul_f32 v130, v217, v130
    s_waitcnt lgkmcnt(4)
    v_mfma_f32_32x32x16_bf16 v[144:159], v[208:211], v[92:95], v[144:159]
    ds_read_b128 v[208:211], v0 offset:59392
    v_mul_f32 v139, v131, v139
    v_mul_f32 v131, v217, v131
    v_mul_f32 v140, v132, v140
    v_mul_f32 v132, v217, v132
    s_waitcnt lgkmcnt(4)
    v_mfma_f32_32x32x16_bf16 v[144:159], v[192:195], v[96:99], v[144:159]
    ds_read_b128 v[192:195], v0 offset:60416
    v_mul_f32 v141, v133, v141
    v_mul_f32 v133, v217, v133
    v_mul_f32 v142, v134, v142
    v_mul_f32 v134, v217, v134
    s_waitcnt lgkmcnt(4)
    v_mfma_f32_32x32x16_bf16 v[144:159], v[196:199], v[100:103], v[144:159]
    ds_read_b128 v[196:199], v0 offset:61440
    v_mul_f32 v143, v135, v143
    v_mul_f32 v135, v217, v135
    v_exp_f32 v128, v128
    s_waitcnt lgkmcnt(4)
    v_mfma_f32_32x32x16_bf16 v[144:159], v[200:203], v[104:107], v[144:159]
    ds_read_b128 v[200:203], v0 offset:62464
    v_exp_f32 v129, v129
    v_exp_f32 v130, v130
    s_waitcnt lgkmcnt(4)
    v_mfma_f32_32x32x16_bf16 v[144:159], v[204:207], v[108:111], v[144:159]
    ds_read_b128 v[204:207], v4 offset:4096
    v_exp_f32 v131, v131
    v_exp_f32 v132, v132
    s_waitcnt lgkmcnt(4)
    v_mfma_f32_32x32x16_bf16 v[144:159], v[208:211], v[112:115], v[144:159]
    ds_read_b128 v[208:211], v0 offset:63488
    v_exp_f32 v133, v133
    v_exp_f32 v134, v134
    s_waitcnt lgkmcnt(4)
    v_mfma_f32_32x32x16_bf16 v[144:159], v[192:195], v[116:119], v[144:159]
    ds_read_b128 v[192:195], v0 offset:64512
    v_exp_f32 v135, v135
    v_fma_f32 v128, v128, v219, v219
    v_fma_f32 v129, v129, v219, v219
    s_waitcnt lgkmcnt(4)
    v_mfma_f32_32x32x16_bf16 v[144:159], v[196:199], v[120:123], v[144:159]
    ds_read_b128 v[196:199], v1 offset:0
    v_fma_f32 v130, v130, v219, v219
    v_fma_f32 v131, v131, v219, v219
    v_fma_f32 v132, v132, v219, v219
    v_fma_f32 v133, v133, v219, v219
    s_waitcnt lgkmcnt(4)
    v_mfma_f32_32x32x16_bf16 v[144:159], v[200:203], v[124:127], v[144:159]
    ds_read_b128 v[200:203], v1 offset:1024
    v_fma_f32 v134, v134, v219, v219
    v_fma_f32 v135, v135, v219, v219
    v_rcp_f32 v128, v128
    s_waitcnt lgkmcnt(4)
    v_mfma_f32_32x32x16_bf16 v[144:159], v[204:207], v[212:215], v[144:159]
    ds_read_b128 v[204:207], v1 offset:2048
    v_rcp_f32 v129, v129
    v_rcp_f32 v130, v130
    s_waitcnt lgkmcnt(4)
    v_mfma_f32_32x32x16_bf16 v[160:175], v[208:211], v[16:19], 0
    ds_read_b128 v[208:211], v1 offset:3072
    v_rcp_f32 v131, v131
    v_rcp_f32 v132, v132
    s_waitcnt lgkmcnt(4)
    v_mfma_f32_32x32x16_bf16 v[160:175], v[192:195], v[20:23], v[160:175]
    ds_read_b128 v[192:195], v1 offset:4096
    v_rcp_f32 v133, v133
    v_rcp_f32 v134, v134
    s_waitcnt lgkmcnt(4)
    v_mfma_f32_32x32x16_bf16 v[160:175], v[196:199], v[24:27], v[160:175]
    ds_read_b128 v[196:199], v1 offset:5120
    v_rcp_f32 v135, v135
    v_mul_f32 v128, v128, v136
    v_mul_f32 v129, v129, v137
    s_waitcnt lgkmcnt(4)
    v_mfma_f32_32x32x16_bf16 v[160:175], v[200:203], v[28:31], v[160:175]
    ds_read_b128 v[200:203], v1 offset:6144
    v_mul_f32 v130, v130, v138
    v_mul_f32 v131, v131, v139
    v_mul_f32 v132, v132, v140
    v_mul_f32 v133, v133, v141
    s_waitcnt lgkmcnt(4)
    v_mfma_f32_32x32x16_bf16 v[160:175], v[204:207], v[32:35], v[160:175]
    ds_read_b128 v[204:207], v1 offset:7168
    v_mul_f32 v134, v134, v142
    v_mul_f32 v135, v135, v143
    v_cvt_pk_bf16_f32 v128, v128, v129
    v_cvt_pk_bf16_f32 v129, v130, v131
    s_waitcnt lgkmcnt(4)
    v_mfma_f32_32x32x16_bf16 v[160:175], v[208:211], v[36:39], v[160:175]
    ds_read_b128 v[208:211], v1 offset:8192
    v_cvt_pk_bf16_f32 v130, v132, v133
    v_cvt_pk_bf16_f32 v131, v134, v135
    s_add_u32 s39, s28, 4096
    s_waitcnt lgkmcnt(4)
    v_mfma_f32_32x32x16_bf16 v[160:175], v[192:195], v[40:43], v[160:175]
    ds_read_b128 v[192:195], v1 offset:9216
    buffer_store_dwordx4 v[128:131], v0, s[4:7], s39 offen offset:0 sc1
    v_mul_f32 v152, v144, v152
    v_mul_f32 v144, v217, v144
    s_waitcnt lgkmcnt(4)
    v_mfma_f32_32x32x16_bf16 v[160:175], v[196:199], v[44:47], v[160:175]
    ds_read_b128 v[196:199], v1 offset:10240
    v_mul_f32 v153, v145, v153
    v_mul_f32 v145, v217, v145
    v_mul_f32 v154, v146, v154
    v_mul_f32 v146, v217, v146
    s_waitcnt lgkmcnt(4)
    v_mfma_f32_32x32x16_bf16 v[160:175], v[200:203], v[48:51], v[160:175]
    ds_read_b128 v[200:203], v1 offset:11264
    v_mul_f32 v155, v147, v155
    v_mul_f32 v147, v217, v147
    v_mul_f32 v156, v148, v156
    v_mul_f32 v148, v217, v148
    s_waitcnt lgkmcnt(4)
    v_mfma_f32_32x32x16_bf16 v[160:175], v[204:207], v[52:55], v[160:175]
    ds_read_b128 v[204:207], v1 offset:12288
    v_mul_f32 v157, v149, v157
    v_mul_f32 v149, v217, v149
    v_mul_f32 v158, v150, v158
    v_mul_f32 v150, v217, v150
    s_waitcnt lgkmcnt(4)
    v_mfma_f32_32x32x16_bf16 v[160:175], v[208:211], v[56:59], v[160:175]
    ds_read_b128 v[208:211], v1 offset:13312
    v_mul_f32 v159, v151, v159
    v_mul_f32 v151, v217, v151
    v_exp_f32 v144, v144
    s_waitcnt lgkmcnt(4)
    v_mfma_f32_32x32x16_bf16 v[160:175], v[192:195], v[60:63], v[160:175]
    ds_read_b128 v[192:195], v1 offset:14336
    v_exp_f32 v145, v145
    v_exp_f32 v146, v146
    s_waitcnt lgkmcnt(4)
    v_mfma_f32_32x32x16_bf16 v[160:175], v[196:199], v[64:67], v[160:175]
    ds_read_b128 v[196:199], v1 offset:15360
    v_exp_f32 v147, v147
    v_exp_f32 v148, v148
    s_waitcnt lgkmcnt(4)
    v_mfma_f32_32x32x16_bf16 v[160:175], v[200:203], v[68:71], v[160:175]
    ds_read_b128 v[200:203], v1 offset:16384
    v_exp_f32 v149, v149
    v_exp_f32 v150, v150
    s_waitcnt lgkmcnt(4)
    v_mfma_f32_32x32x16_bf16 v[160:175], v[204:207], v[72:75], v[160:175]
    ds_read_b128 v[204:207], v1 offset:17408
    v_exp_f32 v151, v151
    v_fma_f32 v144, v144, v219, v219
    v_fma_f32 v145, v145, v219, v219
    s_waitcnt lgkmcnt(4)
    v_mfma_f32_32x32x16_bf16 v[160:175], v[208:211], v[76:79], v[160:175]
    ds_read_b128 v[208:211], v1 offset:18432
    v_fma_f32 v146, v146, v219, v219
    v_fma_f32 v147, v147, v219, v219
    v_fma_f32 v148, v148, v219, v219
    v_fma_f32 v149, v149, v219, v219
    s_waitcnt lgkmcnt(4)
    v_mfma_f32_32x32x16_bf16 v[160:175], v[192:195], v[80:83], v[160:175]
    ds_read_b128 v[192:195], v1 offset:19456
    v_fma_f32 v150, v150, v219, v219
    v_fma_f32 v151, v151, v219, v219
    v_rcp_f32 v144, v144
    s_waitcnt lgkmcnt(4)
    v_mfma_f32_32x32x16_bf16 v[160:175], v[196:199], v[84:87], v[160:175]
    ds_read_b128 v[196:199], v1 offset:20480
    v_rcp_f32 v145, v145
    v_rcp_f32 v146, v146
    s_waitcnt lgkmcnt(4)
    v_mfma_f32_32x32x16_bf16 v[160:175], v[200:203], v[88:91], v[160:175]
    ds_read_b128 v[200:203], v1 offset:21504
    v_rcp_f32 v147, v147
    v_rcp_f32 v148, v148
    s_waitcnt lgkmcnt(4)
    v_mfma_f32_32x32x16_bf16 v[160:175], v[204:207], v[92:95], v[160:175]
    ds_read_b128 v[204:207], v1 offset:22528
    v_rcp_f32 v149, v149
    v_rcp_f32 v150, v150
    s_waitcnt lgkmcnt(4)
    v_mfma_f32_32x32x16_bf16 v[160:175], v[208:211], v[96:99], v[160:175]
    ds_read_b128 v[208:211], v1 offset:23552
    v_rcp_f32 v151, v151
    v_mul_f32 v144, v144, v152
    v_mul_f32 v145, v145, v153
    s_waitcnt lgkmcnt(4)
    v_mfma_f32_32x32x16_bf16 v[160:175], v[192:195], v[100:103], v[160:175]
    ds_read_b128 v[192:195], v1 offset:24576
    v_mul_f32 v146, v146, v154
    v_mul_f32 v147, v147, v155
    v_mul_f32 v148, v148, v156
    v_mul_f32 v149, v149, v157
    s_waitcnt lgkmcnt(4)
    v_mfma_f32_32x32x16_bf16 v[160:175], v[196:199], v[104:107], v[160:175]
    ds_read_b128 v[196:199], v1 offset:25600
    v_mul_f32 v150, v150, v158
    v_mul_f32 v151, v151, v159
    v_cvt_pk_bf16_f32 v144, v144, v145
    v_cvt_pk_bf16_f32 v145, v146, v147
    s_waitcnt lgkmcnt(4)
    v_mfma_f32_32x32x16_bf16 v[160:175], v[200:203], v[108:111], v[160:175]
    ds_read_b128 v[200:203], v4 offset:4608
    v_cvt_pk_bf16_f32 v146, v148, v149
    v_cvt_pk_bf16_f32 v147, v150, v151
    s_waitcnt lgkmcnt(4)
    v_mfma_f32_32x32x16_bf16 v[160:175], v[204:207], v[112:115], v[160:175]
    buffer_store_dwordx4 v[144:147], v0, s[96:99], s39 offen offset:1024
    buffer_store_dwordx4 v[144:147], v0, s[0:3], s39 offen offset:1024 sc1
    s_waitcnt lgkmcnt(3)
    v_mfma_f32_32x32x16_bf16 v[160:175], v[208:211], v[116:119], v[160:175]
    s_waitcnt lgkmcnt(2)
    v_mfma_f32_32x32x16_bf16 v[160:175], v[192:195], v[120:123], v[160:175]
    s_waitcnt lgkmcnt(1)
    v_mfma_f32_32x32x16_bf16 v[160:175], v[196:199], v[124:127], v[160:175]
    s_waitcnt lgkmcnt(0)
    v_mfma_f32_32x32x16_bf16 v[160:175], v[200:203], v[212:215], v[160:175]
    s_nop 11
    v_mul_f32 v168, v160, v168
    v_mul_f32 v160, v217, v160
    v_mul_f32 v169, v161, v169
    v_mul_f32 v161, v217, v161
    v_mul_f32 v170, v162, v170
    v_mul_f32 v162, v217, v162
    v_mul_f32 v171, v163, v171
    v_mul_f32 v163, v217, v163
    v_mul_f32 v172, v164, v172
    v_mul_f32 v164, v217, v164
    v_mul_f32 v173, v165, v173
    v_mul_f32 v165, v217, v165
    v_mul_f32 v174, v166, v174
    v_mul_f32 v166, v217, v166
    v_mul_f32 v175, v167, v175
    v_mul_f32 v167, v217, v167
    v_exp_f32 v160, v160
    v_exp_f32 v161, v161
    v_exp_f32 v162, v162
    v_exp_f32 v163, v163
    v_exp_f32 v164, v164
    v_exp_f32 v165, v165
    v_exp_f32 v166, v166
    v_exp_f32 v167, v167
    v_fma_f32 v160, v160, v219, v219
    v_fma_f32 v161, v161, v219, v219
    v_fma_f32 v162, v162, v219, v219
    v_fma_f32 v163, v163, v219, v219
    v_fma_f32 v164, v164, v219, v219
    v_fma_f32 v165, v165, v219, v219
    v_fma_f32 v166, v166, v219, v219
    v_fma_f32 v167, v167, v219, v219
    v_rcp_f32 v160, v160
    v_rcp_f32 v161, v161
    v_rcp_f32 v162, v162
    v_rcp_f32 v163, v163
    v_rcp_f32 v164, v164
    v_rcp_f32 v165, v165
    v_rcp_f32 v166, v166
    v_rcp_f32 v167, v167
    v_mul_f32 v160, v160, v168
    v_mul_f32 v161, v161, v169
    v_mul_f32 v162, v162, v170
    v_mul_f32 v163, v163, v171
    v_mul_f32 v164, v164, v172
    v_mul_f32 v165, v165, v173
    v_mul_f32 v166, v166, v174
    v_mul_f32 v167, v167, v175
    v_cvt_pk_bf16_f32 v160, v160, v161
    v_cvt_pk_bf16_f32 v161, v162, v163
    v_cvt_pk_bf16_f32 v162, v164, v165
    v_cvt_pk_bf16_f32 v163, v166, v167
    buffer_store_dwordx4 v[160:163], v0, s[96:99], s39 offen offset:2048
    buffer_store_dwordx4 v[160:163], v0, s[0:3], s39 offen offset:2048 sc1
    s_waitcnt vmcnt(0) lgkmcnt(0)
    s_barrier
    s_cmp_eq_u32 s14, 0
    s_cbranch_scc0 Loth_78
    s_add_u32 s34, s30, 8192
    v_mov_b32 v220, s100
    v_mov_b32 v221, s101
    s_mov_b64 exec, 1
    buffer_store_dwordx2 v[220:221], v0, s[96:99], s34 offen
    buffer_store_dwordx2 v[220:221], v0, s[0:3], s34 offen sc1
    s_mov_b64 exec, -1
Loth_78:
    s_cmp_ge_u32 s13, 14
    s_cbranch_scc1 Lp5end_77
    v_lshlrev_b32 v16, 16, v8
    v_and_b32 v17, 0xffff0000, v8
    v_lshlrev_b32 v18, 16, v9
    v_and_b32 v19, 0xffff0000, v9
    v_lshlrev_b32 v20, 16, v10
    v_and_b32 v21, 0xffff0000, v10
    v_lshlrev_b32 v22, 16, v11
    v_and_b32 v23, 0xffff0000, v11
    v_lshlrev_b32 v24, 16, v12
    v_and_b32 v25, 0xffff0000, v12
    v_lshlrev_b32 v26, 16, v13
    v_and_b32 v27, 0xffff0000, v13
    v_lshlrev_b32 v28, 16, v14
    v_and_b32 v29, 0xffff0000, v14
    v_lshlrev_b32 v30, 16, v15
    v_and_b32 v31, 0xffff0000, v15
    s_xor_b32 s34, s14, 1
    s_mul_i32 s34, s34, 12288
    s_add_u32 s34, s34, 0
    v_add_u32 v208, s34, v0
    s_xor_b32 s34, s14, 2
    s_mul_i32 s34, s34, 12288
    s_add_u32 s34, s34, 4096
    v_add_u32 v209, s34, v0
    s_xor_b32 s34, s14, 3
    s_mul_i32 s34, s34, 12288
    s_add_u32 s34, s34, 8192
    v_add_u32 v210, s34, v0
    s_mul_i32 s34, s14, 12288
    v_add_u32 v211, s34, v0
    v_mov_b32 v212, 0
    v_mov_b32 v213, 0
    v_mov_b32 v214, 0
    v_mov_b32 v215, 0
    v_mov_b32 v216, 0x3f803f80
    v_and_b32 v217, 0xf8, v7
    v_bfe_u32 v212, v7, 3, 5
    v_mul_u32_u24 v212, 896, v212
    v_bfe_u32 v213, v7, 8, 1
    v_lshl_add_u32 v212, v213, 4, v212
    s_cmp_eq_u32 s14, 0
    s_cbranch_scc0 Loth_80
    s_add_u32 s34, s29, 8192
    s_mov_b32 exec_lo, 0xffff
    s_mov_b32 exec_hi, 0
Lpoll_82:
    buffer_load_dwordx2 v[220:221], v7, s[4:7], s34 offen sc1
    s_waitcnt vmcnt(0)
    s_waitcnt vmcnt(0)
    v_cmp_eq_u64 vcc, s[100:101], v[220:221]
    s_sub_u32 s33, s33, 1
    s_cmp_eq_u32 s33, 0
    s_cbranch_scc1 main_done
    s_cmp_eq_u64 vcc, exec
    s_cbranch_scc0 Lpoll_82
    s_mov_b64 exec, -1
Loth_80:
    s_barrier
    s_add_u32 s36, s24, 0
    buffer_load_dwordx4 v[80:83], v0, s[4:7], s36 offen offset:0 sc1
    s_add_u32 s37, s25, 0
    buffer_load_dwordx4 v[84:87], v0, s[4:7], s37 offen offset:0 sc1
    buffer_load_dwordx4 v[88:91], v0, s[4:7], s36 offen offset:1024 sc1
    buffer_load_dwordx4 v[92:95], v0, s[4:7], s37 offen offset:1024 sc1
    buffer_load_dwordx4 v[96:99], v0, s[4:7], s36 offen offset:2048 sc1
    buffer_load_dwordx4 v[100:103], v0, s[4:7], s37 offen offset:2048 sc1
    buffer_load_dwordx4 v[104:107], v0, s[4:7], s36 offen offset:3072 sc1
    buffer_load_dwordx4 v[108:111], v0, s[4:7], s37 offen offset:3072 sc1
    s_add_u32 s36, s24, 4096
    buffer_load_dwordx4 v[112:115], v0, s[4:7], s36 offen offset:0 sc1
    s_add_u32 s37, s25, 4096
    buffer_load_dwordx4 v[116:119], v0, s[4:7], s37 offen offset:0 sc1
    s_waitcnt vmcnt(9)
    v_mfma_f32_32x32x16_bf16 v[32:47], a[4:7], v[80:83], 0
    buffer_load_dwordx4 v[120:123], v0, s[4:7], s36 offen offset:1024 sc1
    v_mfma_f32_32x32x16_bf16 v[16:31], a[0:3], v[80:83], v[16:31]
    s_waitcnt vmcnt(9)
    v_mfma_f32_32x32x16_bf16 v[48:63], a[0:3], v[84:87], 0
    buffer_load_dwordx4 v[124:127], v0, s[4:7], s37 offen offset:1024 sc1
    v_mfma_f32_32x32x16_bf16 v[64:79], a[4:7], v[84:87], 0
    s_waitcnt vmcnt(9)
    v_mfma_f32_32x32x16_bf16 v[32:47], a[12:15], v[88:91], v[32:47]
    buffer_load_dwordx4 v[128:131], v0, s[4:7], s36 offen offset:2048 sc1
    v_mfma_f32_32x32x16_bf16 v[16:31], a[8:11], v[88:91], v[16:31]
    s_waitcnt vmcnt(9)
    v_mfma_f32_32x32x16_bf16 v[48:63], a[8:11], v[92:95], v[48:63]
    buffer_load_dwordx4 v[132:135], v0, s[4:7], s37 offen offset:2048 sc1
    v_mfma_f32_32x32x16_bf16 v[64:79], a[12:15], v[92:95], v[64:79]
    s_waitcnt vmcnt(9)
    v_mfma_f32_32x32x16_bf16 v[32:47], a[20:23], v[96:99], v[32:47]
    buffer_load_dwordx4 v[136:139], v0, s[4:7], s36 offen offset:3072 sc1
    v_mfma_f32_32x32x16_bf16 v[16:31], a[16:19], v[96:99], v[16:31]
    s_waitcnt vmcnt(9)
    v_mfma_f32_32x32x16_bf16 v[48:63], a[16:19], v[100:103], v[48:63]
    buffer_load_dwordx4 v[140:143], v0, s[4:7], s37 offen offset:3072 sc1
    v_mfma_f32_32x32x16_bf16 v[64:79], a[20:23], v[100:103], v[64:79]
    s_waitcnt vmcnt(9)
    v_mfma_f32_32x32x16_bf16 v[32:47], a[28:31], v[104:107], v[32:47]
    s_add_u32 s36, s24, 8192
    buffer_load_dwordx4 v[144:147], v0, s[4:7], s36 offen offset:0 sc1
    v_mfma_f32_32x32x16_bf16 v[16:31], a[24:27], v[104:107], v[16:31]
    s_waitcnt vmcnt(9)
    v_mfma_f32_32x32x16_bf16 v[48:63], a[24:27], v[108:111], v[48:63]
    s_add_u32 s37, s25, 8192
    buffer_load_dwordx4 v[148:151], v0, s[4:7], s37 offen offset:0 sc1
    v_mfma_f32_32x32x16_bf16 v[64:79], a[28:31], v[108:111], v[64:79]
    s_waitcnt vmcnt(9)
    v_mfma_f32_32x32x16_bf16 v[32:47], a[36:39], v[112:115], v[32:47]
    buffer_load_dwordx4 v[152:155], v0, s[4:7], s36 offen offset:1024 sc1
    v_mfma_f32_32x32x16_bf16 v[16:31], a[32:35], v[112:115], v[16:31]
    s_waitcnt vmcnt(9)
    v_mfma_f32_32x32x16_bf16 v[48:63], a[32:35], v[116:119], v[48:63]
    buffer_load_dwordx4 v[156:159], v0, s[4:7], s37 offen offset:1024 sc1
    v_mfma_f32_32x32x16_bf16 v[64:79], a[36:39], v[116:119], v[64:79]
    s_waitcnt vmcnt(9)
    v_mfma_f32_32x32x16_bf16 v[32:47], a[44:47], v[120:123], v[32:47]
    buffer_load_dwordx4 v[160:163], v0, s[4:7], s36 offen offset:2048 sc1
    v_mfma_f32_32x32x16_bf16 v[16:31], a[40:43], v[120:123], v[16:31]
    s_waitcnt vmcnt(9)
    v_mfma_f32_32x32x16_bf16 v[48:63], a[40:43], v[124:127], v[48:63]
    buffer_load_dwordx4 v[164:167], v0, s[4:7], s37 offen offset:2048 sc1
    v_mfma_f32_32x32x16_bf16 v[64:79], a[44:47], v[124:127], v[64:79]
    s_waitcnt vmcnt(9)
    v_mfma_f32_32x32x16_bf16 v[32:47], a[52:55], v[128:131], v[32:47]
    buffer_load_dwordx4 v[168:171], v0, s[4:7], s36 offen offset:3072 sc1
    v_mfma_f32_32x32x16_bf16 v[16:31], a[48:51], v[128:131], v[16:31]
    s_waitcnt vmcnt(9)
    v_mfma_f32_32x32x16_bf16 v[48:63], a[48:51], v[132:135], v[48:63]
    buffer_load_dwordx4 v[172:175], v0, s[4:7], s37 offen offset:3072 sc1
    v_mfma_f32_32x32x16_bf16 v[64:79], a[52:55], v[132:135], v[64:79]
    s_waitcnt vmcnt(9)
    v_mfma_f32_32x32x16_bf16 v[32:47], a[60:63], v[136:139], v[32:47]
    s_add_u32 s36, s24, 12288
    buffer_load_dwordx4 v[176:179], v0, s[4:7], s36 offen offset:0 sc1
    v_mfma_f32_32x32x16_bf16 v[16:31], a[56:59], v[136:139], v[16:31]
    s_waitcnt vmcnt(9)
    v_mfma_f32_32x32x16_bf16 v[48:63], a[56:59], v[140:143], v[48:63]
    s_add_u32 s37, s25, 12288
    buffer_load_dwordx4 v[180:183], v0, s[4:7], s37 offen offset:0 sc1
    v_mfma_f32_32x32x16_bf16 v[64:79], a[60:63], v[140:143], v[64:79]
    s_waitcnt vmcnt(9)
    v_mfma_f32_32x32x16_bf16 v[32:47], a[68:71], v[144:147], v[32:47]
    buffer_load_dwordx4 v[184:187], v0, s[4:7], s36 offen offset:1024 sc1
    v_mfma_f32_32x32x16_bf16 v[16:31], a[64:67], v[144:147], v[16:31]
    s_waitcnt vmcnt(9)
    v_mfma_f32_32x32x16_bf16 v[48:63], a[64:67], v[148:151], v[48:63]
    buffer_load_dwordx4 v[188:191], v0, s[4:7], s37 offen offset:1024 sc1
    v_mfma_f32_32x32x16_bf16 v[64:79], a[68:71], v[148:151], v[64:79]
    s_waitcnt vmcnt(9)
    v_mfma_f32_32x32x16_bf16 v[32:47], a[76:79], v[152:155], v[32:47]
    buffer_load_dwordx4 v[192:195], v0, s[4:7], s36 offen offset:2048 sc1
    v_mfma_f32_32x32x16_bf16 v[16:31], a[72:75], v[152:155], v[16:31]
    s_waitcnt vmcnt(9)
    v_mfma_f32_32x32x16_bf16 v[48:63], a[72:75], v[156:159], v[48:63]
    buffer_load_dwordx4 v[196:199], v0, s[4:7], s37 offen offset:2048 sc1
    v_mfma_f32_32x32x16_bf16 v[64:79], a[76:79], v[156:159], v[64:79]
    s_waitcnt vmcnt(9)
    v_mfma_f32_32x32x16_bf16 v[32:47], a[84:87], v[160:163], v[32:47]
    buffer_load_dwordx4 v[200:203], v0, s[4:7], s36 offen offset:3072 sc1
    v_mfma_f32_32x32x16_bf16 v[16:31], a[80:83], v[160:163], v[16:31]
    s_waitcnt vmcnt(9)
    v_mfma_f32_32x32x16_bf16 v[48:63], a[80:83], v[164:167], v[48:63]
    buffer_load_dwordx4 v[204:207], v0, s[4:7], s37 offen offset:3072 sc1
    v_mfma_f32_32x32x16_bf16 v[64:79], a[84:87], v[164:167], v[64:79]
    s_waitcnt vmcnt(9)
    v_mfma_f32_32x32x16_bf16 v[32:47], a[92:95], v[168:171], v[32:47]
    s_add_u32 s36, s24, 16384
    buffer_load_dwordx4 v[80:83], v0, s[4:7], s36 offen offset:0 sc1
    v_mfma_f32_32x32x16_bf16 v[16:31], a[88:91], v[168:171], v[16:31]
    s_waitcnt vmcnt(9)
    v_mfma_f32_32x32x16_bf16 v[48:63], a[88:91], v[172:175], v[48:63]
    s_add_u32 s37, s25, 16384
    buffer_load_dwordx4 v[84:87], v0, s[4:7], s37 offen offset:0 sc1
    v_mfma_f32_32x32x16_bf16 v[64:79], a[92:95], v[172:175], v[64:79]
    s_waitcnt vmcnt(9)
    v_mfma_f32_32x32x16_bf16 v[32:47], a[100:103], v[176:179], v[32:47]
    buffer_load_dwordx4 v[88:91], v0, s[4:7], s36 offen offset:1024 sc1
    v_mfma_f32_32x32x16_bf16 v[16:31], a[96:99], v[176:179], v[16:31]
    s_waitcnt vmcnt(9)
    v_mfma_f32_32x32x16_bf16 v[48:63], a[96:99], v[180:183], v[48:63]
    buffer_load_dwordx4 v[92:95], v0, s[4:7], s37 offen offset:1024 sc1
    v_mfma_f32_32x32x16_bf16 v[64:79], a[100:103], v[180:183], v[64:79]
    s_waitcnt vmcnt(9)
    v_mfma_f32_32x32x16_bf16 v[32:47], a[108:111], v[184:187], v[32:47]
    buffer_load_dwordx4 v[96:99], v0, s[4:7], s36 offen offset:2048 sc1
    v_mfma_f32_32x32x16_bf16 v[16:31], a[104:107], v[184:187], v[16:31]
    s_waitcnt vmcnt(9)
    v_mfma_f32_32x32x16_bf16 v[48:63], a[104:107], v[188:191], v[48:63]
    buffer_load_dwordx4 v[100:103], v0, s[4:7], s37 offen offset:2048 sc1
    v_mfma_f32_32x32x16_bf16 v[64:79], a[108:111], v[188:191], v[64:79]
    s_waitcnt vmcnt(9)
    v_mfma_f32_32x32x16_bf16 v[32:47], a[116:119], v[192:195], v[32:47]
    buffer_load_dwordx4 v[104:107], v0, s[4:7], s36 offen offset:3072 sc1
    v_mfma_f32_32x32x16_bf16 v[16:31], a[112:115], v[192:195], v[16:31]
    s_waitcnt vmcnt(9)
    v_mfma_f32_32x32x16_bf16 v[48:63], a[112:115], v[196:199], v[48:63]
    buffer_load_dwordx4 v[108:111], v0, s[4:7], s37 offen offset:3072 sc1
    v_mfma_f32_32x32x16_bf16 v[64:79], a[116:119], v[196:199], v[64:79]
    s_waitcnt vmcnt(9)
    v_mfma_f32_32x32x16_bf16 v[32:47], a[124:127], v[200:203], v[32:47]
    s_add_u32 s36, s24, 20480
    buffer_load_dwordx4 v[112:115], v0, s[4:7], s36 offen offset:0 sc1
    v_mfma_f32_32x32x16_bf16 v[16:31], a[120:123], v[200:203], v[16:31]
    s_waitcnt vmcnt(9)
    v_mfma_f32_32x32x16_bf16 v[48:63], a[120:123], v[204:207], v[48:63]
    s_add_u32 s37, s25, 20480
    buffer_load_dwordx4 v[116:119], v0, s[4:7], s37 offen offset:0 sc1
    v_mfma_f32_32x32x16_bf16 v[64:79], a[124:127], v[204:207], v[64:79]
    s_waitcnt vmcnt(9)
    v_mfma_f32_32x32x16_bf16 v[32:47], a[132:135], v[80:83], v[32:47]
    buffer_load_dwordx4 v[120:123], v0, s[4:7], s36 offen offset:1024 sc1
    v_mfma_f32_32x32x16_bf16 v[16:31], a[128:131], v[80:83], v[16:31]
    s_waitcnt vmcnt(9)
    v_mfma_f32_32x32x16_bf16 v[48:63], a[128:131], v[84:87], v[48:63]
    buffer_load_dwordx4 v[124:127], v0, s[4:7], s37 offen offset:1024 sc1
    v_mfma_f32_32x32x16_bf16 v[64:79], a[132:135], v[84:87], v[64:79]
    s_waitcnt vmcnt(9)
    v_mfma_f32_32x32x16_bf16 v[32:47], a[140:143], v[88:91], v[32:47]
    buffer_load_dwordx4 v[128:131], v0, s[4:7], s36 offen offset:2048 sc1
    v_mfma_f32_32x32x16_bf16 v[16:31], a[136:139], v[88:91], v[16:31]
    s_waitcnt vmcnt(9)
    v_mfma_f32_32x32x16_bf16 v[48:63], a[136:139], v[92:95], v[48:63]
    buffer_load_dwordx4 v[132:135], v0, s[4:7], s37 offen offset:2048 sc1
    v_mfma_f32_32x32x16_bf16 v[64:79], a[140:143], v[92:95], v[64:79]
    s_waitcnt vmcnt(9)
    v_mfma_f32_32x32x16_bf16 v[32:47], a[148:151], v[96:99], v[32:47]
    buffer_load_dwordx4 v[136:139], v0, s[4:7], s36 offen offset:3072 sc1
    v_mfma_f32_32x32x16_bf16 v[16:31], a[144:147], v[96:99], v[16:31]
    s_waitcnt vmcnt(9)
    v_mfma_f32_32x32x16_bf16 v[48:63], a[144:147], v[100:103], v[48:63]
    buffer_load_dwordx4 v[140:143], v0, s[4:7], s37 offen offset:3072 sc1
    v_mfma_f32_32x32x16_bf16 v[64:79], a[148:151], v[100:103], v[64:79]
    s_waitcnt vmcnt(9)
    v_mfma_f32_32x32x16_bf16 v[32:47], a[156:159], v[104:107], v[32:47]
    s_add_u32 s36, s24, 24576
    buffer_load_dwordx4 v[144:147], v0, s[4:7], s36 offen offset:0 sc1
    v_mfma_f32_32x32x16_bf16 v[16:31], a[152:155], v[104:107], v[16:31]
    s_waitcnt vmcnt(9)
    v_mfma_f32_32x32x16_bf16 v[48:63], a[152:155], v[108:111], v[48:63]
    s_add_u32 s37, s25, 24576
    buffer_load_dwordx4 v[148:151], v0, s[4:7], s37 offen offset:0 sc1
    v_mfma_f32_32x32x16_bf16 v[64:79], a[156:159], v[108:111], v[64:79]
    s_waitcnt vmcnt(9)
    v_mfma_f32_32x32x16_bf16 v[32:47], a[164:167], v[112:115], v[32:47]
    buffer_load_dwordx4 v[152:155], v0, s[4:7], s36 offen offset:1024 sc1
    v_mfma_f32_32x32x16_bf16 v[16:31], a[160:163], v[112:115], v[16:31]
    s_waitcnt vmcnt(9)
    v_mfma_f32_32x32x16_bf16 v[48:63], a[160:163], v[116:119], v[48:63]
    buffer_load_dwordx4 v[156:159], v0, s[4:7], s37 offen offset:1024 sc1
    v_mfma_f32_32x32x16_bf16 v[64:79], a[164:167], v[116:119], v[64:79]
    s_waitcnt vmcnt(9)
    v_mfma_f32_32x32x16_bf16 v[32:47], a[172:175], v[120:123], v[32:47]
    buffer_load_dwordx4 v[160:163], v0, s[4:7], s36 offen offset:2048 sc1
    v_mfma_f32_32x32x16_bf16 v[16:31], a[168:171], v[120:123], v[16:31]
    s_waitcnt vmcnt(9)
    v_mfma_f32_32x32x16_bf16 v[48:63], a[168:171], v[124:127], v[48:63]
    buffer_load_dwordx4 v[164:167], v0, s[4:7], s37 offen offset:2048 sc1
    v_mfma_f32_32x32x16_bf16 v[64:79], a[172:175], v[124:127], v[64:79]
    s_waitcnt vmcnt(9)
    v_mfma_f32_32x32x16_bf16 v[32:47], a[180:183], v[128:131], v[32:47]
    buffer_load_dwordx4 v[168:171], v0, s[4:7], s36 offen offset:3072 sc1
    v_mfma_f32_32x32x16_bf16 v[16:31], a[176:179], v[128:131], v[16:31]
    s_waitcnt vmcnt(9)
    v_mfma_f32_32x32x16_bf16 v[48:63], a[176:179], v[132:135], v[48:63]
    buffer_load_dwordx4 v[172:175], v0, s[4:7], s37 offen offset:3072 sc1
    v_mfma_f32_32x32x16_bf16 v[64:79], a[180:183], v[132:135], v[64:79]
    s_waitcnt vmcnt(9)
    v_mfma_f32_32x32x16_bf16 v[32:47], a[188:191], v[136:139], v[32:47]
    v_mfma_f32_32x32x16_bf16 v[16:31], a[184:187], v[136:139], v[16:31]
    s_waitcnt vmcnt(8)
    v_mfma_f32_32x32x16_bf16 v[48:63], a[184:187], v[140:143], v[48:63]
    v_mfma_f32_32x32x16_bf16 v[64:79], a[188:191], v[140:143], v[64:79]
    s_waitcnt vmcnt(7)
    v_mfma_f32_32x32x16_bf16 v[32:47], a[196:199], v[144:147], v[32:47]
    v_mfma_f32_32x32x16_bf16 v[16:31], a[192:195], v[144:147], v[16:31]
    s_waitcnt vmcnt(6)
    v_mfma_f32_32x32x16_bf16 v[48:63], a[192:195], v[148:151], v[48:63]
    v_mfma_f32_32x32x16_bf16 v[64:79], a[196:199], v[148:151], v[64:79]
    s_waitcnt vmcnt(5)
    v_mfma_f32_32x32x16_bf16 v[32:47], a[204:207], v[152:155], v[32:47]
    v_mfma_f32_32x32x16_bf16 v[16:31], a[200:203], v[152:155], v[16:31]
    s_waitcnt vmcnt(4)
    v_mfma_f32_32x32x16_bf16 v[48:63], a[200:203], v[156:159], v[48:63]
    v_mfma_f32_32x32x16_bf16 v[64:79], a[204:207], v[156:159], v[64:79]
    s_waitcnt vmcnt(3)
    v_mfma_f32_32x32x16_bf16 v[32:47], a[212:215], v[160:163], v[32:47]
    v_mfma_f32_32x32x16_bf16 v[16:31], a[208:211], v[160:163], v[16:31]
    s_waitcnt vmcnt(2)
    v_mfma_f32_32x32x16_bf16 v[48:63], a[208:211], v[164:167], v[48:63]
    v_mfma_f32_32x32x16_bf16 v[64:79], a[212:215], v[164:167], v[64:79]
    s_waitcnt vmcnt(1)
    v_mfma_f32_32x32x16_bf16 v[32:47], a[220:223], v[168:171], v[32:47]
    s_waitcnt vmcnt(0)
    v_mfma_f32_32x32x16_bf16 v[48:63], a[216:219], v[172:175], v[48:63]
    v_mfma_f32_32x32x16_bf16 v[64:79], a[220:223], v[172:175], v[64:79]
    s_nop 8
    ds_write_b128 v208, v[32:35] offset:0
    ds_write_b128 v208, v[36:39] offset:1024
    v_mfma_f32_32x32x16_bf16 v[16:31], a[216:219], v[168:171], v[16:31]
    ds_write_b128 v208, v[40:43] offset:2048
    ds_write_b128 v208, v[44:47] offset:3072
    ds_write_b128 v209, v[48:51] offset:0
    ds_write_b128 v209, v[52:55] offset:1024
    ds_write_b128 v209, v[56:59] offset:2048
    ds_write_b128 v209, v[60:63] offset:3072
    ds_write_b128 v210, v[64:67] offset:0
    ds_write_b128 v210, v[68:71] offset:1024
    ds_write_b128 v210, v[72:75] offset:2048
    ds_write_b128 v210, v[76:79] offset:3072
    s_waitcnt lgkmcnt(0)
    s_barrier
    ds_read_b128 v[80:83], v211 offset:0
    ds_read_b128 v[96:99], v211 offset:4096
    ds_read_b128 v[112:115], v211 offset:8192
    ds_read_b128 v[84:87], v211 offset:1024
    ds_read_b128 v[100:103], v211 offset:5120
    ds_read_b128 v[116:119], v211 offset:9216
    ds_read_b128 v[88:91], v211 offset:2048
    ds_read_b128 v[104:107], v211 offset:6144
    ds_read_b128 v[120:123], v211 offset:10240
    ds_read_b128 v[92:95], v211 offset:3072
    ds_read_b128 v[108:111], v211 offset:7168
    ds_read_b128 v[124:127], v211 offset:11264
    s_waitcnt lgkmcnt(11)
    v_add_f32 v16, v16, v80
    v_add_f32 v17, v17, v81
    v_add_f32 v18, v18, v82
    v_add_f32 v19, v19, v83
    s_waitcnt lgkmcnt(10)
    v_add_f32 v16, v16, v96
    v_add_f32 v17, v17, v97
    v_add_f32 v18, v18, v98
    v_add_f32 v19, v19, v99
    s_waitcnt lgkmcnt(9)
    v_add_f32 v16, v16, v112
    v_add_f32 v17, v17, v113
    v_add_f32 v18, v18, v114
    v_add_f32 v19, v19, v115
    s_waitcnt lgkmcnt(8)
    v_add_f32 v20, v20, v84
    v_add_f32 v21, v21, v85
    v_add_f32 v22, v22, v86
    v_add_f32 v23, v23, v87
    s_waitcnt lgkmcnt(7)
    v_add_f32 v20, v20, v100
    v_add_f32 v21, v21, v101
    v_add_f32 v22, v22, v102
    v_add_f32 v23, v23, v103
    s_waitcnt lgkmcnt(6)
    v_add_f32 v20, v20, v116
    v_add_f32 v21, v21, v117
    v_add_f32 v22, v22, v118
    v_add_f32 v23, v23, v119
    v_cvt_pk_bf16_f32 v8, v16, v17
    v_cvt_pk_bf16_f32 v9, v18, v19
    v_cvt_pk_bf16_f32 v10, v20, v21
    v_cvt_pk_bf16_f32 v11, v22, v23
    buffer_store_dwordx4 v[8:11], v212, s[8:11], s57 offen offset:0
    s_waitcnt lgkmcnt(5)
    v_add_f32 v24, v24, v88
    v_add_f32 v25, v25, v89
    v_add_f32 v26, v26, v90
    v_add_f32 v27, v27, v91
    s_waitcnt lgkmcnt(4)
    v_add_f32 v24, v24, v104
    v_add_f32 v25, v25, v105
    v_add_f32 v26, v26, v106
    v_add_f32 v27, v27, v107
    s_waitcnt lgkmcnt(3)
    v_add_f32 v24, v24, v120
    v_add_f32 v25, v25, v121
    v_add_f32 v26, v26, v122
    v_add_f32 v27, v27, v123
    s_waitcnt lgkmcnt(2)
    v_add_f32 v28, v28, v92
    v_add_f32 v29, v29, v93
    v_add_f32 v30, v30, v94
    v_add_f32 v31, v31, v95
    s_waitcnt lgkmcnt(1)
    v_add_f32 v28, v28, v108
    v_add_f32 v29, v29, v109
    v_add_f32 v30, v30, v110
    v_add_f32 v31, v31, v111
    s_waitcnt lgkmcnt(0)
    v_add_f32 v28, v28, v124
    v_add_f32 v29, v29, v125
    v_add_f32 v30, v30, v126
    v_add_f32 v31, v31, v127
    v_cvt_pk_bf16_f32 v12, v24, v25
    v_cvt_pk_bf16_f32 v13, v26, v27
    v_cvt_pk_bf16_f32 v14, v28, v29
    v_cvt_pk_bf16_f32 v15, v30, v31
    buffer_store_dwordx4 v[12:15], v212, s[8:11], s57 offen offset:32
Lp5end_77:
main_done:
    s_endpgm
.section .rodata,"a"
.p2align 6
.amdhsa_kernel interleave_layers__sliding_block__glu_gated_swiglu__prompt_kernel
  .amdhsa_next_free_vgpr 512
  .amdhsa_next_free_sgpr 102
  .amdhsa_accum_offset 256
  .amdhsa_group_segment_fixed_size 0
  .amdhsa_kernarg_size 80
  .amdhsa_user_sgpr_count 2
  .amdhsa_user_sgpr_kernarg_segment_ptr 1
  .amdhsa_system_sgpr_workgroup_id_x 1
.end_amdhsa_kernel
```
